```python
import torch

def _softmax(x, axis=-1):
    return torch.softmax(x, dim=axis)
def _gelu(x):
    return torch.nn.functional.gelu(x, approximate="tanh")
def _silu(x):
    return torch.nn.functional.silu(x)
def _sigmoid(x):
    return torch.sigmoid(x)
def _layernorm(x, axis=-1, eps=1e-5):
    m = x.mean(dim=axis, keepdim=True)
    v = x.var(dim=axis, keepdim=True, unbiased=False)
    return (x - m) / torch.sqrt(v + eps)
def _scatter_add(tgt, idx, src, axis=0):
    return tgt.clone().index_add_(axis, idx, src)
def _segment_sum(src, seg, n):
    out = torch.zeros((n,) + src.shape[1:], dtype=src.dtype)
    return out.index_add_(0, seg, src)
def _pad(x, pw):
    flat = tuple(v for pair in reversed(pw) for v in pair)
    return torch.nn.functional.pad(x, flat)

kernel_name = 'gated_mix__ssm_conv_s5__dense_activation_squared_relu__prompt'

def setup_inputs():

    _w = (lambda a: (lambda t: t.to(torch.bfloat16) if t.is_floating_point() else t)(torch.as_tensor(a)))
    def _A_setup():
        B, S, D = 1, 2048, 1024
        P = D
        Lambda_re = -0.5 * (lambda _x: torch.exp(torch.as_tensor(_x)))((lambda *s: torch.randn(*s, dtype=torch.bfloat16) * 0.4)(P))
        Lambda_im = (lambda *s: torch.randn(*s, dtype=torch.bfloat16) * 0.8)(P) * 1.0
        B_re = (lambda *s: torch.randn(*s, dtype=torch.bfloat16) * 0.8)(P, D) * (D ** -0.5)
        B_im = (lambda *s: torch.randn(*s, dtype=torch.bfloat16) * 0.8)(P, D) * (D ** -0.5)
        C_re = (lambda *s: torch.randn(*s, dtype=torch.bfloat16) * 0.8)(D, P) * (P ** -0.5)
        C_im = (lambda *s: torch.randn(*s, dtype=torch.bfloat16) * 0.8)(D, P) * (P ** -0.5)
        log_dt = (lambda *s: torch.randn(*s, dtype=torch.bfloat16) * 0.4)(P) * 0.3 - 2.0
        Dskip = (lambda *s: torch.randn(*s, dtype=torch.bfloat16) * 0.1)(D)
        return {
            "x": _w((lambda *s: torch.randn(*s, dtype=torch.bfloat16) * 0.05)(B, S, D)),
            "Lambda_re": _w(Lambda_re),
            "Lambda_im": _w(Lambda_im),
            "B_re": _w(B_re),
            "B_im": _w(B_im),
            "C_re": _w(C_re),
            "C_im": _w(C_im),
            "log_dt": _w(log_dt),
            "Dskip": _w(Dskip),
        }
    _A_in = _A_setup()

    def _B_setup():
        B, S, D, F = 1, 2048, 1024, 3584
        return {
            "x": _w((lambda *s: torch.randn(*s, dtype=torch.bfloat16) * 0.05)(B, S, D)),
            "w1": _w((lambda *s: torch.randn(*s, dtype=torch.bfloat16) * 0.05)(D, F)),
            "b1": _w((lambda *s: torch.randn(*s, dtype=torch.bfloat16) * 0.05)(F)),
            "w2": _w((lambda *s: torch.randn(*s, dtype=torch.bfloat16) * 0.05)(F, D)),
            "b2": _w((lambda *s: torch.randn(*s, dtype=torch.bfloat16) * 0.05)(D)),
        }
    _B_in = _B_setup()

    return {
        "A_x": _A_in["x"],
        "A_Lambda_re": _A_in["Lambda_re"],
        "A_Lambda_im": _A_in["Lambda_im"],
        "A_B_re": _A_in["B_re"],
        "A_B_im": _A_in["B_im"],
        "A_C_re": _A_in["C_re"],
        "A_C_im": _A_in["C_im"],
        "A_log_dt": _A_in["log_dt"],
        "A_Dskip": _A_in["Dskip"],
        "B_x": _B_in["x"],
        "B_w1": _B_in["w1"],
        "B_b1": _B_in["b1"],
        "B_w2": _B_in["w2"],
        "B_b2": _B_in["b2"],
        "gate_w": _w((lambda *s: torch.randn(*s, dtype=torch.bfloat16) * 0.05)(1024) * 16.0),
    }

def reference(A_x, A_Lambda_re, A_Lambda_im, A_B_re, A_B_im, A_C_re, A_C_im, A_log_dt, A_Dskip, B_x, B_w1, B_b1, B_w2, B_b2, gate_w):
    def _A_ref(x, Lambda_re, Lambda_im, B_re, B_im, C_re, C_im, log_dt, Dskip):
        Bsz, L, H = x.shape
        Lam = Lambda_re + 1j * Lambda_im
        Bmat = B_re + 1j * B_im
        Cmat = C_re + 1j * C_im
        dt = torch.exp(log_dt)
        Lam_bar = torch.exp(dt * Lam)
        B_bar = ((Lam_bar - 1.0) / Lam)[:, None] * Bmat
        Bu = torch.einsum("bld,pd->blp", x + 0j, B_bar)
        h = torch.zeros_like(Bu[:, 0, :])
        hs = []
        for t in range(L):
            h = Lam_bar[None, :] * h + Bu[:, t, :]
            hs.append(h)
        hseq = torch.stack(hs, 1)
        y = 2.0 * torch.einsum("blp,dp->bld", hseq, Cmat).real + x * Dskip[None, None, :]
        return y

    def _B_ref(x, w1, b1, w2, b2):
        h = torch.einsum("bsd,df->bsf", x, w1) + b1
        zero = torch.zeros_like(h)
        r = torch.where(h > zero, h, zero)
        h = r * r
        out = torch.einsum("bsf,fd->bsd", h, w2) + b2
        return out

    x = A_x
    g = _sigmoid((x * gate_w).sum(-1, keepdims=True))
    a = _A_ref(x, A_Lambda_re, A_Lambda_im, A_B_re, A_B_im, A_C_re, A_C_im, A_log_dt, A_Dskip)
    b = _B_ref(x, B_w1, B_b1, B_w2, B_b2)
    return g * a + (1 - g) * b
```

```asm
; @launch grid=(256,1,1) block=(512,1,1) lds=155648
.amdgcn_target "amdgcn-amd-amdhsa--gfx950"
.text
.globl gated_mix__ssm_conv_s5__dense_activation_squared_relu__prompt_kernel
.p2align 8
.type gated_mix__ssm_conv_s5__dense_activation_squared_relu__prompt_kernel,@function
gated_mix__ssm_conv_s5__dense_activation_squared_relu__prompt_kernel:
    s_cmp_ge_u32 s2, 256
    s_cbranch_scc1 L_end
    s_load_dwordx16 s[40:55], s[0:1], 0
    s_load_dwordx16 s[56:71], s[0:1], 64
    s_load_dwordx4 s[72:75], s[0:1], 128
    s_getpc_b64 s[4:5]
L_pc:
    v_lshlrev_b32 v2, 7, v0
    v_min_u32 v2, L_codeend-L_pc-4, v2
    global_load_dword v250, v2, s[4:5]
    v_lshrrev_b32 v1, 6, v0
    v_and_b32 v0, 63, v0
    v_readfirstlane_b32 s28, v1
    s_and_b32 s76, s2, 7
    s_lshr_b32 s77, s2, 3
    s_lshr_b32 s31, s77, 4
    s_bfe_u32 s78, s77, 0x20002
    s_and_b32 s79, s77, 3
    s_lshr_b32 s29, s76, 2
    s_lshl_b32 s29, s29, 2
    s_add_u32 s29, s29, s78
    s_and_b32 s30, s76, 3
    s_lshl_b32 s30, s30, 2
    s_add_u32 s30, s30, s79
    s_xor_b32 s78, s78, s79
    s_and_b32 s78, s78, 1
    s_lshl_b32 s82, s78, 3
    s_and_b32 s76, s76, 3
    s_lshl_b32 s76, s76, 1
    s_add_u32 s82, s82, s76
    s_and_b32 s82, s82, 15
    s_cmp_eq_u32 s31, 1
    s_cbranch_scc1 L_ssm
    s_lshr_b32 s80, s28, 2
    s_and_b32 s81, s28, 3
    s_mul_i32 s76, s30, 448
    s_mul_i32 s88, s28, 3
    s_min_u32 s89, s28, 4
    s_add_u32 s88, s88, s89
    s_add_u32 s89, s88, 0
    s_lshl_b32 s89, s89, 6
    v_add_u32 v2, s89, v0
    v_mul_u32_u24 v3, 37450, v2
    v_lshrrev_b32 v3, 20, v3
    v_mul_u32_u24 v4, 28, v3
    v_sub_u32 v2, v2, v4
    v_bfe_u32 v4, v3, 3, 1
    v_lshlrev_b32 v4, 1, v4
    v_xor_b32 v2, v2, v4
    v_mul_u32_u24 v3, 7168, v3
    v_lshl_add_u32 v2, v2, 4, v3
    v_add_u32 v10, s76, v2
    s_add_u32 s89, s88, 1
    s_lshl_b32 s89, s89, 6
    v_add_u32 v2, s89, v0
    v_mul_u32_u24 v3, 37450, v2
    v_lshrrev_b32 v3, 20, v3
    v_mul_u32_u24 v4, 28, v3
    v_sub_u32 v2, v2, v4
    v_bfe_u32 v4, v3, 3, 1
    v_lshlrev_b32 v4, 1, v4
    v_xor_b32 v2, v2, v4
    v_mul_u32_u24 v3, 7168, v3
    v_lshl_add_u32 v2, v2, 4, v3
    s_sub_u32 s89, s76, 1024
    v_add_u32 v11, s89, v2
    s_add_u32 s89, s88, 2
    s_lshl_b32 s89, s89, 6
    v_add_u32 v2, s89, v0
    v_mul_u32_u24 v3, 37450, v2
    v_lshrrev_b32 v3, 20, v3
    v_mul_u32_u24 v4, 28, v3
    v_sub_u32 v2, v2, v4
    v_bfe_u32 v4, v3, 3, 1
    v_lshlrev_b32 v4, 1, v4
    v_xor_b32 v2, v2, v4
    v_mul_u32_u24 v3, 7168, v3
    v_lshl_add_u32 v2, v2, 4, v3
    s_sub_u32 s89, s76, 2048
    v_add_u32 v12, s89, v2
    s_add_u32 s89, s88, 3
    s_lshl_b32 s89, s89, 6
    v_add_u32 v2, s89, v0
    v_mul_u32_u24 v3, 37450, v2
    v_lshrrev_b32 v3, 20, v3
    v_mul_u32_u24 v4, 28, v3
    v_sub_u32 v2, v2, v4
    v_bfe_u32 v4, v3, 3, 1
    v_lshlrev_b32 v4, 1, v4
    v_xor_b32 v2, v2, v4
    v_mul_u32_u24 v3, 7168, v3
    v_lshl_add_u32 v2, v2, 4, v3
    s_sub_u32 s89, s76, 3072
    v_add_u32 v13, s89, v2
    v_and_b32 v2, 7, v0
    v_lshrrev_b32 v3, 4, v0
    v_xor_b32 v2, v2, v3
    v_lshlrev_b32 v2, 4, v2
    v_lshrrev_b32 v3, 3, v0
    v_lshl_add_u32 v2, v3, 11, v2
    s_lshl_b32 s76, s29, 8
    s_lshl_b32 s77, s28, 5
    s_add_u32 s76, s76, s77
    s_add_u32 s76, s76, 0
    s_lshl_b32 s76, s76, 11
    s_sub_u32 s76, s76, 0
    v_add_u32 v18, s76, v2
    s_lshl_b32 s76, s29, 8
    s_lshl_b32 s77, s28, 5
    s_add_u32 s76, s76, s77
    s_add_u32 s76, s76, 8
    s_lshl_b32 s76, s76, 11
    s_sub_u32 s76, s76, 1024
    v_xor_b32 v19, 64, v2
    v_add_u32 v19, s76, v19
    s_lshl_b32 s76, s29, 8
    s_lshl_b32 s77, s28, 5
    s_add_u32 s76, s76, s77
    s_add_u32 s76, s76, 16
    s_lshl_b32 s76, s76, 11
    s_sub_u32 s76, s76, 2048
    v_add_u32 v20, s76, v2
    s_lshl_b32 s76, s29, 8
    s_lshl_b32 s77, s28, 5
    s_add_u32 s76, s76, s77
    s_add_u32 s76, s76, 24
    s_lshl_b32 s76, s76, 11
    s_sub_u32 s76, s76, 3072
    v_xor_b32 v21, 64, v2
    v_add_u32 v21, s76, v21
    s_mul_i32 s38, s28, 3
    s_min_u32 s88, s28, 4
    s_add_u32 s38, s38, s88
    s_lshl_b32 s38, s38, 10
    s_lshl_b32 s39, s28, 12
    s_add_u32 s39, s39, 57344
    s_mul_i32 s36, s82, 458752
    s_lshl_b32 s37, s82, 7
    s_waitcnt lgkmcnt(0)
    s_mov_b32 s4, s40
    s_mov_b32 s5, s41
    s_mov_b32 s6, 4194304
    s_mov_b32 s7, 0x20000
    s_mov_b32 s16, s74
    s_mov_b32 s17, s75
    s_mov_b32 s18, 268435456
    s_mov_b32 s19, 0x20000
    s_mov_b32 s20, s72
    s_mov_b32 s21, s73
    s_mov_b32 s22, 256
    s_mov_b32 s23, 0x20000
    s_mov_b32 s8, s60
    s_mov_b32 s9, s61
    s_mov_b32 s10, 7340032
    s_mov_b32 s11, 0x20000
    s_mov_b32 s32, 0
    s_mov_b32 s85, 0
    s_add_u32 s35, s32, s38
    s_mov_b32 m0, s35
    s_nop 0
    buffer_load_dwordx4 v10, s[8:11], s36 offen lds
    buffer_load_dwordx4 v11, s[8:11], s36 offen offset:1024 lds
    buffer_load_dwordx4 v12, s[8:11], s36 offen offset:2048 lds
    s_cmp_lt_u32 s28, 4
    s_cbranch_scc0 L_ncs1
    buffer_load_dwordx4 v13, s[8:11], s36 offen offset:3072 lds
L_ncs1:
    s_add_u32 s36, s36, 458752
    s_cmp_eq_u32 s36, 7340032
    s_cselect_b32 s36, 0, s36
    s_add_u32 s32, s32, 28672
    s_add_u32 s35, s85, s39
    s_mov_b32 m0, s35
    s_nop 0
    buffer_load_dwordx4 v18, s[4:7], s37 offen lds
    buffer_load_dwordx4 v19, s[4:7], s37 offen offset:1024 lds
    buffer_load_dwordx4 v20, s[4:7], s37 offen offset:2048 lds
    buffer_load_dwordx4 v21, s[4:7], s37 offen offset:3072 lds
    s_add_u32 s37, s37, 128
    s_and_b32 s37, s37, 2047
    s_add_u32 s85, s85, 32768
    s_mul_i32 s78, s30, 224
    s_mul_i32 s79, s80, 112
    s_add_u32 s78, s78, s79
    s_lshl_b32 s79, s78, 1
    v_lshrrev_b32 v4, 4, v0
    v_lshlrev_b32 v4, 3, v4
    s_mov_b32 s24, s62
    s_mov_b32 s25, s63
    s_mov_b32 s26, 7168
    s_mov_b32 s27, 0x20000
    buffer_load_dwordx2 v[226:227], v4, s[24:27], s79 offen offset:0
    buffer_load_dwordx2 v[228:229], v4, s[24:27], s79 offen offset:32
    buffer_load_dwordx2 v[230:231], v4, s[24:27], s79 offen offset:64
    buffer_load_dwordx2 v[232:233], v4, s[24:27], s79 offen offset:96
    buffer_load_dwordx2 v[234:235], v4, s[24:27], s79 offen offset:128
    buffer_load_dwordx2 v[236:237], v4, s[24:27], s79 offen offset:160
    buffer_load_dwordx2 v[238:239], v4, s[24:27], s79 offen offset:192
    s_mul_i32 s76, s80, 7
    v_lshrrev_b32 v2, 4, v0
    v_lshlrev_b32 v2, 3, v2
    v_bfe_u32 v3, v0, 2, 2
    v_add_u32 v2, v2, v3
    v_bfe_u32 v3, v2, 3, 1
    v_mul_u32_u24 v2, 448, v2
    v_and_b32 v4, 3, v0
    v_lshl_add_u32 v2, v4, 3, v2
    s_add_u32 s88, s76, 0
    v_xor_b32 v4, s88, v3
    v_lshl_add_u32 v14, v4, 5, v2
    s_add_u32 s88, s76, 1
    v_xor_b32 v4, s88, v3
    v_subrev_u32 v4, 1, v4
    v_lshl_add_u32 v15, v4, 5, v2
    s_mul_i32 s76, s81, 4
    v_and_b32 v2, 15, v0
    v_lshrrev_b32 v3, 4, v0
    v_lshrrev_b32 v4, 1, v2
    v_xor_b32 v3, v3, v4
    v_lshlrev_b32 v3, 4, v3
    v_lshl_add_u32 v2, v2, 7, v3
    s_lshl_b32 s88, s76, 11
    s_add_u32 s88, s88, 57344
    v_add_u32 v22, s88, v2
    s_add_u32 s35, s32, s38
    s_mov_b32 m0, s35
    s_nop 0
    buffer_load_dwordx4 v10, s[8:11], s36 offen lds
    buffer_load_dwordx4 v11, s[8:11], s36 offen offset:1024 lds
    buffer_load_dwordx4 v12, s[8:11], s36 offen offset:2048 lds
    s_cmp_lt_u32 s28, 4
    s_cbranch_scc0 L_ncs2
    buffer_load_dwordx4 v13, s[8:11], s36 offen offset:3072 lds
L_ncs2:
    s_add_u32 s36, s36, 458752
    s_cmp_eq_u32 s36, 7340032
    s_cselect_b32 s36, 0, s36
    s_add_u32 s32, s32, 28672
    s_add_u32 s35, s85, s39
    s_mov_b32 m0, s35
    s_nop 0
    buffer_load_dwordx4 v18, s[4:7], s37 offen lds
    buffer_load_dwordx4 v19, s[4:7], s37 offen offset:1024 lds
    buffer_load_dwordx4 v20, s[4:7], s37 offen offset:2048 lds
    buffer_load_dwordx4 v21, s[4:7], s37 offen offset:3072 lds
    s_add_u32 s37, s37, 128
    s_and_b32 s37, s37, 2047
    s_add_u32 s85, s85, 32768
    s_waitcnt vmcnt(7)
    v_lshlrev_b32 v114, 16, v226
    v_and_b32 v115, 0xffff0000, v226
    v_lshlrev_b32 v116, 16, v227
    v_and_b32 v117, 0xffff0000, v227
    v_mov_b32 v118, v114
    v_mov_b32 v119, v115
    v_mov_b32 v120, v116
    v_mov_b32 v121, v117
    v_mov_b32 v122, v114
    v_mov_b32 v123, v115
    v_mov_b32 v124, v116
    v_mov_b32 v125, v117
    v_mov_b32 v126, v114
    v_mov_b32 v127, v115
    v_mov_b32 v128, v116
    v_mov_b32 v129, v117
    v_lshlrev_b32 v130, 16, v228
    v_and_b32 v131, 0xffff0000, v228
    v_lshlrev_b32 v132, 16, v229
    v_and_b32 v133, 0xffff0000, v229
    v_mov_b32 v134, v130
    v_mov_b32 v135, v131
    v_mov_b32 v136, v132
    v_mov_b32 v137, v133
    v_mov_b32 v138, v130
    v_mov_b32 v139, v131
    v_mov_b32 v140, v132
    v_mov_b32 v141, v133
    v_mov_b32 v142, v130
    v_mov_b32 v143, v131
    v_mov_b32 v144, v132
    v_mov_b32 v145, v133
    v_lshlrev_b32 v146, 16, v230
    v_and_b32 v147, 0xffff0000, v230
    v_lshlrev_b32 v148, 16, v231
    v_and_b32 v149, 0xffff0000, v231
    v_mov_b32 v150, v146
    v_mov_b32 v151, v147
    v_mov_b32 v152, v148
    v_mov_b32 v153, v149
    v_mov_b32 v154, v146
    v_mov_b32 v155, v147
    v_mov_b32 v156, v148
    v_mov_b32 v157, v149
    v_mov_b32 v158, v146
    v_mov_b32 v159, v147
    v_mov_b32 v160, v148
    v_mov_b32 v161, v149
    v_lshlrev_b32 v162, 16, v232
    v_and_b32 v163, 0xffff0000, v232
    v_lshlrev_b32 v164, 16, v233
    v_and_b32 v165, 0xffff0000, v233
    v_mov_b32 v166, v162
    v_mov_b32 v167, v163
    v_mov_b32 v168, v164
    v_mov_b32 v169, v165
    v_mov_b32 v170, v162
    v_mov_b32 v171, v163
    v_mov_b32 v172, v164
    v_mov_b32 v173, v165
    v_mov_b32 v174, v162
    v_mov_b32 v175, v163
    v_mov_b32 v176, v164
    v_mov_b32 v177, v165
    v_lshlrev_b32 v178, 16, v234
    v_and_b32 v179, 0xffff0000, v234
    v_lshlrev_b32 v180, 16, v235
    v_and_b32 v181, 0xffff0000, v235
    v_mov_b32 v182, v178
    v_mov_b32 v183, v179
    v_mov_b32 v184, v180
    v_mov_b32 v185, v181
    v_mov_b32 v186, v178
    v_mov_b32 v187, v179
    v_mov_b32 v188, v180
    v_mov_b32 v189, v181
    v_mov_b32 v190, v178
    v_mov_b32 v191, v179
    v_mov_b32 v192, v180
    v_mov_b32 v193, v181
    v_lshlrev_b32 v194, 16, v236
    v_and_b32 v195, 0xffff0000, v236
    v_lshlrev_b32 v196, 16, v237
    v_and_b32 v197, 0xffff0000, v237
    v_mov_b32 v198, v194
    v_mov_b32 v199, v195
    v_mov_b32 v200, v196
    v_mov_b32 v201, v197
    v_mov_b32 v202, v194
    v_mov_b32 v203, v195
    v_mov_b32 v204, v196
    v_mov_b32 v205, v197
    v_mov_b32 v206, v194
    v_mov_b32 v207, v195
    v_mov_b32 v208, v196
    v_mov_b32 v209, v197
    v_lshlrev_b32 v210, 16, v238
    v_and_b32 v211, 0xffff0000, v238
    v_lshlrev_b32 v212, 16, v239
    v_and_b32 v213, 0xffff0000, v239
    v_mov_b32 v214, v210
    v_mov_b32 v215, v211
    v_mov_b32 v216, v212
    v_mov_b32 v217, v213
    v_mov_b32 v218, v210
    v_mov_b32 v219, v211
    v_mov_b32 v220, v212
    v_mov_b32 v221, v213
    v_mov_b32 v222, v210
    v_mov_b32 v223, v211
    v_mov_b32 v224, v212
    v_mov_b32 v225, v213
    s_waitcnt vmcnt(14)
    s_barrier
    v_mov_b32 v16, v14
    v_mov_b32 v17, v15
    v_mov_b32 v23, v22
    v_xor_b32 v24, 64, v22
    s_mov_b32 s33, 0
    s_mov_b32 s32, 28672
    s_mov_b32 s86, 0
    s_mov_b32 s85, 65536
    ds_read_b64_tr_b16 v[26:27], v16 offset:0
    ds_read_b128 v[54:57], v23 offset:0
    ds_read_b64_tr_b16 v[28:29], v16 offset:1792
    ds_read_b64_tr_b16 v[30:31], v17 offset:32
    ds_read_b64_tr_b16 v[32:33], v17 offset:1824
    ds_read_b128 v[58:61], v23 offset:2048
    ds_read_b64_tr_b16 v[34:35], v16 offset:64
    ds_read_b64_tr_b16 v[36:37], v16 offset:1856
    ds_read_b64_tr_b16 v[38:39], v17 offset:96
    ds_read_b64_tr_b16 v[40:41], v17 offset:1888
    ds_read_b128 v[62:65], v23 offset:4096
    ds_read_b64_tr_b16 v[42:43], v16 offset:128
    ds_read_b64_tr_b16 v[44:45], v16 offset:1920
    ds_read_b64_tr_b16 v[46:47], v17 offset:160
    ds_read_b128 v[66:69], v23 offset:6144
    ds_read_b64_tr_b16 v[48:49], v17 offset:1952
    ds_read_b64_tr_b16 v[50:51], v16 offset:192
    ds_read_b64_tr_b16 v[52:53], v16 offset:1984
    s_mov_b32 s34, 4
L_gl4:
    s_mov_b32 s31, s85
    s_mov_b32 s32, s33
    s_add_u32 s33, s33, 28672
    s_cmp_eq_u32 s33, 57344
    s_cselect_b32 s33, 0, s33
    s_mov_b32 s85, s86
    s_add_u32 s86, s86, 32768
    s_cmp_eq_u32 s86, 98304
    s_cselect_b32 s86, 0, s86
    s_waitcnt lgkmcnt(0)
    v_mfma_f32_16x16x32_bf16 v[114:117], v[26:29], v[54:57], v[114:117]
    ds_read_b64_tr_b16 v[70:71], v16 offset:14336
    v_mfma_f32_16x16x32_bf16 v[118:121], v[26:29], v[58:61], v[118:121]
    s_add_u32 s35, s31, s39
    s_mov_b32 m0, s35
    s_nop 0
    buffer_load_dwordx4 v18, s[4:7], s37 offen lds
    v_mfma_f32_16x16x32_bf16 v[122:125], v[26:29], v[62:65], v[122:125]
    ds_read_b128 v[98:101], v24 offset:0
    v_mfma_f32_16x16x32_bf16 v[126:129], v[26:29], v[66:69], v[126:129]
    ds_read_b64_tr_b16 v[72:73], v16 offset:16128
    v_mfma_f32_16x16x32_bf16 v[130:133], v[30:33], v[54:57], v[130:133]
    ds_read_b64_tr_b16 v[74:75], v17 offset:14368
    v_mfma_f32_16x16x32_bf16 v[134:137], v[30:33], v[58:61], v[134:137]
    buffer_load_dwordx4 v19, s[4:7], s37 offen offset:1024 lds
    v_mfma_f32_16x16x32_bf16 v[138:141], v[30:33], v[62:65], v[138:141]
    v_mfma_f32_16x16x32_bf16 v[142:145], v[30:33], v[66:69], v[142:145]
    ds_read_b64_tr_b16 v[76:77], v17 offset:16160
    v_mfma_f32_16x16x32_bf16 v[146:149], v[34:37], v[54:57], v[146:149]
    ds_read_b128 v[102:105], v24 offset:2048
    v_mfma_f32_16x16x32_bf16 v[150:153], v[34:37], v[58:61], v[150:153]
    ds_read_b64_tr_b16 v[78:79], v16 offset:14400
    v_mfma_f32_16x16x32_bf16 v[154:157], v[34:37], v[62:65], v[154:157]
    ds_read_b64_tr_b16 v[80:81], v16 offset:16192
    v_mfma_f32_16x16x32_bf16 v[158:161], v[34:37], v[66:69], v[158:161]
    buffer_load_dwordx4 v20, s[4:7], s37 offen offset:2048 lds
    v_mfma_f32_16x16x32_bf16 v[162:165], v[38:41], v[54:57], v[162:165]
    ds_read_b64_tr_b16 v[82:83], v17 offset:14432
    v_mfma_f32_16x16x32_bf16 v[166:169], v[38:41], v[58:61], v[166:169]
    v_mfma_f32_16x16x32_bf16 v[170:173], v[38:41], v[62:65], v[170:173]
    ds_read_b64_tr_b16 v[84:85], v17 offset:16224
    v_mfma_f32_16x16x32_bf16 v[174:177], v[38:41], v[66:69], v[174:177]
    ds_read_b128 v[106:109], v24 offset:4096
    v_mfma_f32_16x16x32_bf16 v[178:181], v[42:45], v[54:57], v[178:181]
    ds_read_b64_tr_b16 v[86:87], v16 offset:14464
    v_mfma_f32_16x16x32_bf16 v[182:185], v[42:45], v[58:61], v[182:185]
    buffer_load_dwordx4 v21, s[4:7], s37 offen offset:3072 lds
    v_mfma_f32_16x16x32_bf16 v[186:189], v[42:45], v[62:65], v[186:189]
    ds_read_b64_tr_b16 v[88:89], v16 offset:16256
    v_mfma_f32_16x16x32_bf16 v[190:193], v[42:45], v[66:69], v[190:193]
    ds_read_b64_tr_b16 v[90:91], v17 offset:14496
    v_mfma_f32_16x16x32_bf16 v[194:197], v[46:49], v[54:57], v[194:197]
    v_mfma_f32_16x16x32_bf16 v[198:201], v[46:49], v[58:61], v[198:201]
    ds_read_b128 v[110:113], v24 offset:6144
    v_mfma_f32_16x16x32_bf16 v[202:205], v[46:49], v[62:65], v[202:205]
    ds_read_b64_tr_b16 v[92:93], v17 offset:16288
    v_mfma_f32_16x16x32_bf16 v[206:209], v[46:49], v[66:69], v[206:209]
    s_add_u32 s37, s37, 128
    s_and_b32 s37, s37, 2047
    v_mfma_f32_16x16x32_bf16 v[210:213], v[50:53], v[54:57], v[210:213]
    ds_read_b64_tr_b16 v[94:95], v16 offset:14528
    v_mfma_f32_16x16x32_bf16 v[214:217], v[50:53], v[58:61], v[214:217]
    ds_read_b64_tr_b16 v[96:97], v16 offset:16320
    v_mfma_f32_16x16x32_bf16 v[218:221], v[50:53], v[62:65], v[218:221]
    v_add_u32 v16, s33, v14
    v_add_u32 v17, s33, v15
    v_add_u32 v23, s86, v22
    v_mfma_f32_16x16x32_bf16 v[222:225], v[50:53], v[66:69], v[222:225]
    s_waitcnt vmcnt(4) lgkmcnt(0)
    s_barrier
    s_setprio 1
    v_mfma_f32_16x16x32_bf16 v[114:117], v[70:73], v[98:101], v[114:117]
    ds_read_b64_tr_b16 v[26:27], v16 offset:0
    v_mfma_f32_16x16x32_bf16 v[118:121], v[70:73], v[102:105], v[118:121]
    s_add_u32 s35, s32, s38
    s_mov_b32 m0, s35
    s_nop 0
    buffer_load_dwordx4 v10, s[8:11], s36 offen lds
    v_mfma_f32_16x16x32_bf16 v[122:125], v[70:73], v[106:109], v[122:125]
    ds_read_b128 v[54:57], v23 offset:0
    v_mfma_f32_16x16x32_bf16 v[126:129], v[70:73], v[110:113], v[126:129]
    ds_read_b64_tr_b16 v[28:29], v16 offset:1792
    v_mfma_f32_16x16x32_bf16 v[130:133], v[74:77], v[98:101], v[130:133]
    ds_read_b64_tr_b16 v[30:31], v17 offset:32
    v_mfma_f32_16x16x32_bf16 v[134:137], v[74:77], v[102:105], v[134:137]
    buffer_load_dwordx4 v11, s[8:11], s36 offen offset:1024 lds
    v_mfma_f32_16x16x32_bf16 v[138:141], v[74:77], v[106:109], v[138:141]
    v_mfma_f32_16x16x32_bf16 v[142:145], v[74:77], v[110:113], v[142:145]
    ds_read_b64_tr_b16 v[32:33], v17 offset:1824
    v_mfma_f32_16x16x32_bf16 v[146:149], v[78:81], v[98:101], v[146:149]
    ds_read_b128 v[58:61], v23 offset:2048
    v_mfma_f32_16x16x32_bf16 v[150:153], v[78:81], v[102:105], v[150:153]
    ds_read_b64_tr_b16 v[34:35], v16 offset:64
    v_mfma_f32_16x16x32_bf16 v[154:157], v[78:81], v[106:109], v[154:157]
    ds_read_b64_tr_b16 v[36:37], v16 offset:1856
    v_mfma_f32_16x16x32_bf16 v[158:161], v[78:81], v[110:113], v[158:161]
    buffer_load_dwordx4 v12, s[8:11], s36 offen offset:2048 lds
    v_mfma_f32_16x16x32_bf16 v[162:165], v[82:85], v[98:101], v[162:165]
    ds_read_b64_tr_b16 v[38:39], v17 offset:96
    v_mfma_f32_16x16x32_bf16 v[166:169], v[82:85], v[102:105], v[166:169]
    v_mfma_f32_16x16x32_bf16 v[170:173], v[82:85], v[106:109], v[170:173]
    ds_read_b64_tr_b16 v[40:41], v17 offset:1888
    v_mfma_f32_16x16x32_bf16 v[174:177], v[82:85], v[110:113], v[174:177]
    ds_read_b128 v[62:65], v23 offset:4096
    v_mfma_f32_16x16x32_bf16 v[178:181], v[86:89], v[98:101], v[178:181]
    s_cmp_lt_u32 s28, 4
    s_cbranch_scc0 L_ncs5
    buffer_load_dwordx4 v13, s[8:11], s36 offen offset:3072 lds
L_ncs5:
    v_mfma_f32_16x16x32_bf16 v[182:185], v[86:89], v[102:105], v[182:185]
    ds_read_b64_tr_b16 v[42:43], v16 offset:128
    v_mfma_f32_16x16x32_bf16 v[186:189], v[86:89], v[106:109], v[186:189]
    ds_read_b64_tr_b16 v[44:45], v16 offset:1920
    v_mfma_f32_16x16x32_bf16 v[190:193], v[86:89], v[110:113], v[190:193]
    ds_read_b64_tr_b16 v[46:47], v17 offset:160
    v_mfma_f32_16x16x32_bf16 v[194:197], v[90:93], v[98:101], v[194:197]
    v_mfma_f32_16x16x32_bf16 v[198:201], v[90:93], v[102:105], v[198:201]
    ds_read_b128 v[66:69], v23 offset:6144
    v_mfma_f32_16x16x32_bf16 v[202:205], v[90:93], v[106:109], v[202:205]
    s_add_u32 s36, s36, 458752
    s_cmp_eq_u32 s36, 7340032
    s_cselect_b32 s36, 0, s36
    v_mfma_f32_16x16x32_bf16 v[206:209], v[90:93], v[110:113], v[206:209]
    ds_read_b64_tr_b16 v[48:49], v17 offset:1952
    v_mfma_f32_16x16x32_bf16 v[210:213], v[94:97], v[98:101], v[210:213]
    ds_read_b64_tr_b16 v[50:51], v16 offset:192
    v_mfma_f32_16x16x32_bf16 v[214:217], v[94:97], v[102:105], v[214:217]
    ds_read_b64_tr_b16 v[52:53], v16 offset:1984
    v_mfma_f32_16x16x32_bf16 v[218:221], v[94:97], v[106:109], v[218:221]
    v_xor_b32 v24, 64, v23
    v_mfma_f32_16x16x32_bf16 v[222:225], v[94:97], v[110:113], v[222:225]
    s_setprio 0
    s_sub_u32 s34, s34, 1
    s_cmp_lg_u32 s34, 0
    s_cbranch_scc1 L_gl4
    s_mov_b32 s31, s85
    s_mov_b32 s32, s33
    s_add_u32 s33, s33, 28672
    s_cmp_eq_u32 s33, 57344
    s_cselect_b32 s33, 0, s33
    s_mov_b32 s85, s86
    s_add_u32 s86, s86, 32768
    s_cmp_eq_u32 s86, 98304
    s_cselect_b32 s86, 0, s86
    s_waitcnt lgkmcnt(0)
    v_mfma_f32_16x16x32_bf16 v[114:117], v[26:29], v[54:57], v[114:117]
    ds_read_b64_tr_b16 v[70:71], v16 offset:14336
    v_mfma_f32_16x16x32_bf16 v[118:121], v[26:29], v[58:61], v[118:121]
    s_add_u32 s35, s31, s39
    s_mov_b32 m0, s35
    s_nop 0
    buffer_load_dwordx4 v18, s[4:7], s37 offen lds
    v_mfma_f32_16x16x32_bf16 v[122:125], v[26:29], v[62:65], v[122:125]
    ds_read_b128 v[98:101], v24 offset:0
    v_mfma_f32_16x16x32_bf16 v[126:129], v[26:29], v[66:69], v[126:129]
    ds_read_b64_tr_b16 v[72:73], v16 offset:16128
    v_mfma_f32_16x16x32_bf16 v[130:133], v[30:33], v[54:57], v[130:133]
    ds_read_b64_tr_b16 v[74:75], v17 offset:14368
    v_mfma_f32_16x16x32_bf16 v[134:137], v[30:33], v[58:61], v[134:137]
    buffer_load_dwordx4 v19, s[4:7], s37 offen offset:1024 lds
    v_mfma_f32_16x16x32_bf16 v[138:141], v[30:33], v[62:65], v[138:141]
    v_mfma_f32_16x16x32_bf16 v[142:145], v[30:33], v[66:69], v[142:145]
    ds_read_b64_tr_b16 v[76:77], v17 offset:16160
    v_mfma_f32_16x16x32_bf16 v[146:149], v[34:37], v[54:57], v[146:149]
    ds_read_b128 v[102:105], v24 offset:2048
    v_mfma_f32_16x16x32_bf16 v[150:153], v[34:37], v[58:61], v[150:153]
    ds_read_b64_tr_b16 v[78:79], v16 offset:14400
    v_mfma_f32_16x16x32_bf16 v[154:157], v[34:37], v[62:65], v[154:157]
    ds_read_b64_tr_b16 v[80:81], v16 offset:16192
    v_mfma_f32_16x16x32_bf16 v[158:161], v[34:37], v[66:69], v[158:161]
    buffer_load_dwordx4 v20, s[4:7], s37 offen offset:2048 lds
    v_mfma_f32_16x16x32_bf16 v[162:165], v[38:41], v[54:57], v[162:165]
    ds_read_b64_tr_b16 v[82:83], v17 offset:14432
    v_mfma_f32_16x16x32_bf16 v[166:169], v[38:41], v[58:61], v[166:169]
    v_mfma_f32_16x16x32_bf16 v[170:173], v[38:41], v[62:65], v[170:173]
    ds_read_b64_tr_b16 v[84:85], v17 offset:16224
    v_mfma_f32_16x16x32_bf16 v[174:177], v[38:41], v[66:69], v[174:177]
    ds_read_b128 v[106:109], v24 offset:4096
    v_mfma_f32_16x16x32_bf16 v[178:181], v[42:45], v[54:57], v[178:181]
    ds_read_b64_tr_b16 v[86:87], v16 offset:14464
    v_mfma_f32_16x16x32_bf16 v[182:185], v[42:45], v[58:61], v[182:185]
    buffer_load_dwordx4 v21, s[4:7], s37 offen offset:3072 lds
    v_mfma_f32_16x16x32_bf16 v[186:189], v[42:45], v[62:65], v[186:189]
    ds_read_b64_tr_b16 v[88:89], v16 offset:16256
    v_mfma_f32_16x16x32_bf16 v[190:193], v[42:45], v[66:69], v[190:193]
    ds_read_b64_tr_b16 v[90:91], v17 offset:14496
    v_mfma_f32_16x16x32_bf16 v[194:197], v[46:49], v[54:57], v[194:197]
    v_mfma_f32_16x16x32_bf16 v[198:201], v[46:49], v[58:61], v[198:201]
    ds_read_b128 v[110:113], v24 offset:6144
    v_mfma_f32_16x16x32_bf16 v[202:205], v[46:49], v[62:65], v[202:205]
    ds_read_b64_tr_b16 v[92:93], v17 offset:16288
    v_mfma_f32_16x16x32_bf16 v[206:209], v[46:49], v[66:69], v[206:209]
    s_add_u32 s37, s37, 128
    s_and_b32 s37, s37, 2047
    v_mfma_f32_16x16x32_bf16 v[210:213], v[50:53], v[54:57], v[210:213]
    ds_read_b64_tr_b16 v[94:95], v16 offset:14528
    v_mfma_f32_16x16x32_bf16 v[214:217], v[50:53], v[58:61], v[214:217]
    ds_read_b64_tr_b16 v[96:97], v16 offset:16320
    v_mfma_f32_16x16x32_bf16 v[218:221], v[50:53], v[62:65], v[218:221]
    v_add_u32 v16, s33, v14
    v_add_u32 v17, s33, v15
    v_add_u32 v23, s86, v22
    v_mfma_f32_16x16x32_bf16 v[222:225], v[50:53], v[66:69], v[222:225]
    s_waitcnt vmcnt(4) lgkmcnt(0)
    s_barrier
    s_setprio 1
    v_mfma_f32_16x16x32_bf16 v[114:117], v[70:73], v[98:101], v[114:117]
    ds_read_b64_tr_b16 v[26:27], v16 offset:0
    v_mfma_f32_16x16x32_bf16 v[118:121], v[70:73], v[102:105], v[118:121]
    s_add_u32 s35, s32, s38
    s_mov_b32 m0, s35
    s_nop 0
    buffer_load_dwordx4 v10, s[8:11], s36 offen lds
    v_mfma_f32_16x16x32_bf16 v[122:125], v[70:73], v[106:109], v[122:125]
    ds_read_b128 v[54:57], v23 offset:0
    v_mfma_f32_16x16x32_bf16 v[126:129], v[70:73], v[110:113], v[126:129]
    ds_read_b64_tr_b16 v[28:29], v16 offset:1792
    v_mfma_f32_16x16x32_bf16 v[130:133], v[74:77], v[98:101], v[130:133]
    ds_read_b64_tr_b16 v[30:31], v17 offset:32
    v_mfma_f32_16x16x32_bf16 v[134:137], v[74:77], v[102:105], v[134:137]
    buffer_load_dwordx4 v11, s[8:11], s36 offen offset:1024 lds
    v_mfma_f32_16x16x32_bf16 v[138:141], v[74:77], v[106:109], v[138:141]
    ds_read_b64_tr_b16 v[32:33], v17 offset:1824
    v_mfma_f32_16x16x32_bf16 v[142:145], v[74:77], v[110:113], v[142:145]
    ds_read_b128 v[58:61], v23 offset:2048
    v_mfma_f32_16x16x32_bf16 v[146:149], v[78:81], v[98:101], v[146:149]
    ds_read_b64_tr_b16 v[34:35], v16 offset:64
    v_mfma_f32_16x16x32_bf16 v[150:153], v[78:81], v[102:105], v[150:153]
    v_mfma_f32_16x16x32_bf16 v[154:157], v[78:81], v[106:109], v[154:157]
    ds_read_b64_tr_b16 v[36:37], v16 offset:1856
    v_mfma_f32_16x16x32_bf16 v[158:161], v[78:81], v[110:113], v[158:161]
    buffer_load_dwordx4 v12, s[8:11], s36 offen offset:2048 lds
    v_mfma_f32_16x16x32_bf16 v[162:165], v[82:85], v[98:101], v[162:165]
    ds_read_b64_tr_b16 v[38:39], v17 offset:96
    v_mfma_f32_16x16x32_bf16 v[166:169], v[82:85], v[102:105], v[166:169]
    ds_read_b64_tr_b16 v[40:41], v17 offset:1888
    v_mfma_f32_16x16x32_bf16 v[170:173], v[82:85], v[106:109], v[170:173]
    ds_read_b128 v[62:65], v23 offset:4096
    v_mfma_f32_16x16x32_bf16 v[174:177], v[82:85], v[110:113], v[174:177]
    s_cmp_lt_u32 s28, 4
    s_cbranch_scc0 L_ncs6
    buffer_load_dwordx4 v13, s[8:11], s36 offen offset:3072 lds
L_ncs6:
    v_mfma_f32_16x16x32_bf16 v[178:181], v[86:89], v[98:101], v[178:181]
    ds_read_b64_tr_b16 v[42:43], v16 offset:128
    v_mfma_f32_16x16x32_bf16 v[182:185], v[86:89], v[102:105], v[182:185]
    ds_read_b64_tr_b16 v[44:45], v16 offset:1920
    v_mfma_f32_16x16x32_bf16 v[186:189], v[86:89], v[106:109], v[186:189]
    v_mfma_f32_16x16x32_bf16 v[190:193], v[86:89], v[110:113], v[190:193]
    ds_read_b64_tr_b16 v[46:47], v17 offset:160
    v_mfma_f32_16x16x32_bf16 v[194:197], v[90:93], v[98:101], v[194:197]
    ds_read_b128 v[66:69], v23 offset:6144
    v_mfma_f32_16x16x32_bf16 v[198:201], v[90:93], v[102:105], v[198:201]
    s_add_u32 s36, s36, 458752
    s_cmp_eq_u32 s36, 7340032
    s_cselect_b32 s36, 0, s36
    v_mfma_f32_16x16x32_bf16 v[202:205], v[90:93], v[106:109], v[202:205]
    ds_read_b64_tr_b16 v[48:49], v17 offset:1952
    v_mfma_f32_16x16x32_bf16 v[206:209], v[90:93], v[110:113], v[206:209]
    ds_read_b64_tr_b16 v[50:51], v16 offset:192
    v_mfma_f32_16x16x32_bf16 v[210:213], v[94:97], v[98:101], v[210:213]
    ds_read_b64_tr_b16 v[52:53], v16 offset:1984
    v_mfma_f32_16x16x32_bf16 v[214:217], v[94:97], v[102:105], v[214:217]
    v_xor_b32 v24, 64, v23
    v_mfma_f32_16x16x32_bf16 v[218:221], v[94:97], v[106:109], v[218:221]
    s_cmp_lg_u32 s28, 0
    s_cbranch_scc1 L_mz3
    v_mov_b32 v6, 0
    v_lshlrev_b32 v8, 2, v0
    s_lshl_b32 s88, s2, 8
    s_add_u32 s88, s88, 25362432
    buffer_store_dword v6, v8, s[16:19], s88 offen sc1
L_mz3:
    v_mfma_f32_16x16x32_bf16 v[222:225], v[94:97], v[110:113], v[222:225]
    s_setprio 0
    s_mov_b32 s34, 2
L_gl7:
    s_mov_b32 s31, s85
    s_mov_b32 s32, s33
    s_add_u32 s33, s33, 28672
    s_cmp_eq_u32 s33, 57344
    s_cselect_b32 s33, 0, s33
    s_mov_b32 s85, s86
    s_add_u32 s86, s86, 32768
    s_cmp_eq_u32 s86, 98304
    s_cselect_b32 s86, 0, s86
    s_waitcnt lgkmcnt(0)
    v_mfma_f32_16x16x32_bf16 v[114:117], v[26:29], v[54:57], v[114:117]
    ds_read_b64_tr_b16 v[70:71], v16 offset:14336
    v_mfma_f32_16x16x32_bf16 v[118:121], v[26:29], v[58:61], v[118:121]
    s_add_u32 s35, s31, s39
    s_mov_b32 m0, s35
    s_nop 0
    buffer_load_dwordx4 v18, s[4:7], s37 offen lds
    v_mfma_f32_16x16x32_bf16 v[122:125], v[26:29], v[62:65], v[122:125]
    ds_read_b128 v[98:101], v24 offset:0
    v_mfma_f32_16x16x32_bf16 v[126:129], v[26:29], v[66:69], v[126:129]
    ds_read_b64_tr_b16 v[72:73], v16 offset:16128
    v_mfma_f32_16x16x32_bf16 v[130:133], v[30:33], v[54:57], v[130:133]
    ds_read_b64_tr_b16 v[74:75], v17 offset:14368
    v_mfma_f32_16x16x32_bf16 v[134:137], v[30:33], v[58:61], v[134:137]
    buffer_load_dwordx4 v19, s[4:7], s37 offen offset:1024 lds
    v_mfma_f32_16x16x32_bf16 v[138:141], v[30:33], v[62:65], v[138:141]
    v_mfma_f32_16x16x32_bf16 v[142:145], v[30:33], v[66:69], v[142:145]
    ds_read_b64_tr_b16 v[76:77], v17 offset:16160
    v_mfma_f32_16x16x32_bf16 v[146:149], v[34:37], v[54:57], v[146:149]
    ds_read_b128 v[102:105], v24 offset:2048
    v_mfma_f32_16x16x32_bf16 v[150:153], v[34:37], v[58:61], v[150:153]
    ds_read_b64_tr_b16 v[78:79], v16 offset:14400
    v_mfma_f32_16x16x32_bf16 v[154:157], v[34:37], v[62:65], v[154:157]
    ds_read_b64_tr_b16 v[80:81], v16 offset:16192
    v_mfma_f32_16x16x32_bf16 v[158:161], v[34:37], v[66:69], v[158:161]
    buffer_load_dwordx4 v20, s[4:7], s37 offen offset:2048 lds
    v_mfma_f32_16x16x32_bf16 v[162:165], v[38:41], v[54:57], v[162:165]
    ds_read_b64_tr_b16 v[82:83], v17 offset:14432
    v_mfma_f32_16x16x32_bf16 v[166:169], v[38:41], v[58:61], v[166:169]
    v_mfma_f32_16x16x32_bf16 v[170:173], v[38:41], v[62:65], v[170:173]
    ds_read_b64_tr_b16 v[84:85], v17 offset:16224
    v_mfma_f32_16x16x32_bf16 v[174:177], v[38:41], v[66:69], v[174:177]
    ds_read_b128 v[106:109], v24 offset:4096
    v_mfma_f32_16x16x32_bf16 v[178:181], v[42:45], v[54:57], v[178:181]
    ds_read_b64_tr_b16 v[86:87], v16 offset:14464
    v_mfma_f32_16x16x32_bf16 v[182:185], v[42:45], v[58:61], v[182:185]
    buffer_load_dwordx4 v21, s[4:7], s37 offen offset:3072 lds
    v_mfma_f32_16x16x32_bf16 v[186:189], v[42:45], v[62:65], v[186:189]
    ds_read_b64_tr_b16 v[88:89], v16 offset:16256
    v_mfma_f32_16x16x32_bf16 v[190:193], v[42:45], v[66:69], v[190:193]
    ds_read_b64_tr_b16 v[90:91], v17 offset:14496
    v_mfma_f32_16x16x32_bf16 v[194:197], v[46:49], v[54:57], v[194:197]
    v_mfma_f32_16x16x32_bf16 v[198:201], v[46:49], v[58:61], v[198:201]
    ds_read_b128 v[110:113], v24 offset:6144
    v_mfma_f32_16x16x32_bf16 v[202:205], v[46:49], v[62:65], v[202:205]
    ds_read_b64_tr_b16 v[92:93], v17 offset:16288
    v_mfma_f32_16x16x32_bf16 v[206:209], v[46:49], v[66:69], v[206:209]
    s_add_u32 s37, s37, 128
    s_and_b32 s37, s37, 2047
    v_mfma_f32_16x16x32_bf16 v[210:213], v[50:53], v[54:57], v[210:213]
    ds_read_b64_tr_b16 v[94:95], v16 offset:14528
    v_mfma_f32_16x16x32_bf16 v[214:217], v[50:53], v[58:61], v[214:217]
    ds_read_b64_tr_b16 v[96:97], v16 offset:16320
    v_mfma_f32_16x16x32_bf16 v[218:221], v[50:53], v[62:65], v[218:221]
    v_add_u32 v16, s33, v14
    v_add_u32 v17, s33, v15
    v_add_u32 v23, s86, v22
    v_mfma_f32_16x16x32_bf16 v[222:225], v[50:53], v[66:69], v[222:225]
    s_waitcnt vmcnt(4) lgkmcnt(0)
    s_barrier
    s_setprio 1
    v_mfma_f32_16x16x32_bf16 v[114:117], v[70:73], v[98:101], v[114:117]
    ds_read_b64_tr_b16 v[26:27], v16 offset:0
    v_mfma_f32_16x16x32_bf16 v[118:121], v[70:73], v[102:105], v[118:121]
    s_add_u32 s35, s32, s38
    s_mov_b32 m0, s35
    s_nop 0
    buffer_load_dwordx4 v10, s[8:11], s36 offen lds
    v_mfma_f32_16x16x32_bf16 v[122:125], v[70:73], v[106:109], v[122:125]
    ds_read_b128 v[54:57], v23 offset:0
    v_mfma_f32_16x16x32_bf16 v[126:129], v[70:73], v[110:113], v[126:129]
    ds_read_b64_tr_b16 v[28:29], v16 offset:1792
    v_mfma_f32_16x16x32_bf16 v[130:133], v[74:77], v[98:101], v[130:133]
    ds_read_b64_tr_b16 v[30:31], v17 offset:32
    v_mfma_f32_16x16x32_bf16 v[134:137], v[74:77], v[102:105], v[134:137]
    buffer_load_dwordx4 v11, s[8:11], s36 offen offset:1024 lds
    v_mfma_f32_16x16x32_bf16 v[138:141], v[74:77], v[106:109], v[138:141]
    v_mfma_f32_16x16x32_bf16 v[142:145], v[74:77], v[110:113], v[142:145]
    ds_read_b64_tr_b16 v[32:33], v17 offset:1824
    v_mfma_f32_16x16x32_bf16 v[146:149], v[78:81], v[98:101], v[146:149]
    ds_read_b128 v[58:61], v23 offset:2048
    v_mfma_f32_16x16x32_bf16 v[150:153], v[78:81], v[102:105], v[150:153]
    ds_read_b64_tr_b16 v[34:35], v16 offset:64
    v_mfma_f32_16x16x32_bf16 v[154:157], v[78:81], v[106:109], v[154:157]
    ds_read_b64_tr_b16 v[36:37], v16 offset:1856
    v_mfma_f32_16x16x32_bf16 v[158:161], v[78:81], v[110:113], v[158:161]
    buffer_load_dwordx4 v12, s[8:11], s36 offen offset:2048 lds
    v_mfma_f32_16x16x32_bf16 v[162:165], v[82:85], v[98:101], v[162:165]
    ds_read_b64_tr_b16 v[38:39], v17 offset:96
    v_mfma_f32_16x16x32_bf16 v[166:169], v[82:85], v[102:105], v[166:169]
    v_mfma_f32_16x16x32_bf16 v[170:173], v[82:85], v[106:109], v[170:173]
    ds_read_b64_tr_b16 v[40:41], v17 offset:1888
    v_mfma_f32_16x16x32_bf16 v[174:177], v[82:85], v[110:113], v[174:177]
    ds_read_b128 v[62:65], v23 offset:4096
    v_mfma_f32_16x16x32_bf16 v[178:181], v[86:89], v[98:101], v[178:181]
    s_cmp_lt_u32 s28, 4
    s_cbranch_scc0 L_ncs8
    buffer_load_dwordx4 v13, s[8:11], s36 offen offset:3072 lds
L_ncs8:
    v_mfma_f32_16x16x32_bf16 v[182:185], v[86:89], v[102:105], v[182:185]
    ds_read_b64_tr_b16 v[42:43], v16 offset:128
    v_mfma_f32_16x16x32_bf16 v[186:189], v[86:89], v[106:109], v[186:189]
    ds_read_b64_tr_b16 v[44:45], v16 offset:1920
    v_mfma_f32_16x16x32_bf16 v[190:193], v[86:89], v[110:113], v[190:193]
    ds_read_b64_tr_b16 v[46:47], v17 offset:160
    v_mfma_f32_16x16x32_bf16 v[194:197], v[90:93], v[98:101], v[194:197]
    v_mfma_f32_16x16x32_bf16 v[198:201], v[90:93], v[102:105], v[198:201]
    ds_read_b128 v[66:69], v23 offset:6144
    v_mfma_f32_16x16x32_bf16 v[202:205], v[90:93], v[106:109], v[202:205]
    s_add_u32 s36, s36, 458752
    s_cmp_eq_u32 s36, 7340032
    s_cselect_b32 s36, 0, s36
    v_mfma_f32_16x16x32_bf16 v[206:209], v[90:93], v[110:113], v[206:209]
    ds_read_b64_tr_b16 v[48:49], v17 offset:1952
    v_mfma_f32_16x16x32_bf16 v[210:213], v[94:97], v[98:101], v[210:213]
    ds_read_b64_tr_b16 v[50:51], v16 offset:192
    v_mfma_f32_16x16x32_bf16 v[214:217], v[94:97], v[102:105], v[214:217]
    ds_read_b64_tr_b16 v[52:53], v16 offset:1984
    v_mfma_f32_16x16x32_bf16 v[218:221], v[94:97], v[106:109], v[218:221]
    v_xor_b32 v24, 64, v23
    v_mfma_f32_16x16x32_bf16 v[222:225], v[94:97], v[110:113], v[222:225]
    s_setprio 0
    s_sub_u32 s34, s34, 1
    s_cmp_lg_u32 s34, 0
    s_cbranch_scc1 L_gl7
    s_mov_b32 s31, s85
    s_mov_b32 s32, s33
    s_add_u32 s33, s33, 28672
    s_cmp_eq_u32 s33, 57344
    s_cselect_b32 s33, 0, s33
    s_mov_b32 s85, s86
    s_add_u32 s86, s86, 32768
    s_cmp_eq_u32 s86, 98304
    s_cselect_b32 s86, 0, s86
    s_waitcnt lgkmcnt(0)
    v_mfma_f32_16x16x32_bf16 v[114:117], v[26:29], v[54:57], v[114:117]
    ds_read_b64_tr_b16 v[70:71], v16 offset:14336
    v_mfma_f32_16x16x32_bf16 v[118:121], v[26:29], v[58:61], v[118:121]
    s_add_u32 s35, s31, s39
    s_mov_b32 m0, s35
    s_nop 0
    buffer_load_dwordx4 v18, s[4:7], s37 offen lds
    v_mfma_f32_16x16x32_bf16 v[122:125], v[26:29], v[62:65], v[122:125]
    ds_read_b128 v[98:101], v24 offset:0
    v_mfma_f32_16x16x32_bf16 v[126:129], v[26:29], v[66:69], v[126:129]
    ds_read_b64_tr_b16 v[72:73], v16 offset:16128
    v_mfma_f32_16x16x32_bf16 v[130:133], v[30:33], v[54:57], v[130:133]
    ds_read_b64_tr_b16 v[74:75], v17 offset:14368
    v_mfma_f32_16x16x32_bf16 v[134:137], v[30:33], v[58:61], v[134:137]
    buffer_load_dwordx4 v19, s[4:7], s37 offen offset:1024 lds
    v_mfma_f32_16x16x32_bf16 v[138:141], v[30:33], v[62:65], v[138:141]
    v_mfma_f32_16x16x32_bf16 v[142:145], v[30:33], v[66:69], v[142:145]
    ds_read_b64_tr_b16 v[76:77], v17 offset:16160
    v_mfma_f32_16x16x32_bf16 v[146:149], v[34:37], v[54:57], v[146:149]
    ds_read_b128 v[102:105], v24 offset:2048
    v_mfma_f32_16x16x32_bf16 v[150:153], v[34:37], v[58:61], v[150:153]
    ds_read_b64_tr_b16 v[78:79], v16 offset:14400
    v_mfma_f32_16x16x32_bf16 v[154:157], v[34:37], v[62:65], v[154:157]
    ds_read_b64_tr_b16 v[80:81], v16 offset:16192
    v_mfma_f32_16x16x32_bf16 v[158:161], v[34:37], v[66:69], v[158:161]
    buffer_load_dwordx4 v20, s[4:7], s37 offen offset:2048 lds
    v_mfma_f32_16x16x32_bf16 v[162:165], v[38:41], v[54:57], v[162:165]
    ds_read_b64_tr_b16 v[82:83], v17 offset:14432
    v_mfma_f32_16x16x32_bf16 v[166:169], v[38:41], v[58:61], v[166:169]
    v_mfma_f32_16x16x32_bf16 v[170:173], v[38:41], v[62:65], v[170:173]
    ds_read_b64_tr_b16 v[84:85], v17 offset:16224
    v_mfma_f32_16x16x32_bf16 v[174:177], v[38:41], v[66:69], v[174:177]
    ds_read_b128 v[106:109], v24 offset:4096
    v_mfma_f32_16x16x32_bf16 v[178:181], v[42:45], v[54:57], v[178:181]
    ds_read_b64_tr_b16 v[86:87], v16 offset:14464
    v_mfma_f32_16x16x32_bf16 v[182:185], v[42:45], v[58:61], v[182:185]
    buffer_load_dwordx4 v21, s[4:7], s37 offen offset:3072 lds
    v_mfma_f32_16x16x32_bf16 v[186:189], v[42:45], v[62:65], v[186:189]
    ds_read_b64_tr_b16 v[88:89], v16 offset:16256
    v_mfma_f32_16x16x32_bf16 v[190:193], v[42:45], v[66:69], v[190:193]
    ds_read_b64_tr_b16 v[90:91], v17 offset:14496
    v_mfma_f32_16x16x32_bf16 v[194:197], v[46:49], v[54:57], v[194:197]
    v_mfma_f32_16x16x32_bf16 v[198:201], v[46:49], v[58:61], v[198:201]
    ds_read_b128 v[110:113], v24 offset:6144
    v_mfma_f32_16x16x32_bf16 v[202:205], v[46:49], v[62:65], v[202:205]
    ds_read_b64_tr_b16 v[92:93], v17 offset:16288
    v_mfma_f32_16x16x32_bf16 v[206:209], v[46:49], v[66:69], v[206:209]
    s_add_u32 s37, s37, 128
    s_and_b32 s37, s37, 2047
    v_mfma_f32_16x16x32_bf16 v[210:213], v[50:53], v[54:57], v[210:213]
    ds_read_b64_tr_b16 v[94:95], v16 offset:14528
    v_mfma_f32_16x16x32_bf16 v[214:217], v[50:53], v[58:61], v[214:217]
    ds_read_b64_tr_b16 v[96:97], v16 offset:16320
    v_mfma_f32_16x16x32_bf16 v[218:221], v[50:53], v[62:65], v[218:221]
    v_add_u32 v16, s33, v14
    v_add_u32 v17, s33, v15
    v_add_u32 v23, s86, v22
    v_mfma_f32_16x16x32_bf16 v[222:225], v[50:53], v[66:69], v[222:225]
    s_cmp_lg_u32 s28, 0
    s_cbranch_scc1 L_mi9
    v_mov_b32 v6, 1
    v_mov_b32 v7, 0
    s_mov_b64 exec, 1
    buffer_atomic_add v6, v7, s[20:23], 0 offen sc1
    s_mov_b64 exec, -1
L_mi9:
    s_waitcnt vmcnt(4) lgkmcnt(0)
    s_barrier
    s_setprio 1
    v_mfma_f32_16x16x32_bf16 v[114:117], v[70:73], v[98:101], v[114:117]
    ds_read_b64_tr_b16 v[26:27], v16 offset:0
    v_mfma_f32_16x16x32_bf16 v[118:121], v[70:73], v[102:105], v[118:121]
    s_add_u32 s35, s32, s38
    s_mov_b32 m0, s35
    s_nop 0
    buffer_load_dwordx4 v10, s[8:11], s36 offen lds
    v_mfma_f32_16x16x32_bf16 v[122:125], v[70:73], v[106:109], v[122:125]
    ds_read_b128 v[54:57], v23 offset:0
    v_mfma_f32_16x16x32_bf16 v[126:129], v[70:73], v[110:113], v[126:129]
    ds_read_b64_tr_b16 v[28:29], v16 offset:1792
    v_mfma_f32_16x16x32_bf16 v[130:133], v[74:77], v[98:101], v[130:133]
    ds_read_b64_tr_b16 v[30:31], v17 offset:32
    v_mfma_f32_16x16x32_bf16 v[134:137], v[74:77], v[102:105], v[134:137]
    buffer_load_dwordx4 v11, s[8:11], s36 offen offset:1024 lds
    v_mfma_f32_16x16x32_bf16 v[138:141], v[74:77], v[106:109], v[138:141]
    v_mfma_f32_16x16x32_bf16 v[142:145], v[74:77], v[110:113], v[142:145]
    ds_read_b64_tr_b16 v[32:33], v17 offset:1824
    v_mfma_f32_16x16x32_bf16 v[146:149], v[78:81], v[98:101], v[146:149]
    ds_read_b128 v[58:61], v23 offset:2048
    v_mfma_f32_16x16x32_bf16 v[150:153], v[78:81], v[102:105], v[150:153]
    ds_read_b64_tr_b16 v[34:35], v16 offset:64
    v_mfma_f32_16x16x32_bf16 v[154:157], v[78:81], v[106:109], v[154:157]
    ds_read_b64_tr_b16 v[36:37], v16 offset:1856
    v_mfma_f32_16x16x32_bf16 v[158:161], v[78:81], v[110:113], v[158:161]
    buffer_load_dwordx4 v12, s[8:11], s36 offen offset:2048 lds
    v_mfma_f32_16x16x32_bf16 v[162:165], v[82:85], v[98:101], v[162:165]
    ds_read_b64_tr_b16 v[38:39], v17 offset:96
    v_mfma_f32_16x16x32_bf16 v[166:169], v[82:85], v[102:105], v[166:169]
    v_mfma_f32_16x16x32_bf16 v[170:173], v[82:85], v[106:109], v[170:173]
    ds_read_b64_tr_b16 v[40:41], v17 offset:1888
    v_mfma_f32_16x16x32_bf16 v[174:177], v[82:85], v[110:113], v[174:177]
    ds_read_b128 v[62:65], v23 offset:4096
    v_mfma_f32_16x16x32_bf16 v[178:181], v[86:89], v[98:101], v[178:181]
    s_cmp_lt_u32 s28, 4
    s_cbranch_scc0 L_ncs10
    buffer_load_dwordx4 v13, s[8:11], s36 offen offset:3072 lds
L_ncs10:
    v_mfma_f32_16x16x32_bf16 v[182:185], v[86:89], v[102:105], v[182:185]
    ds_read_b64_tr_b16 v[42:43], v16 offset:128
    v_mfma_f32_16x16x32_bf16 v[186:189], v[86:89], v[106:109], v[186:189]
    ds_read_b64_tr_b16 v[44:45], v16 offset:1920
    v_mfma_f32_16x16x32_bf16 v[190:193], v[86:89], v[110:113], v[190:193]
    ds_read_b64_tr_b16 v[46:47], v17 offset:160
    v_mfma_f32_16x16x32_bf16 v[194:197], v[90:93], v[98:101], v[194:197]
    v_mfma_f32_16x16x32_bf16 v[198:201], v[90:93], v[102:105], v[198:201]
    ds_read_b128 v[66:69], v23 offset:6144
    v_mfma_f32_16x16x32_bf16 v[202:205], v[90:93], v[106:109], v[202:205]
    s_add_u32 s36, s36, 458752
    s_cmp_eq_u32 s36, 7340032
    s_cselect_b32 s36, 0, s36
    v_mfma_f32_16x16x32_bf16 v[206:209], v[90:93], v[110:113], v[206:209]
    ds_read_b64_tr_b16 v[48:49], v17 offset:1952
    v_mfma_f32_16x16x32_bf16 v[210:213], v[94:97], v[98:101], v[210:213]
    ds_read_b64_tr_b16 v[50:51], v16 offset:192
    v_mfma_f32_16x16x32_bf16 v[214:217], v[94:97], v[102:105], v[214:217]
    ds_read_b64_tr_b16 v[52:53], v16 offset:1984
    v_mfma_f32_16x16x32_bf16 v[218:221], v[94:97], v[106:109], v[218:221]
    v_xor_b32 v24, 64, v23
    v_mfma_f32_16x16x32_bf16 v[222:225], v[94:97], v[110:113], v[222:225]
    s_setprio 0
    s_mov_b32 s34, 6
L_gl11:
    s_mov_b32 s31, s85
    s_mov_b32 s32, s33
    s_add_u32 s33, s33, 28672
    s_cmp_eq_u32 s33, 57344
    s_cselect_b32 s33, 0, s33
    s_mov_b32 s85, s86
    s_add_u32 s86, s86, 32768
    s_cmp_eq_u32 s86, 98304
    s_cselect_b32 s86, 0, s86
    s_waitcnt lgkmcnt(0)
    v_mfma_f32_16x16x32_bf16 v[114:117], v[26:29], v[54:57], v[114:117]
    ds_read_b64_tr_b16 v[70:71], v16 offset:14336
    v_mfma_f32_16x16x32_bf16 v[118:121], v[26:29], v[58:61], v[118:121]
    s_add_u32 s35, s31, s39
    s_mov_b32 m0, s35
    s_nop 0
    buffer_load_dwordx4 v18, s[4:7], s37 offen lds
    v_mfma_f32_16x16x32_bf16 v[122:125], v[26:29], v[62:65], v[122:125]
    ds_read_b128 v[98:101], v24 offset:0
    v_mfma_f32_16x16x32_bf16 v[126:129], v[26:29], v[66:69], v[126:129]
    ds_read_b64_tr_b16 v[72:73], v16 offset:16128
    v_mfma_f32_16x16x32_bf16 v[130:133], v[30:33], v[54:57], v[130:133]
    ds_read_b64_tr_b16 v[74:75], v17 offset:14368
    v_mfma_f32_16x16x32_bf16 v[134:137], v[30:33], v[58:61], v[134:137]
    buffer_load_dwordx4 v19, s[4:7], s37 offen offset:1024 lds
    v_mfma_f32_16x16x32_bf16 v[138:141], v[30:33], v[62:65], v[138:141]
    v_mfma_f32_16x16x32_bf16 v[142:145], v[30:33], v[66:69], v[142:145]
    ds_read_b64_tr_b16 v[76:77], v17 offset:16160
    v_mfma_f32_16x16x32_bf16 v[146:149], v[34:37], v[54:57], v[146:149]
    ds_read_b128 v[102:105], v24 offset:2048
    v_mfma_f32_16x16x32_bf16 v[150:153], v[34:37], v[58:61], v[150:153]
    ds_read_b64_tr_b16 v[78:79], v16 offset:14400
    v_mfma_f32_16x16x32_bf16 v[154:157], v[34:37], v[62:65], v[154:157]
    ds_read_b64_tr_b16 v[80:81], v16 offset:16192
    v_mfma_f32_16x16x32_bf16 v[158:161], v[34:37], v[66:69], v[158:161]
    buffer_load_dwordx4 v20, s[4:7], s37 offen offset:2048 lds
    v_mfma_f32_16x16x32_bf16 v[162:165], v[38:41], v[54:57], v[162:165]
    ds_read_b64_tr_b16 v[82:83], v17 offset:14432
    v_mfma_f32_16x16x32_bf16 v[166:169], v[38:41], v[58:61], v[166:169]
    v_mfma_f32_16x16x32_bf16 v[170:173], v[38:41], v[62:65], v[170:173]
    ds_read_b64_tr_b16 v[84:85], v17 offset:16224
    v_mfma_f32_16x16x32_bf16 v[174:177], v[38:41], v[66:69], v[174:177]
    ds_read_b128 v[106:109], v24 offset:4096
    v_mfma_f32_16x16x32_bf16 v[178:181], v[42:45], v[54:57], v[178:181]
    ds_read_b64_tr_b16 v[86:87], v16 offset:14464
    v_mfma_f32_16x16x32_bf16 v[182:185], v[42:45], v[58:61], v[182:185]
    buffer_load_dwordx4 v21, s[4:7], s37 offen offset:3072 lds
    v_mfma_f32_16x16x32_bf16 v[186:189], v[42:45], v[62:65], v[186:189]
    ds_read_b64_tr_b16 v[88:89], v16 offset:16256
    v_mfma_f32_16x16x32_bf16 v[190:193], v[42:45], v[66:69], v[190:193]
    ds_read_b64_tr_b16 v[90:91], v17 offset:14496
    v_mfma_f32_16x16x32_bf16 v[194:197], v[46:49], v[54:57], v[194:197]
    v_mfma_f32_16x16x32_bf16 v[198:201], v[46:49], v[58:61], v[198:201]
    ds_read_b128 v[110:113], v24 offset:6144
    v_mfma_f32_16x16x32_bf16 v[202:205], v[46:49], v[62:65], v[202:205]
    ds_read_b64_tr_b16 v[92:93], v17 offset:16288
    v_mfma_f32_16x16x32_bf16 v[206:209], v[46:49], v[66:69], v[206:209]
    s_add_u32 s37, s37, 128
    s_and_b32 s37, s37, 2047
    v_mfma_f32_16x16x32_bf16 v[210:213], v[50:53], v[54:57], v[210:213]
    ds_read_b64_tr_b16 v[94:95], v16 offset:14528
    v_mfma_f32_16x16x32_bf16 v[214:217], v[50:53], v[58:61], v[214:217]
    ds_read_b64_tr_b16 v[96:97], v16 offset:16320
    v_mfma_f32_16x16x32_bf16 v[218:221], v[50:53], v[62:65], v[218:221]
    v_add_u32 v16, s33, v14
    v_add_u32 v17, s33, v15
    v_add_u32 v23, s86, v22
    v_mfma_f32_16x16x32_bf16 v[222:225], v[50:53], v[66:69], v[222:225]
    s_waitcnt vmcnt(4) lgkmcnt(0)
    s_barrier
    s_setprio 1
    v_mfma_f32_16x16x32_bf16 v[114:117], v[70:73], v[98:101], v[114:117]
    ds_read_b64_tr_b16 v[26:27], v16 offset:0
    v_mfma_f32_16x16x32_bf16 v[118:121], v[70:73], v[102:105], v[118:121]
    s_add_u32 s35, s32, s38
    s_mov_b32 m0, s35
    s_nop 0
    buffer_load_dwordx4 v10, s[8:11], s36 offen lds
    v_mfma_f32_16x16x32_bf16 v[122:125], v[70:73], v[106:109], v[122:125]
    ds_read_b128 v[54:57], v23 offset:0
    v_mfma_f32_16x16x32_bf16 v[126:129], v[70:73], v[110:113], v[126:129]
    ds_read_b64_tr_b16 v[28:29], v16 offset:1792
    v_mfma_f32_16x16x32_bf16 v[130:133], v[74:77], v[98:101], v[130:133]
    ds_read_b64_tr_b16 v[30:31], v17 offset:32
    v_mfma_f32_16x16x32_bf16 v[134:137], v[74:77], v[102:105], v[134:137]
    buffer_load_dwordx4 v11, s[8:11], s36 offen offset:1024 lds
    v_mfma_f32_16x16x32_bf16 v[138:141], v[74:77], v[106:109], v[138:141]
    v_mfma_f32_16x16x32_bf16 v[142:145], v[74:77], v[110:113], v[142:145]
    ds_read_b64_tr_b16 v[32:33], v17 offset:1824
    v_mfma_f32_16x16x32_bf16 v[146:149], v[78:81], v[98:101], v[146:149]
    ds_read_b128 v[58:61], v23 offset:2048
    v_mfma_f32_16x16x32_bf16 v[150:153], v[78:81], v[102:105], v[150:153]
    ds_read_b64_tr_b16 v[34:35], v16 offset:64
    v_mfma_f32_16x16x32_bf16 v[154:157], v[78:81], v[106:109], v[154:157]
    ds_read_b64_tr_b16 v[36:37], v16 offset:1856
    v_mfma_f32_16x16x32_bf16 v[158:161], v[78:81], v[110:113], v[158:161]
    buffer_load_dwordx4 v12, s[8:11], s36 offen offset:2048 lds
    v_mfma_f32_16x16x32_bf16 v[162:165], v[82:85], v[98:101], v[162:165]
    ds_read_b64_tr_b16 v[38:39], v17 offset:96
    v_mfma_f32_16x16x32_bf16 v[166:169], v[82:85], v[102:105], v[166:169]
    v_mfma_f32_16x16x32_bf16 v[170:173], v[82:85], v[106:109], v[170:173]
    ds_read_b64_tr_b16 v[40:41], v17 offset:1888
    v_mfma_f32_16x16x32_bf16 v[174:177], v[82:85], v[110:113], v[174:177]
    ds_read_b128 v[62:65], v23 offset:4096
    v_mfma_f32_16x16x32_bf16 v[178:181], v[86:89], v[98:101], v[178:181]
    s_cmp_lt_u32 s28, 4
    s_cbranch_scc0 L_ncs12
    buffer_load_dwordx4 v13, s[8:11], s36 offen offset:3072 lds
L_ncs12:
    v_mfma_f32_16x16x32_bf16 v[182:185], v[86:89], v[102:105], v[182:185]
    ds_read_b64_tr_b16 v[42:43], v16 offset:128
    v_mfma_f32_16x16x32_bf16 v[186:189], v[86:89], v[106:109], v[186:189]
    ds_read_b64_tr_b16 v[44:45], v16 offset:1920
    v_mfma_f32_16x16x32_bf16 v[190:193], v[86:89], v[110:113], v[190:193]
    ds_read_b64_tr_b16 v[46:47], v17 offset:160
    v_mfma_f32_16x16x32_bf16 v[194:197], v[90:93], v[98:101], v[194:197]
    v_mfma_f32_16x16x32_bf16 v[198:201], v[90:93], v[102:105], v[198:201]
    ds_read_b128 v[66:69], v23 offset:6144
    v_mfma_f32_16x16x32_bf16 v[202:205], v[90:93], v[106:109], v[202:205]
    s_add_u32 s36, s36, 458752
    s_cmp_eq_u32 s36, 7340032
    s_cselect_b32 s36, 0, s36
    v_mfma_f32_16x16x32_bf16 v[206:209], v[90:93], v[110:113], v[206:209]
    ds_read_b64_tr_b16 v[48:49], v17 offset:1952
    v_mfma_f32_16x16x32_bf16 v[210:213], v[94:97], v[98:101], v[210:213]
    ds_read_b64_tr_b16 v[50:51], v16 offset:192
    v_mfma_f32_16x16x32_bf16 v[214:217], v[94:97], v[102:105], v[214:217]
    ds_read_b64_tr_b16 v[52:53], v16 offset:1984
    v_mfma_f32_16x16x32_bf16 v[218:221], v[94:97], v[106:109], v[218:221]
    v_xor_b32 v24, 64, v23
    v_mfma_f32_16x16x32_bf16 v[222:225], v[94:97], v[110:113], v[222:225]
    s_setprio 0
    s_sub_u32 s34, s34, 1
    s_cmp_lg_u32 s34, 0
    s_cbranch_scc1 L_gl11
    s_mov_b32 s31, s85
    s_mov_b32 s32, s33
    s_add_u32 s33, s33, 28672
    s_cmp_eq_u32 s33, 57344
    s_cselect_b32 s33, 0, s33
    s_mov_b32 s85, s86
    s_add_u32 s86, s86, 32768
    s_cmp_eq_u32 s86, 98304
    s_cselect_b32 s86, 0, s86
    s_waitcnt lgkmcnt(0)
    v_mfma_f32_16x16x32_bf16 v[114:117], v[26:29], v[54:57], v[114:117]
    ds_read_b64_tr_b16 v[70:71], v16 offset:14336
    v_mfma_f32_16x16x32_bf16 v[118:121], v[26:29], v[58:61], v[118:121]
    ds_read_b128 v[98:101], v24 offset:0
    v_mfma_f32_16x16x32_bf16 v[122:125], v[26:29], v[62:65], v[122:125]
    ds_read_b64_tr_b16 v[72:73], v16 offset:16128
    v_mfma_f32_16x16x32_bf16 v[126:129], v[26:29], v[66:69], v[126:129]
    v_mfma_f32_16x16x32_bf16 v[130:133], v[30:33], v[54:57], v[130:133]
    ds_read_b64_tr_b16 v[74:75], v17 offset:14368
    v_mfma_f32_16x16x32_bf16 v[134:137], v[30:33], v[58:61], v[134:137]
    ds_read_b64_tr_b16 v[76:77], v17 offset:16160
    v_mfma_f32_16x16x32_bf16 v[138:141], v[30:33], v[62:65], v[138:141]
    v_mfma_f32_16x16x32_bf16 v[142:145], v[30:33], v[66:69], v[142:145]
    ds_read_b128 v[102:105], v24 offset:2048
    v_mfma_f32_16x16x32_bf16 v[146:149], v[34:37], v[54:57], v[146:149]
    ds_read_b64_tr_b16 v[78:79], v16 offset:14400
    v_mfma_f32_16x16x32_bf16 v[150:153], v[34:37], v[58:61], v[150:153]
    v_mfma_f32_16x16x32_bf16 v[154:157], v[34:37], v[62:65], v[154:157]
    ds_read_b64_tr_b16 v[80:81], v16 offset:16192
    v_mfma_f32_16x16x32_bf16 v[158:161], v[34:37], v[66:69], v[158:161]
    ds_read_b64_tr_b16 v[82:83], v17 offset:14432
    v_mfma_f32_16x16x32_bf16 v[162:165], v[38:41], v[54:57], v[162:165]
    v_mfma_f32_16x16x32_bf16 v[166:169], v[38:41], v[58:61], v[166:169]
    ds_read_b64_tr_b16 v[84:85], v17 offset:16224
    v_mfma_f32_16x16x32_bf16 v[170:173], v[38:41], v[62:65], v[170:173]
    ds_read_b128 v[106:109], v24 offset:4096
    v_mfma_f32_16x16x32_bf16 v[174:177], v[38:41], v[66:69], v[174:177]
    v_mfma_f32_16x16x32_bf16 v[178:181], v[42:45], v[54:57], v[178:181]
    ds_read_b64_tr_b16 v[86:87], v16 offset:14464
    v_mfma_f32_16x16x32_bf16 v[182:185], v[42:45], v[58:61], v[182:185]
    ds_read_b64_tr_b16 v[88:89], v16 offset:16256
    v_mfma_f32_16x16x32_bf16 v[186:189], v[42:45], v[62:65], v[186:189]
    v_mfma_f32_16x16x32_bf16 v[190:193], v[42:45], v[66:69], v[190:193]
    ds_read_b64_tr_b16 v[90:91], v17 offset:14496
    v_mfma_f32_16x16x32_bf16 v[194:197], v[46:49], v[54:57], v[194:197]
    ds_read_b128 v[110:113], v24 offset:6144
    v_mfma_f32_16x16x32_bf16 v[198:201], v[46:49], v[58:61], v[198:201]
    v_mfma_f32_16x16x32_bf16 v[202:205], v[46:49], v[62:65], v[202:205]
    ds_read_b64_tr_b16 v[92:93], v17 offset:16288
    v_mfma_f32_16x16x32_bf16 v[206:209], v[46:49], v[66:69], v[206:209]
    ds_read_b64_tr_b16 v[94:95], v16 offset:14528
    v_mfma_f32_16x16x32_bf16 v[210:213], v[50:53], v[54:57], v[210:213]
    v_mfma_f32_16x16x32_bf16 v[214:217], v[50:53], v[58:61], v[214:217]
    ds_read_b64_tr_b16 v[96:97], v16 offset:16320
    v_mfma_f32_16x16x32_bf16 v[218:221], v[50:53], v[62:65], v[218:221]
    v_add_u32 v16, s33, v14
    v_add_u32 v17, s33, v15
    v_add_u32 v23, s86, v22
    v_mfma_f32_16x16x32_bf16 v[222:225], v[50:53], v[66:69], v[222:225]
    s_waitcnt vmcnt(0) lgkmcnt(0)
    s_barrier
    s_setprio 1
    v_mfma_f32_16x16x32_bf16 v[114:117], v[70:73], v[98:101], v[114:117]
    ds_read_b64_tr_b16 v[26:27], v16 offset:0
    v_mfma_f32_16x16x32_bf16 v[118:121], v[70:73], v[102:105], v[118:121]
    ds_read_b128 v[54:57], v23 offset:0
    v_mfma_f32_16x16x32_bf16 v[122:125], v[70:73], v[106:109], v[122:125]
    ds_read_b64_tr_b16 v[28:29], v16 offset:1792
    v_mfma_f32_16x16x32_bf16 v[126:129], v[70:73], v[110:113], v[126:129]
    v_mfma_f32_16x16x32_bf16 v[130:133], v[74:77], v[98:101], v[130:133]
    ds_read_b64_tr_b16 v[30:31], v17 offset:32
    v_mfma_f32_16x16x32_bf16 v[134:137], v[74:77], v[102:105], v[134:137]
    ds_read_b64_tr_b16 v[32:33], v17 offset:1824
    v_mfma_f32_16x16x32_bf16 v[138:141], v[74:77], v[106:109], v[138:141]
    v_mfma_f32_16x16x32_bf16 v[142:145], v[74:77], v[110:113], v[142:145]
    ds_read_b128 v[58:61], v23 offset:2048
    v_mfma_f32_16x16x32_bf16 v[146:149], v[78:81], v[98:101], v[146:149]
    ds_read_b64_tr_b16 v[34:35], v16 offset:64
    v_mfma_f32_16x16x32_bf16 v[150:153], v[78:81], v[102:105], v[150:153]
    v_mfma_f32_16x16x32_bf16 v[154:157], v[78:81], v[106:109], v[154:157]
    ds_read_b64_tr_b16 v[36:37], v16 offset:1856
    v_mfma_f32_16x16x32_bf16 v[158:161], v[78:81], v[110:113], v[158:161]
    ds_read_b64_tr_b16 v[38:39], v17 offset:96
    v_mfma_f32_16x16x32_bf16 v[162:165], v[82:85], v[98:101], v[162:165]
    v_mfma_f32_16x16x32_bf16 v[166:169], v[82:85], v[102:105], v[166:169]
    ds_read_b64_tr_b16 v[40:41], v17 offset:1888
    v_mfma_f32_16x16x32_bf16 v[170:173], v[82:85], v[106:109], v[170:173]
    ds_read_b128 v[62:65], v23 offset:4096
    v_mfma_f32_16x16x32_bf16 v[174:177], v[82:85], v[110:113], v[174:177]
    v_mfma_f32_16x16x32_bf16 v[178:181], v[86:89], v[98:101], v[178:181]
    ds_read_b64_tr_b16 v[42:43], v16 offset:128
    v_mfma_f32_16x16x32_bf16 v[182:185], v[86:89], v[102:105], v[182:185]
    ds_read_b64_tr_b16 v[44:45], v16 offset:1920
    v_mfma_f32_16x16x32_bf16 v[186:189], v[86:89], v[106:109], v[186:189]
    v_mfma_f32_16x16x32_bf16 v[190:193], v[86:89], v[110:113], v[190:193]
    ds_read_b64_tr_b16 v[46:47], v17 offset:160
    v_mfma_f32_16x16x32_bf16 v[194:197], v[90:93], v[98:101], v[194:197]
    ds_read_b128 v[66:69], v23 offset:6144
    v_mfma_f32_16x16x32_bf16 v[198:201], v[90:93], v[102:105], v[198:201]
    v_mfma_f32_16x16x32_bf16 v[202:205], v[90:93], v[106:109], v[202:205]
    ds_read_b64_tr_b16 v[48:49], v17 offset:1952
    v_mfma_f32_16x16x32_bf16 v[206:209], v[90:93], v[110:113], v[206:209]
    ds_read_b64_tr_b16 v[50:51], v16 offset:192
    v_mfma_f32_16x16x32_bf16 v[210:213], v[94:97], v[98:101], v[210:213]
    v_mfma_f32_16x16x32_bf16 v[214:217], v[94:97], v[102:105], v[214:217]
    ds_read_b64_tr_b16 v[52:53], v16 offset:1984
    v_mfma_f32_16x16x32_bf16 v[218:221], v[94:97], v[106:109], v[218:221]
    v_xor_b32 v24, 64, v23
    v_mfma_f32_16x16x32_bf16 v[222:225], v[94:97], v[110:113], v[222:225]
    s_setprio 0
    s_mov_b32 s31, s85
    s_mov_b32 s32, s33
    s_add_u32 s33, s33, 28672
    s_cmp_eq_u32 s33, 57344
    s_cselect_b32 s33, 0, s33
    s_mov_b32 s85, s86
    s_add_u32 s86, s86, 32768
    s_cmp_eq_u32 s86, 98304
    s_cselect_b32 s86, 0, s86
    s_waitcnt lgkmcnt(0)
    v_mfma_f32_16x16x32_bf16 v[114:117], v[26:29], v[54:57], v[114:117]
    ds_read_b64_tr_b16 v[70:71], v16 offset:14336
    v_mfma_f32_16x16x32_bf16 v[118:121], v[26:29], v[58:61], v[118:121]
    ds_read_b128 v[98:101], v24 offset:0
    v_mfma_f32_16x16x32_bf16 v[122:125], v[26:29], v[62:65], v[122:125]
    v_mfma_f32_16x16x32_bf16 v[126:129], v[26:29], v[66:69], v[126:129]
    ds_read_b64_tr_b16 v[72:73], v16 offset:16128
    v_mfma_f32_16x16x32_bf16 v[130:133], v[30:33], v[54:57], v[130:133]
    ds_read_b64_tr_b16 v[74:75], v17 offset:14368
    v_mfma_f32_16x16x32_bf16 v[134:137], v[30:33], v[58:61], v[134:137]
    v_mfma_f32_16x16x32_bf16 v[138:141], v[30:33], v[62:65], v[138:141]
    ds_read_b64_tr_b16 v[76:77], v17 offset:16160
    v_mfma_f32_16x16x32_bf16 v[142:145], v[30:33], v[66:69], v[142:145]
    ds_read_b128 v[102:105], v24 offset:2048
    v_mfma_f32_16x16x32_bf16 v[146:149], v[34:37], v[54:57], v[146:149]
    v_mfma_f32_16x16x32_bf16 v[150:153], v[34:37], v[58:61], v[150:153]
    ds_read_b64_tr_b16 v[78:79], v16 offset:14400
    v_mfma_f32_16x16x32_bf16 v[154:157], v[34:37], v[62:65], v[154:157]
    ds_read_b64_tr_b16 v[80:81], v16 offset:16192
    v_mfma_f32_16x16x32_bf16 v[158:161], v[34:37], v[66:69], v[158:161]
    v_mfma_f32_16x16x32_bf16 v[162:165], v[38:41], v[54:57], v[162:165]
    ds_read_b64_tr_b16 v[82:83], v17 offset:14432
    v_mfma_f32_16x16x32_bf16 v[166:169], v[38:41], v[58:61], v[166:169]
    v_mfma_f32_16x16x32_bf16 v[170:173], v[38:41], v[62:65], v[170:173]
    ds_read_b64_tr_b16 v[84:85], v17 offset:16224
    v_mfma_f32_16x16x32_bf16 v[174:177], v[38:41], v[66:69], v[174:177]
    ds_read_b128 v[106:109], v24 offset:4096
    v_mfma_f32_16x16x32_bf16 v[178:181], v[42:45], v[54:57], v[178:181]
    v_mfma_f32_16x16x32_bf16 v[182:185], v[42:45], v[58:61], v[182:185]
    ds_read_b64_tr_b16 v[86:87], v16 offset:14464
    v_mfma_f32_16x16x32_bf16 v[186:189], v[42:45], v[62:65], v[186:189]
    ds_read_b64_tr_b16 v[88:89], v16 offset:16256
    v_mfma_f32_16x16x32_bf16 v[190:193], v[42:45], v[66:69], v[190:193]
    v_mfma_f32_16x16x32_bf16 v[194:197], v[46:49], v[54:57], v[194:197]
    ds_read_b64_tr_b16 v[90:91], v17 offset:14496
    v_mfma_f32_16x16x32_bf16 v[198:201], v[46:49], v[58:61], v[198:201]
    ds_read_b128 v[110:113], v24 offset:6144
    v_mfma_f32_16x16x32_bf16 v[202:205], v[46:49], v[62:65], v[202:205]
    v_mfma_f32_16x16x32_bf16 v[206:209], v[46:49], v[66:69], v[206:209]
    ds_read_b64_tr_b16 v[92:93], v17 offset:16288
    v_mfma_f32_16x16x32_bf16 v[210:213], v[50:53], v[54:57], v[210:213]
    ds_read_b64_tr_b16 v[94:95], v16 offset:14528
    v_mfma_f32_16x16x32_bf16 v[214:217], v[50:53], v[58:61], v[214:217]
    v_mfma_f32_16x16x32_bf16 v[218:221], v[50:53], v[62:65], v[218:221]
    ds_read_b64_tr_b16 v[96:97], v16 offset:16320
    v_mfma_f32_16x16x32_bf16 v[222:225], v[50:53], v[66:69], v[222:225]
    s_waitcnt lgkmcnt(0)
    v_mfma_f32_16x16x32_bf16 v[114:117], v[70:73], v[98:101], v[114:117]
    v_mfma_f32_16x16x32_bf16 v[118:121], v[70:73], v[102:105], v[118:121]
    v_mfma_f32_16x16x32_bf16 v[122:125], v[70:73], v[106:109], v[122:125]
    v_mfma_f32_16x16x32_bf16 v[126:129], v[70:73], v[110:113], v[126:129]
    v_mfma_f32_16x16x32_bf16 v[130:133], v[74:77], v[98:101], v[130:133]
    v_mfma_f32_16x16x32_bf16 v[134:137], v[74:77], v[102:105], v[134:137]
    v_mfma_f32_16x16x32_bf16 v[138:141], v[74:77], v[106:109], v[138:141]
    v_mfma_f32_16x16x32_bf16 v[142:145], v[74:77], v[110:113], v[142:145]
    v_mfma_f32_16x16x32_bf16 v[146:149], v[78:81], v[98:101], v[146:149]
    v_mfma_f32_16x16x32_bf16 v[150:153], v[78:81], v[102:105], v[150:153]
    v_mfma_f32_16x16x32_bf16 v[154:157], v[78:81], v[106:109], v[154:157]
    v_mfma_f32_16x16x32_bf16 v[158:161], v[78:81], v[110:113], v[158:161]
    v_mfma_f32_16x16x32_bf16 v[162:165], v[82:85], v[98:101], v[162:165]
    v_mfma_f32_16x16x32_bf16 v[166:169], v[82:85], v[102:105], v[166:169]
    v_mfma_f32_16x16x32_bf16 v[170:173], v[82:85], v[106:109], v[170:173]
    v_mfma_f32_16x16x32_bf16 v[174:177], v[82:85], v[110:113], v[174:177]
    v_mfma_f32_16x16x32_bf16 v[178:181], v[86:89], v[98:101], v[178:181]
    v_mfma_f32_16x16x32_bf16 v[182:185], v[86:89], v[102:105], v[182:185]
    v_mfma_f32_16x16x32_bf16 v[186:189], v[86:89], v[106:109], v[186:189]
    v_mfma_f32_16x16x32_bf16 v[190:193], v[86:89], v[110:113], v[190:193]
    v_mfma_f32_16x16x32_bf16 v[194:197], v[90:93], v[98:101], v[194:197]
    v_mfma_f32_16x16x32_bf16 v[198:201], v[90:93], v[102:105], v[198:201]
    v_mfma_f32_16x16x32_bf16 v[202:205], v[90:93], v[106:109], v[202:205]
    v_mfma_f32_16x16x32_bf16 v[206:209], v[90:93], v[110:113], v[206:209]
    v_mfma_f32_16x16x32_bf16 v[210:213], v[94:97], v[98:101], v[210:213]
    v_mfma_f32_16x16x32_bf16 v[214:217], v[94:97], v[102:105], v[214:217]
    v_mfma_f32_16x16x32_bf16 v[218:221], v[94:97], v[106:109], v[218:221]
    v_mfma_f32_16x16x32_bf16 v[222:225], v[94:97], v[110:113], v[222:225]
    s_cmp_lg_u32 s28, 0
    s_cbranch_scc1 L_il13
    v_mov_b32 v1, 0
    buffer_load_dword v1, v1, s[20:23], 0 offen sc1
L_il13:
    v_and_b32 v2, 15, v0
    v_mul_u32_u24 v2, 464, v2
    v_lshrrev_b32 v3, 4, v0
    v_lshl_add_u32 v2, v3, 3, v2
    s_mul_i32 s76, s81, 29696
    s_mul_i32 s77, s80, 224
    s_add_u32 s76, s76, s77
    v_add_u32 v2, s76, v2
    v_cmp_le_u32 vcc, 28, v0
    s_nop 1
    v_cndmask_b32 v5, 0, 1, vcc
    v_mul_u32_u24 v6, 28, v5
    v_sub_u32 v6, v0, v6
    v_lshlrev_b32 v6, 4, v6
    v_mul_u32_u24 v3, 464, v5
    v_add_u32 v3, v3, v6
    s_mul_i32 s76, s81, 29696
    s_mul_i32 s77, s80, 3712
    s_add_u32 s76, s76, s77
    v_add_u32 v3, s76, v3
    v_mul_u32_u24 v4, 11264, v5
    v_add_u32 v4, v4, v6
    s_lshl_b32 s76, s29, 8
    s_lshl_b32 s77, s81, 6
    s_add_u32 s76, s76, s77
    s_mul_i32 s77, s80, 8
    s_add_u32 s76, s76, s77
    s_mul_i32 s76, s76, 11264
    s_mul_i32 s77, s30, 448
    s_add_u32 s76, s76, s77
    s_add_u32 s76, s76, 4096
    v_mul_f32_e64 v114, v114, |v114|
    v_mul_f32_e64 v115, v115, |v115|
    v_mul_f32_e64 v116, v116, |v116|
    v_mul_f32_e64 v117, v117, |v117|
    v_cvt_pk_bf16_f32 v114, v114, v115
    v_cvt_pk_bf16_f32 v115, v116, v117
    v_pk_max_i16 v114, v114, 0
    v_pk_max_i16 v115, v115, 0
    v_mul_f32_e64 v130, v130, |v130|
    v_mul_f32_e64 v131, v131, |v131|
    v_mul_f32_e64 v132, v132, |v132|
    v_mul_f32_e64 v133, v133, |v133|
    v_cvt_pk_bf16_f32 v130, v130, v131
    v_cvt_pk_bf16_f32 v131, v132, v133
    v_pk_max_i16 v130, v130, 0
    v_pk_max_i16 v131, v131, 0
    v_mul_f32_e64 v146, v146, |v146|
    v_mul_f32_e64 v147, v147, |v147|
    v_mul_f32_e64 v148, v148, |v148|
    v_mul_f32_e64 v149, v149, |v149|
    v_cvt_pk_bf16_f32 v146, v146, v147
    v_cvt_pk_bf16_f32 v147, v148, v149
    v_pk_max_i16 v146, v146, 0
    v_pk_max_i16 v147, v147, 0
    v_mul_f32_e64 v162, v162, |v162|
    v_mul_f32_e64 v163, v163, |v163|
    v_mul_f32_e64 v164, v164, |v164|
    v_mul_f32_e64 v165, v165, |v165|
    v_cvt_pk_bf16_f32 v162, v162, v163
    v_cvt_pk_bf16_f32 v163, v164, v165
    v_pk_max_i16 v162, v162, 0
    v_pk_max_i16 v163, v163, 0
    v_mul_f32_e64 v178, v178, |v178|
    v_mul_f32_e64 v179, v179, |v179|
    v_mul_f32_e64 v180, v180, |v180|
    v_mul_f32_e64 v181, v181, |v181|
    v_cvt_pk_bf16_f32 v178, v178, v179
    v_cvt_pk_bf16_f32 v179, v180, v181
    v_pk_max_i16 v178, v178, 0
    v_pk_max_i16 v179, v179, 0
    v_mul_f32_e64 v194, v194, |v194|
    v_mul_f32_e64 v195, v195, |v195|
    v_mul_f32_e64 v196, v196, |v196|
    v_mul_f32_e64 v197, v197, |v197|
    v_cvt_pk_bf16_f32 v194, v194, v195
    v_cvt_pk_bf16_f32 v195, v196, v197
    v_pk_max_i16 v194, v194, 0
    v_pk_max_i16 v195, v195, 0
    v_mul_f32_e64 v210, v210, |v210|
    v_mul_f32_e64 v211, v211, |v211|
    v_mul_f32_e64 v212, v212, |v212|
    v_mul_f32_e64 v213, v213, |v213|
    v_cvt_pk_bf16_f32 v210, v210, v211
    v_cvt_pk_bf16_f32 v211, v212, v213
    v_pk_max_i16 v210, v210, 0
    v_pk_max_i16 v211, v211, 0
    s_barrier
    ds_write_b64 v2, v[114:115] offset:0
    ds_write_b64 v2, v[130:131] offset:32
    ds_write_b64 v2, v[146:147] offset:64
    ds_write_b64 v2, v[162:163] offset:96
    ds_write_b64 v2, v[178:179] offset:128
    ds_write_b64 v2, v[194:195] offset:160
    ds_write_b64 v2, v[210:211] offset:192
    s_waitcnt lgkmcnt(0)
    s_barrier
    s_mov_b32 exec_hi, 0x00ffffff
    ds_read_b128 v[26:29], v3 offset:0
    ds_read_b128 v[30:33], v3 offset:928
    ds_read_b128 v[34:37], v3 offset:1856
    ds_read_b128 v[38:41], v3 offset:2784
    s_waitcnt lgkmcnt(3)
    buffer_store_dwordx4 v[26:29], v4, s[16:19], s76 offen sc1
    s_add_u32 s76, s76, 22528
    s_waitcnt lgkmcnt(2)
    buffer_store_dwordx4 v[30:33], v4, s[16:19], s76 offen sc1
    s_add_u32 s76, s76, 22528
    s_waitcnt lgkmcnt(1)
    buffer_store_dwordx4 v[34:37], v4, s[16:19], s76 offen sc1
    s_add_u32 s76, s76, 22528
    s_waitcnt lgkmcnt(0)
    buffer_store_dwordx4 v[38:41], v4, s[16:19], s76 offen sc1
    s_add_u32 s76, s76, 22528
    s_mov_b64 exec, -1
    s_nop 1
    v_mul_f32_e64 v118, v118, |v118|
    v_mul_f32_e64 v119, v119, |v119|
    v_mul_f32_e64 v120, v120, |v120|
    v_mul_f32_e64 v121, v121, |v121|
    v_cvt_pk_bf16_f32 v118, v118, v119
    v_cvt_pk_bf16_f32 v119, v120, v121
    v_pk_max_i16 v118, v118, 0
    v_pk_max_i16 v119, v119, 0
    v_mul_f32_e64 v134, v134, |v134|
    v_mul_f32_e64 v135, v135, |v135|
    v_mul_f32_e64 v136, v136, |v136|
    v_mul_f32_e64 v137, v137, |v137|
    v_cvt_pk_bf16_f32 v134, v134, v135
    v_cvt_pk_bf16_f32 v135, v136, v137
    v_pk_max_i16 v134, v134, 0
    v_pk_max_i16 v135, v135, 0
    v_mul_f32_e64 v150, v150, |v150|
    v_mul_f32_e64 v151, v151, |v151|
    v_mul_f32_e64 v152, v152, |v152|
    v_mul_f32_e64 v153, v153, |v153|
    v_cvt_pk_bf16_f32 v150, v150, v151
    v_cvt_pk_bf16_f32 v151, v152, v153
    v_pk_max_i16 v150, v150, 0
    v_pk_max_i16 v151, v151, 0
    v_mul_f32_e64 v166, v166, |v166|
    v_mul_f32_e64 v167, v167, |v167|
    v_mul_f32_e64 v168, v168, |v168|
    v_mul_f32_e64 v169, v169, |v169|
    v_cvt_pk_bf16_f32 v166, v166, v167
    v_cvt_pk_bf16_f32 v167, v168, v169
    v_pk_max_i16 v166, v166, 0
    v_pk_max_i16 v167, v167, 0
    v_mul_f32_e64 v182, v182, |v182|
    v_mul_f32_e64 v183, v183, |v183|
    v_mul_f32_e64 v184, v184, |v184|
    v_mul_f32_e64 v185, v185, |v185|
    v_cvt_pk_bf16_f32 v182, v182, v183
    v_cvt_pk_bf16_f32 v183, v184, v185
    v_pk_max_i16 v182, v182, 0
    v_pk_max_i16 v183, v183, 0
    v_mul_f32_e64 v198, v198, |v198|
    v_mul_f32_e64 v199, v199, |v199|
    v_mul_f32_e64 v200, v200, |v200|
    v_mul_f32_e64 v201, v201, |v201|
    v_cvt_pk_bf16_f32 v198, v198, v199
    v_cvt_pk_bf16_f32 v199, v200, v201
    v_pk_max_i16 v198, v198, 0
    v_pk_max_i16 v199, v199, 0
    v_mul_f32_e64 v214, v214, |v214|
    v_mul_f32_e64 v215, v215, |v215|
    v_mul_f32_e64 v216, v216, |v216|
    v_mul_f32_e64 v217, v217, |v217|
    v_cvt_pk_bf16_f32 v214, v214, v215
    v_cvt_pk_bf16_f32 v215, v216, v217
    v_pk_max_i16 v214, v214, 0
    v_pk_max_i16 v215, v215, 0
    ds_write_b64 v2, v[118:119] offset:7424
    ds_write_b64 v2, v[134:135] offset:7456
    ds_write_b64 v2, v[150:151] offset:7488
    ds_write_b64 v2, v[166:167] offset:7520
    ds_write_b64 v2, v[182:183] offset:7552
    ds_write_b64 v2, v[198:199] offset:7584
    ds_write_b64 v2, v[214:215] offset:7616
    s_waitcnt lgkmcnt(0)
    s_barrier
    s_mov_b32 exec_hi, 0x00ffffff
    ds_read_b128 v[26:29], v3 offset:7424
    ds_read_b128 v[30:33], v3 offset:8352
    ds_read_b128 v[34:37], v3 offset:9280
    ds_read_b128 v[38:41], v3 offset:10208
    s_add_u32 s76, s76, 90112
    s_waitcnt lgkmcnt(3)
    buffer_store_dwordx4 v[26:29], v4, s[16:19], s76 offen sc1
    s_add_u32 s76, s76, 22528
    s_waitcnt lgkmcnt(2)
    buffer_store_dwordx4 v[30:33], v4, s[16:19], s76 offen sc1
    s_add_u32 s76, s76, 22528
    s_waitcnt lgkmcnt(1)
    buffer_store_dwordx4 v[34:37], v4, s[16:19], s76 offen sc1
    s_add_u32 s76, s76, 22528
    s_waitcnt lgkmcnt(0)
    buffer_store_dwordx4 v[38:41], v4, s[16:19], s76 offen sc1
    s_add_u32 s76, s76, 22528
    s_mov_b64 exec, -1
    s_nop 1
    v_mul_f32_e64 v122, v122, |v122|
    v_mul_f32_e64 v123, v123, |v123|
    v_mul_f32_e64 v124, v124, |v124|
    v_mul_f32_e64 v125, v125, |v125|
    v_cvt_pk_bf16_f32 v122, v122, v123
    v_cvt_pk_bf16_f32 v123, v124, v125
    v_pk_max_i16 v122, v122, 0
    v_pk_max_i16 v123, v123, 0
    v_mul_f32_e64 v138, v138, |v138|
    v_mul_f32_e64 v139, v139, |v139|
    v_mul_f32_e64 v140, v140, |v140|
    v_mul_f32_e64 v141, v141, |v141|
    v_cvt_pk_bf16_f32 v138, v138, v139
    v_cvt_pk_bf16_f32 v139, v140, v141
    v_pk_max_i16 v138, v138, 0
    v_pk_max_i16 v139, v139, 0
    v_mul_f32_e64 v154, v154, |v154|
    v_mul_f32_e64 v155, v155, |v155|
    v_mul_f32_e64 v156, v156, |v156|
    v_mul_f32_e64 v157, v157, |v157|
    v_cvt_pk_bf16_f32 v154, v154, v155
    v_cvt_pk_bf16_f32 v155, v156, v157
    v_pk_max_i16 v154, v154, 0
    v_pk_max_i16 v155, v155, 0
    v_mul_f32_e64 v170, v170, |v170|
    v_mul_f32_e64 v171, v171, |v171|
    v_mul_f32_e64 v172, v172, |v172|
    v_mul_f32_e64 v173, v173, |v173|
    v_cvt_pk_bf16_f32 v170, v170, v171
    v_cvt_pk_bf16_f32 v171, v172, v173
    v_pk_max_i16 v170, v170, 0
    v_pk_max_i16 v171, v171, 0
    v_mul_f32_e64 v186, v186, |v186|
    v_mul_f32_e64 v187, v187, |v187|
    v_mul_f32_e64 v188, v188, |v188|
    v_mul_f32_e64 v189, v189, |v189|
    v_cvt_pk_bf16_f32 v186, v186, v187
    v_cvt_pk_bf16_f32 v187, v188, v189
    v_pk_max_i16 v186, v186, 0
    v_pk_max_i16 v187, v187, 0
    v_mul_f32_e64 v202, v202, |v202|
    v_mul_f32_e64 v203, v203, |v203|
    v_mul_f32_e64 v204, v204, |v204|
    v_mul_f32_e64 v205, v205, |v205|
    v_cvt_pk_bf16_f32 v202, v202, v203
    v_cvt_pk_bf16_f32 v203, v204, v205
    v_pk_max_i16 v202, v202, 0
    v_pk_max_i16 v203, v203, 0
    v_mul_f32_e64 v218, v218, |v218|
    v_mul_f32_e64 v219, v219, |v219|
    v_mul_f32_e64 v220, v220, |v220|
    v_mul_f32_e64 v221, v221, |v221|
    v_cvt_pk_bf16_f32 v218, v218, v219
    v_cvt_pk_bf16_f32 v219, v220, v221
    v_pk_max_i16 v218, v218, 0
    v_pk_max_i16 v219, v219, 0
    ds_write_b64 v2, v[122:123] offset:14848
    ds_write_b64 v2, v[138:139] offset:14880
    ds_write_b64 v2, v[154:155] offset:14912
    ds_write_b64 v2, v[170:171] offset:14944
    ds_write_b64 v2, v[186:187] offset:14976
    ds_write_b64 v2, v[202:203] offset:15008
    ds_write_b64 v2, v[218:219] offset:15040
    s_waitcnt lgkmcnt(0)
    s_barrier
    s_mov_b32 exec_hi, 0x00ffffff
    ds_read_b128 v[26:29], v3 offset:14848
    ds_read_b128 v[30:33], v3 offset:15776
    ds_read_b128 v[34:37], v3 offset:16704
    ds_read_b128 v[38:41], v3 offset:17632
    s_add_u32 s76, s76, 90112
    s_waitcnt lgkmcnt(3)
    buffer_store_dwordx4 v[26:29], v4, s[16:19], s76 offen sc1
    s_add_u32 s76, s76, 22528
    s_waitcnt lgkmcnt(2)
    buffer_store_dwordx4 v[30:33], v4, s[16:19], s76 offen sc1
    s_add_u32 s76, s76, 22528
    s_waitcnt lgkmcnt(1)
    buffer_store_dwordx4 v[34:37], v4, s[16:19], s76 offen sc1
    s_add_u32 s76, s76, 22528
    s_waitcnt lgkmcnt(0)
    buffer_store_dwordx4 v[38:41], v4, s[16:19], s76 offen sc1
    s_add_u32 s76, s76, 22528
    s_mov_b64 exec, -1
    s_nop 1
    v_mul_f32_e64 v126, v126, |v126|
    v_mul_f32_e64 v127, v127, |v127|
    v_mul_f32_e64 v128, v128, |v128|
    v_mul_f32_e64 v129, v129, |v129|
    v_cvt_pk_bf16_f32 v126, v126, v127
    v_cvt_pk_bf16_f32 v127, v128, v129
    v_pk_max_i16 v126, v126, 0
    v_pk_max_i16 v127, v127, 0
    v_mul_f32_e64 v142, v142, |v142|
    v_mul_f32_e64 v143, v143, |v143|
    v_mul_f32_e64 v144, v144, |v144|
    v_mul_f32_e64 v145, v145, |v145|
    v_cvt_pk_bf16_f32 v142, v142, v143
    v_cvt_pk_bf16_f32 v143, v144, v145
    v_pk_max_i16 v142, v142, 0
    v_pk_max_i16 v143, v143, 0
    v_mul_f32_e64 v158, v158, |v158|
    v_mul_f32_e64 v159, v159, |v159|
    v_mul_f32_e64 v160, v160, |v160|
    v_mul_f32_e64 v161, v161, |v161|
    v_cvt_pk_bf16_f32 v158, v158, v159
    v_cvt_pk_bf16_f32 v159, v160, v161
    v_pk_max_i16 v158, v158, 0
    v_pk_max_i16 v159, v159, 0
    v_mul_f32_e64 v174, v174, |v174|
    v_mul_f32_e64 v175, v175, |v175|
    v_mul_f32_e64 v176, v176, |v176|
    v_mul_f32_e64 v177, v177, |v177|
    v_cvt_pk_bf16_f32 v174, v174, v175
    v_cvt_pk_bf16_f32 v175, v176, v177
    v_pk_max_i16 v174, v174, 0
    v_pk_max_i16 v175, v175, 0
    v_mul_f32_e64 v190, v190, |v190|
    v_mul_f32_e64 v191, v191, |v191|
    v_mul_f32_e64 v192, v192, |v192|
    v_mul_f32_e64 v193, v193, |v193|
    v_cvt_pk_bf16_f32 v190, v190, v191
    v_cvt_pk_bf16_f32 v191, v192, v193
    v_pk_max_i16 v190, v190, 0
    v_pk_max_i16 v191, v191, 0
    v_mul_f32_e64 v206, v206, |v206|
    v_mul_f32_e64 v207, v207, |v207|
    v_mul_f32_e64 v208, v208, |v208|
    v_mul_f32_e64 v209, v209, |v209|
    v_cvt_pk_bf16_f32 v206, v206, v207
    v_cvt_pk_bf16_f32 v207, v208, v209
    v_pk_max_i16 v206, v206, 0
    v_pk_max_i16 v207, v207, 0
    v_mul_f32_e64 v222, v222, |v222|
    v_mul_f32_e64 v223, v223, |v223|
    v_mul_f32_e64 v224, v224, |v224|
    v_mul_f32_e64 v225, v225, |v225|
    v_cvt_pk_bf16_f32 v222, v222, v223
    v_cvt_pk_bf16_f32 v223, v224, v225
    v_pk_max_i16 v222, v222, 0
    v_pk_max_i16 v223, v223, 0
    ds_write_b64 v2, v[126:127] offset:22272
    ds_write_b64 v2, v[142:143] offset:22304
    ds_write_b64 v2, v[158:159] offset:22336
    ds_write_b64 v2, v[174:175] offset:22368
    ds_write_b64 v2, v[190:191] offset:22400
    ds_write_b64 v2, v[206:207] offset:22432
    ds_write_b64 v2, v[222:223] offset:22464
    s_waitcnt lgkmcnt(0)
    s_barrier
    s_mov_b32 exec_hi, 0x00ffffff
    ds_read_b128 v[26:29], v3 offset:22272
    ds_read_b128 v[30:33], v3 offset:23200
    ds_read_b128 v[34:37], v3 offset:24128
    ds_read_b128 v[38:41], v3 offset:25056
    s_add_u32 s76, s76, 90112
    s_waitcnt lgkmcnt(3)
    buffer_store_dwordx4 v[26:29], v4, s[16:19], s76 offen sc1
    s_add_u32 s76, s76, 22528
    s_waitcnt lgkmcnt(2)
    buffer_store_dwordx4 v[30:33], v4, s[16:19], s76 offen sc1
    s_add_u32 s76, s76, 22528
    s_waitcnt lgkmcnt(1)
    buffer_store_dwordx4 v[34:37], v4, s[16:19], s76 offen sc1
    s_add_u32 s76, s76, 22528
    s_waitcnt lgkmcnt(0)
    buffer_store_dwordx4 v[38:41], v4, s[16:19], s76 offen sc1
    s_add_u32 s76, s76, 22528
    s_mov_b64 exec, -1
    s_and_b32 s76, s2, 7
    s_lshr_b32 s77, s2, 3
    s_lshr_b32 s0, s76, 1
    s_and_b32 s78, s76, 1
    s_lshl_b32 s86, s78, 2
    s_bfe_u32 s78, s77, 0x20002
    s_add_u32 s86, s86, s78
    s_and_b32 s78, s0, 1
    s_xor_b32 s78, s78, 1
    s_lshl_b32 s87, s78, 2
    s_and_b32 s78, s77, 3
    s_add_u32 s87, s87, s78
    s_lshl_b32 s85, s86, 3
    s_add_u32 s85, s85, s87
    s_lshr_b32 s80, s28, 2
    s_and_b32 s81, s28, 3
    s_mov_b32 s24, s64
    s_mov_b32 s25, s65
    s_mov_b32 s26, 7340032
    s_mov_b32 s27, 0x20000
    s_lshr_b32 s76, s0, 1
    s_cmp_eq_u32 s76, 0
    s_cselect_b32 s8, s50, s52
    s_cselect_b32 s9, s51, s53
    s_mov_b32 s10, 2097152
    s_mov_b32 s11, 0x20000
    v_and_b32 v2, 7, v0
    v_lshrrev_b32 v3, 4, v0
    v_xor_b32 v2, v2, v3
    v_lshlrev_b32 v2, 4, v2
    v_lshrrev_b32 v3, 3, v0
    v_lshl_add_u32 v5, v3, 11, v2
    s_lshl_b32 s76, s87, 7
    s_lshl_b32 s77, s28, 4
    s_add_u32 s76, s76, s77
    s_lshl_b32 s76, s76, 11
    v_add_u32 v10, s76, v5
    s_lshl_b32 s76, s87, 7
    s_lshl_b32 s77, s28, 4
    s_add_u32 s76, s76, s77
    s_add_u32 s76, s76, 8
    s_lshl_b32 s76, s76, 11
    s_sub_u32 s76, s76, 1024
    v_xor_b32 v11, 64, v5
    v_add_u32 v11, s76, v11
    s_lshl_b32 s38, s28, 11
    s_lshl_b32 s76, s87, 8
    s_mul_i32 s88, s28, 2
    s_add_u32 s89, s88, 0
    s_lshl_b32 s89, s89, 6
    v_add_u32 v6, s89, v0
    v_lshrrev_b32 v7, 4, v6
    v_and_b32 v6, 15, v6
    v_and_b32 v8, 3, v7
    v_bfe_u32 v9, v7, 3, 1
    v_lshl_or_b32 v8, v9, 2, v8
    v_lshlrev_b32 v8, 1, v8
    v_xor_b32 v6, v6, v8
    v_mul_u32_u24 v7, 2048, v7
    v_lshl_add_u32 v6, v6, 4, v7
    v_add_u32 v15, s76, v6
    s_add_u32 s89, s88, 1
    s_lshl_b32 s89, s89, 6
    v_add_u32 v6, s89, v0
    v_lshrrev_b32 v7, 4, v6
    v_and_b32 v6, 15, v6
    v_and_b32 v8, 3, v7
    v_bfe_u32 v9, v7, 3, 1
    v_lshl_or_b32 v8, v9, 2, v8
    v_lshlrev_b32 v8, 1, v8
    v_xor_b32 v6, v6, v8
    v_mul_u32_u24 v7, 2048, v7
    v_lshl_add_u32 v6, v6, 4, v7
    s_sub_u32 s89, s76, 1024
    v_add_u32 v16, s89, v6
    s_mul_i32 s83, s28, 2
    s_lshl_b32 s83, s83, 10
    v_lshrrev_b32 v3, 3, v0
    v_mul_u32_u24 v3, 11264, v3
    v_add_u32 v5, v3, v2
    s_mul_i32 s76, s28, 32
    s_lshr_b32 s77, s76, 4
    s_add_u32 s77, s77, s0
    s_and_b32 s77, s77, 3
    s_lshl_b32 s77, s77, 4
    s_andn2_b32 s76, s76, 48
    s_or_b32 s76, s76, s77
    s_mul_i32 s77, s86, 256
    s_add_u32 s76, s76, s77
    s_mul_i32 s76, s76, 11264
    v_add_u32 v25, s76, v5
    s_mul_i32 s76, s28, 32
    s_add_u32 s76, s76, 8
    s_lshr_b32 s77, s76, 4
    s_add_u32 s77, s77, s0
    s_and_b32 s77, s77, 3
    s_lshl_b32 s77, s77, 4
    s_andn2_b32 s76, s76, 48
    s_or_b32 s76, s76, s77
    s_mul_i32 s77, s86, 256
    s_add_u32 s76, s76, s77
    s_mul_i32 s76, s76, 11264
    s_sub_u32 s76, s76, 1024
    v_xor_b32 v26, 64, v5
    v_add_u32 v26, s76, v26
    s_mul_i32 s76, s28, 32
    s_add_u32 s76, s76, 16
    s_lshr_b32 s77, s76, 4
    s_add_u32 s77, s77, s0
    s_and_b32 s77, s77, 3
    s_lshl_b32 s77, s77, 4
    s_andn2_b32 s76, s76, 48
    s_or_b32 s76, s76, s77
    s_mul_i32 s77, s86, 256
    s_add_u32 s76, s76, s77
    s_mul_i32 s76, s76, 11264
    s_sub_u32 s76, s76, 2048
    v_add_u32 v27, s76, v5
    s_mul_i32 s76, s28, 32
    s_add_u32 s76, s76, 24
    s_lshr_b32 s77, s76, 4
    s_add_u32 s77, s77, s0
    s_and_b32 s77, s77, 3
    s_lshl_b32 s77, s77, 4
    s_andn2_b32 s76, s76, 48
    s_or_b32 s76, s76, s77
    s_mul_i32 s77, s86, 256
    s_add_u32 s76, s76, s77
    s_mul_i32 s76, s76, 11264
    s_sub_u32 s76, s76, 3072
    v_xor_b32 v28, 64, v5
    v_add_u32 v28, s76, v28
    s_mul_i32 s39, s28, 4096
    s_add_u32 s39, s39, 16384
    s_mul_i32 s37, s0, 1024
    s_and_b32 s36, s37, 2047
    s_lshr_b32 s76, s0, 1
    s_mul_i32 s76, s76, 28
    s_and_b32 s77, s0, 1
    s_mul_i32 s77, s77, 16
    s_add_u32 s76, s76, s77
    s_mul_i32 s84, s76, 131072
    s_lshl_b32 s3, s76, 7
    s_add_u32 s3, s3, 4096
    s_mul_i32 s76, s80, 4
    v_and_b32 v2, 15, v0
    v_lshrrev_b32 v3, 4, v0
    v_lshrrev_b32 v4, 1, v2
    v_xor_b32 v3, v3, v4
    v_lshlrev_b32 v3, 4, v3
    v_lshl_add_u32 v2, v2, 7, v3
    s_lshl_b32 s88, s76, 11
    v_add_u32 v12, s88, v2
    v_lshrrev_b32 v2, 4, v0
    v_lshlrev_b32 v2, 3, v2
    v_bfe_u32 v3, v0, 2, 2
    v_add_u32 v2, v2, v3
    v_and_b32 v3, 3, v2
    v_bfe_u32 v4, v2, 3, 1
    v_lshl_or_b32 v3, v4, 2, v3
    v_mul_u32_u24 v2, 256, v2
    v_and_b32 v4, 3, v0
    v_lshl_add_u32 v2, v4, 3, v2
    s_add_u32 s88, s76, 0
    v_xor_b32 v4, s88, v3
    v_lshl_add_u32 v17, v4, 5, v2
    s_add_u32 s88, s76, 1
    v_xor_b32 v4, s88, v3
    v_subrev_u32 v4, 1, v4
    v_lshl_add_u32 v18, v4, 5, v2
    s_add_u32 s88, s76, 2
    v_xor_b32 v4, s88, v3
    v_subrev_u32 v4, 2, v4
    v_lshl_add_u32 v19, v4, 5, v2
    s_add_u32 s88, s76, 3
    v_xor_b32 v4, s88, v3
    v_subrev_u32 v4, 3, v4
    v_lshl_add_u32 v20, v4, 5, v2
    s_mul_i32 s76, s81, 4
    v_and_b32 v2, 15, v0
    v_lshrrev_b32 v3, 4, v0
    v_lshrrev_b32 v4, 1, v2
    v_xor_b32 v3, v3, v4
    v_lshlrev_b32 v3, 4, v3
    v_lshl_add_u32 v2, v2, 7, v3
    s_lshl_b32 s88, s76, 11
    s_add_u32 s88, s88, 16384
    v_add_u32 v29, s88, v2
    s_barrier
    s_mov_b32 s32, 0
    s_add_u32 s35, s32, s38
    s_mov_b32 m0, s35
    s_nop 0
    buffer_load_dwordx4 v10, s[8:11], s36 offen lds
    buffer_load_dwordx4 v11, s[8:11], s36 offen offset:1024 lds
    s_add_u32 s36, s36, 128
    s_add_u32 s32, s32, 49152
    s_add_u32 s35, s32, s38
    s_mov_b32 m0, s35
    s_nop 0
    buffer_load_dwordx4 v10, s[8:11], s36 offen lds
    buffer_load_dwordx4 v11, s[8:11], s36 offen offset:1024 lds
    s_add_u32 s36, s36, 128
    s_add_u32 s32, s32, 49152
    s_add_u32 s35, s32, s38
    s_mov_b32 m0, s35
    s_nop 0
    buffer_load_dwordx4 v10, s[8:11], s36 offen lds
    buffer_load_dwordx4 v11, s[8:11], s36 offen offset:1024 lds
    s_add_u32 s36, s36, 128
    s_add_u32 s32, s32, 49152
    s_waitcnt vmcnt(6)
    s_barrier
    s_cmp_eq_u32 s28, 1
    s_cbranch_scc1 L_p2B_pl
    s_cmp_lg_u32 s28, 0
    s_cbranch_scc1 L_p2B_dep
    v_readfirstlane_b32 s88, v1
    s_nop 3
    s_cmp_ge_u32 s88, 256
    s_cbranch_scc1 L_ic14
    s_mov_b32 s79, 0
    v_mov_b32 v6, s79
    s_mov_b32 s90, 300000
L_poll15:
    s_sub_u32 s90, s90, 1
    s_cmp_eq_u32 s90, 0
    s_cbranch_scc1 L_pok16
    buffer_load_dword v2, v6, s[20:23], 0 offen sc1
    s_waitcnt vmcnt(0)
    v_readfirstlane_b32 s88, v2
    s_nop 3
    s_cmp_ge_u32 s88, 256
    s_cbranch_scc1 L_pok16
    s_sleep 32
    s_branch L_poll15
L_pok16:
L_ic14:
    v_mov_b32 v3, s29
    v_bfe_u32 v5, v0, 3, 2
    v_lshrrev_b32 v4, 2, v3
    v_mad_u32_u24 v4, v5, 2, v4
    v_and_b32 v3, 3, v3
    v_lshlrev_b32 v3, 2, v3
    v_and_b32 v2, 3, v0
    v_or_b32 v3, v3, v2
    v_bfe_u32 v2, v0, 2, 1
    v_and_b32 v5, 1, v5
    v_xor_b32 v2, v2, v5
    v_xor_b32 v2, 1, v2
    v_lshl_or_b32 v3, v2, 4, v3
    v_lshl_or_b32 v3, v3, 3, v4
    v_lshlrev_b32 v3, 8, v3
    v_mov_b32 v2, 1
    s_mov_b32 s76, 25362440
    s_mov_b32 exec_hi, 0
    buffer_atomic_add v2, v3, s[16:19], s76 offen sc1
    s_mov_b64 exec, -1
    s_branch L_p2B_dep
L_p2B_pl:
    s_lshl_b32 s79, s2, 8
    s_add_u32 s79, s79, 25362432
    v_mov_b32 v6, s79
    s_mov_b32 s90, 300000
L_poll17:
    s_sub_u32 s90, s90, 1
    s_cmp_eq_u32 s90, 0
    s_cbranch_scc1 L_pok18
    buffer_load_dwordx4 v[2:5], v6, s[16:19], 0 offen sc1
    s_waitcnt vmcnt(0)
    v_readfirstlane_b32 s88, v2
    v_readfirstlane_b32 s89, v3
    v_readfirstlane_b32 s91, v4
    s_nop 3
    s_bitcmp1_b32 s0, 0
    s_cselect_b32 s49, s89, s88
    s_and_b32 s88, s49, 7
    s_cmp_eq_u32 s88, 7
    s_cbranch_scc1 L_pok18
    s_sleep 2
    s_branch L_poll17
L_pok18:
L_p2B_dep:
    s_barrier
    s_mov_b32 s32, 0
    s_add_u32 s35, s32, s39
    s_mov_b32 m0, s35
    s_nop 0
    buffer_load_dwordx4 v25, s[16:19], s37 offen sc1 lds
    buffer_load_dwordx4 v26, s[16:19], s37 offen offset:1024 sc1 lds
    buffer_load_dwordx4 v27, s[16:19], s37 offen offset:2048 sc1 lds
    buffer_load_dwordx4 v28, s[16:19], s37 offen offset:3072 sc1 lds
    s_add_u32 s37, s37, 128
    s_add_u32 s32, s32, 49152
    s_add_u32 s35, s32, s39
    s_mov_b32 m0, s35
    s_nop 0
    buffer_load_dwordx4 v25, s[16:19], s37 offen sc1 lds
    buffer_load_dwordx4 v26, s[16:19], s37 offen offset:1024 sc1 lds
    buffer_load_dwordx4 v27, s[16:19], s37 offen offset:2048 sc1 lds
    buffer_load_dwordx4 v28, s[16:19], s37 offen offset:3072 sc1 lds
    s_add_u32 s37, s37, 128
    s_add_u32 s32, s32, 49152
    s_add_u32 s32, s32, 49152
    s_waitcnt vmcnt(4)
    s_barrier
    v_mov_b32 v13, v12
    v_xor_b32 v14, 64, v12
    v_mov_b32 v30, v29
    v_xor_b32 v31, 64, v29
    v_mov_b32 v21, v17
    v_mov_b32 v22, v18
    v_mov_b32 v23, v19
    v_mov_b32 v24, v20
    s_mov_b32 s33, 0
    s_mov_b32 s32, 98304
    ds_read_b128 v[32:35], v13 offset:0
    ds_read_b128 v[48:51], v30 offset:0
    ds_read_b128 v[36:39], v13 offset:2048
    ds_read_b128 v[52:55], v30 offset:2048
    ds_read_b128 v[40:43], v13 offset:4096
    ds_read_b128 v[56:59], v30 offset:4096
    ds_read_b128 v[44:47], v13 offset:6144
    ds_read_b128 v[60:63], v30 offset:6144
    s_mov_b32 s31, s32
    s_mov_b32 s32, s33
    s_add_u32 s33, s33, 49152
    s_cmp_eq_u32 s33, 147456
    s_cselect_b32 s33, 0, s33
    s_waitcnt lgkmcnt(0)
    v_mfma_f32_16x16x32_bf16 v[160:163], v[32:35], v[48:51], 0
    ds_read_b128 v[64:67], v14 offset:0
    v_mfma_f32_16x16x32_bf16 v[164:167], v[32:35], v[52:55], 0
    s_add_u32 s35, s31, s39
    s_mov_b32 m0, s35
    s_nop 0
    buffer_load_dwordx4 v25, s[16:19], s37 offen sc1 lds
    v_mfma_f32_16x16x32_bf16 v[168:171], v[32:35], v[56:59], 0
    ds_read_b128 v[80:83], v31 offset:0
    v_mfma_f32_16x16x32_bf16 v[172:175], v[32:35], v[60:63], 0
    buffer_load_dwordx4 v26, s[16:19], s37 offen offset:1024 sc1 lds
    v_mfma_f32_16x16x32_bf16 v[176:179], v[36:39], v[48:51], 0
    ds_read_b128 v[68:71], v14 offset:2048
    v_mfma_f32_16x16x32_bf16 v[180:183], v[36:39], v[52:55], 0
    ds_read_b128 v[84:87], v31 offset:2048
    v_mfma_f32_16x16x32_bf16 v[184:187], v[36:39], v[56:59], 0
    buffer_load_dwordx4 v27, s[16:19], s37 offen offset:2048 sc1 lds
    v_mfma_f32_16x16x32_bf16 v[188:191], v[36:39], v[60:63], 0
    v_mfma_f32_16x16x32_bf16 v[192:195], v[40:43], v[48:51], 0
    ds_read_b128 v[72:75], v14 offset:4096
    v_mfma_f32_16x16x32_bf16 v[196:199], v[40:43], v[52:55], 0
    ds_read_b128 v[88:91], v31 offset:4096
    v_mfma_f32_16x16x32_bf16 v[200:203], v[40:43], v[56:59], 0
    buffer_load_dwordx4 v28, s[16:19], s37 offen offset:3072 sc1 lds
    v_mfma_f32_16x16x32_bf16 v[204:207], v[40:43], v[60:63], 0
    ds_read_b128 v[76:79], v14 offset:6144
    v_mfma_f32_16x16x32_bf16 v[208:211], v[44:47], v[48:51], 0
    ds_read_b128 v[92:95], v31 offset:6144
    v_mfma_f32_16x16x32_bf16 v[212:215], v[44:47], v[52:55], 0
    s_add_u32 s37, s37, 128
    v_mfma_f32_16x16x32_bf16 v[216:219], v[44:47], v[56:59], 0
    v_add_u32 v13, s33, v12
    v_add_u32 v30, s33, v29
    v_mfma_f32_16x16x32_bf16 v[220:223], v[44:47], v[60:63], 0
    s_cmp_lg_u32 s28, 1
    s_cbranch_scc1 L_hs19
    s_bitcmp1_b32 s49, 3
    s_cbranch_scc1 L_hs19
    s_lshl_b32 s79, s2, 8
    s_add_u32 s79, s79, 25362432
    v_mov_b32 v6, s79
    s_mov_b32 s90, 300000
L_poll20:
    s_sub_u32 s90, s90, 1
    s_cmp_eq_u32 s90, 0
    s_cbranch_scc1 L_pok21
    buffer_load_dwordx4 v[2:5], v6, s[16:19], 0 offen sc1
    s_waitcnt vmcnt(0)
    v_readfirstlane_b32 s88, v2
    v_readfirstlane_b32 s89, v3
    v_readfirstlane_b32 s91, v4
    s_nop 3
    s_bitcmp1_b32 s0, 0
    s_cselect_b32 s49, s89, s88
    s_and_b32 s88, s49, 8
    s_cmp_eq_u32 s88, 8
    s_cbranch_scc1 L_pok21
    s_sleep 2
    s_branch L_poll20
L_pok21:
L_hs19:
    s_waitcnt vmcnt(4) lgkmcnt(0)
    s_barrier
    s_setprio 1
    v_mfma_f32_16x16x32_bf16 v[160:163], v[64:67], v[80:83], v[160:163]
    ds_read_b128 v[32:35], v13 offset:0
    v_mfma_f32_16x16x32_bf16 v[164:167], v[64:67], v[84:87], v[164:167]
    s_add_u32 s35, s32, s38
    s_mov_b32 m0, s35
    s_nop 0
    buffer_load_dwordx4 v10, s[8:11], s36 offen lds
    v_mfma_f32_16x16x32_bf16 v[168:171], v[64:67], v[88:91], v[168:171]
    ds_read_b128 v[48:51], v30 offset:0
    v_mfma_f32_16x16x32_bf16 v[172:175], v[64:67], v[92:95], v[172:175]
    v_mfma_f32_16x16x32_bf16 v[176:179], v[68:71], v[80:83], v[176:179]
    ds_read_b128 v[36:39], v13 offset:2048
    v_mfma_f32_16x16x32_bf16 v[180:183], v[68:71], v[84:87], v[180:183]
    buffer_load_dwordx4 v11, s[8:11], s36 offen offset:1024 lds
    v_mfma_f32_16x16x32_bf16 v[184:187], v[68:71], v[88:91], v[184:187]
    ds_read_b128 v[52:55], v30 offset:2048
    v_mfma_f32_16x16x32_bf16 v[188:191], v[68:71], v[92:95], v[188:191]
    v_mfma_f32_16x16x32_bf16 v[192:195], v[72:75], v[80:83], v[192:195]
    ds_read_b128 v[40:43], v13 offset:4096
    v_mfma_f32_16x16x32_bf16 v[196:199], v[72:75], v[84:87], v[196:199]
    ds_read_b128 v[56:59], v30 offset:4096
    v_mfma_f32_16x16x32_bf16 v[200:203], v[72:75], v[88:91], v[200:203]
    s_add_u32 s36, s36, 128
    v_mfma_f32_16x16x32_bf16 v[204:207], v[72:75], v[92:95], v[204:207]
    v_mfma_f32_16x16x32_bf16 v[208:211], v[76:79], v[80:83], v[208:211]
    ds_read_b128 v[44:47], v13 offset:6144
    v_mfma_f32_16x16x32_bf16 v[212:215], v[76:79], v[84:87], v[212:215]
    ds_read_b128 v[60:63], v30 offset:6144
    v_mfma_f32_16x16x32_bf16 v[216:219], v[76:79], v[88:91], v[216:219]
    v_xor_b32 v14, 64, v13
    v_xor_b32 v31, 64, v30
    v_mfma_f32_16x16x32_bf16 v[220:223], v[76:79], v[92:95], v[220:223]
    s_setprio 0
    s_mov_b32 s31, s32
    s_mov_b32 s32, s33
    s_add_u32 s33, s33, 49152
    s_cmp_eq_u32 s33, 147456
    s_cselect_b32 s33, 0, s33
    s_waitcnt lgkmcnt(0)
    v_mfma_f32_16x16x32_bf16 v[160:163], v[32:35], v[48:51], v[160:163]
    ds_read_b128 v[64:67], v14 offset:0
    v_mfma_f32_16x16x32_bf16 v[164:167], v[32:35], v[52:55], v[164:167]
    s_add_u32 s35, s31, s39
    s_mov_b32 m0, s35
    s_nop 0
    buffer_load_dwordx4 v25, s[16:19], s37 offen sc1 lds
    v_mfma_f32_16x16x32_bf16 v[168:171], v[32:35], v[56:59], v[168:171]
    ds_read_b128 v[80:83], v31 offset:0
    v_mfma_f32_16x16x32_bf16 v[172:175], v[32:35], v[60:63], v[172:175]
    buffer_load_dwordx4 v26, s[16:19], s37 offen offset:1024 sc1 lds
    v_mfma_f32_16x16x32_bf16 v[176:179], v[36:39], v[48:51], v[176:179]
    ds_read_b128 v[68:71], v14 offset:2048
    v_mfma_f32_16x16x32_bf16 v[180:183], v[36:39], v[52:55], v[180:183]
    ds_read_b128 v[84:87], v31 offset:2048
    v_mfma_f32_16x16x32_bf16 v[184:187], v[36:39], v[56:59], v[184:187]
    buffer_load_dwordx4 v27, s[16:19], s37 offen offset:2048 sc1 lds
    v_mfma_f32_16x16x32_bf16 v[188:191], v[36:39], v[60:63], v[188:191]
    v_mfma_f32_16x16x32_bf16 v[192:195], v[40:43], v[48:51], v[192:195]
    ds_read_b128 v[72:75], v14 offset:4096
    v_mfma_f32_16x16x32_bf16 v[196:199], v[40:43], v[52:55], v[196:199]
    ds_read_b128 v[88:91], v31 offset:4096
    v_mfma_f32_16x16x32_bf16 v[200:203], v[40:43], v[56:59], v[200:203]
    buffer_load_dwordx4 v28, s[16:19], s37 offen offset:3072 sc1 lds
    v_mfma_f32_16x16x32_bf16 v[204:207], v[40:43], v[60:63], v[204:207]
    ds_read_b128 v[76:79], v14 offset:6144
    v_mfma_f32_16x16x32_bf16 v[208:211], v[44:47], v[48:51], v[208:211]
    ds_read_b128 v[92:95], v31 offset:6144
    v_mfma_f32_16x16x32_bf16 v[212:215], v[44:47], v[52:55], v[212:215]
    s_add_u32 s37, s37, 128
    v_mfma_f32_16x16x32_bf16 v[216:219], v[44:47], v[56:59], v[216:219]
    v_add_u32 v13, s33, v12
    v_add_u32 v30, s33, v29
    v_mfma_f32_16x16x32_bf16 v[220:223], v[44:47], v[60:63], v[220:223]
    s_cmp_lg_u32 s28, 1
    s_cbranch_scc1 L_hs22
    s_bitcmp1_b32 s49, 4
    s_cbranch_scc1 L_hs22
    s_lshl_b32 s79, s2, 8
    s_add_u32 s79, s79, 25362432
    v_mov_b32 v6, s79
    s_mov_b32 s90, 300000
L_poll23:
    s_sub_u32 s90, s90, 1
    s_cmp_eq_u32 s90, 0
    s_cbranch_scc1 L_pok24
    buffer_load_dwordx4 v[2:5], v6, s[16:19], 0 offen sc1
    s_waitcnt vmcnt(0)
    v_readfirstlane_b32 s88, v2
    v_readfirstlane_b32 s89, v3
    v_readfirstlane_b32 s91, v4
    s_nop 3
    s_bitcmp1_b32 s0, 0
    s_cselect_b32 s49, s89, s88
    s_and_b32 s88, s49, 16
    s_cmp_eq_u32 s88, 16
    s_cbranch_scc1 L_pok24
    s_sleep 2
    s_branch L_poll23
L_pok24:
L_hs22:
    s_waitcnt vmcnt(6) lgkmcnt(0)
    s_barrier
    s_setprio 1
    v_mfma_f32_16x16x32_bf16 v[160:163], v[64:67], v[80:83], v[160:163]
    ds_read_b128 v[32:35], v13 offset:0
    v_mfma_f32_16x16x32_bf16 v[164:167], v[64:67], v[84:87], v[164:167]
    s_add_u32 s35, s32, s38
    s_mov_b32 m0, s35
    s_nop 0
    buffer_load_dwordx4 v10, s[8:11], s36 offen lds
    v_mfma_f32_16x16x32_bf16 v[168:171], v[64:67], v[88:91], v[168:171]
    ds_read_b128 v[48:51], v30 offset:0
    v_mfma_f32_16x16x32_bf16 v[172:175], v[64:67], v[92:95], v[172:175]
    v_mfma_f32_16x16x32_bf16 v[176:179], v[68:71], v[80:83], v[176:179]
    ds_read_b128 v[36:39], v13 offset:2048
    v_mfma_f32_16x16x32_bf16 v[180:183], v[68:71], v[84:87], v[180:183]
    buffer_load_dwordx4 v11, s[8:11], s36 offen offset:1024 lds
    v_mfma_f32_16x16x32_bf16 v[184:187], v[68:71], v[88:91], v[184:187]
    ds_read_b128 v[52:55], v30 offset:2048
    v_mfma_f32_16x16x32_bf16 v[188:191], v[68:71], v[92:95], v[188:191]
    v_mfma_f32_16x16x32_bf16 v[192:195], v[72:75], v[80:83], v[192:195]
    ds_read_b128 v[40:43], v13 offset:4096
    v_mfma_f32_16x16x32_bf16 v[196:199], v[72:75], v[84:87], v[196:199]
    ds_read_b128 v[56:59], v30 offset:4096
    v_mfma_f32_16x16x32_bf16 v[200:203], v[72:75], v[88:91], v[200:203]
    s_add_u32 s36, s36, 128
    v_mfma_f32_16x16x32_bf16 v[204:207], v[72:75], v[92:95], v[204:207]
    v_mfma_f32_16x16x32_bf16 v[208:211], v[76:79], v[80:83], v[208:211]
    ds_read_b128 v[44:47], v13 offset:6144
    v_mfma_f32_16x16x32_bf16 v[212:215], v[76:79], v[84:87], v[212:215]
    ds_read_b128 v[60:63], v30 offset:6144
    v_mfma_f32_16x16x32_bf16 v[216:219], v[76:79], v[88:91], v[216:219]
    v_xor_b32 v14, 64, v13
    v_xor_b32 v31, 64, v30
    v_mfma_f32_16x16x32_bf16 v[220:223], v[76:79], v[92:95], v[220:223]
    s_setprio 0
    s_mov_b32 s31, s32
    s_mov_b32 s32, s33
    s_add_u32 s33, s33, 49152
    s_cmp_eq_u32 s33, 147456
    s_cselect_b32 s33, 0, s33
    s_waitcnt lgkmcnt(0)
    v_mfma_f32_16x16x32_bf16 v[160:163], v[32:35], v[48:51], v[160:163]
    ds_read_b128 v[64:67], v14 offset:0
    v_mfma_f32_16x16x32_bf16 v[164:167], v[32:35], v[52:55], v[164:167]
    s_add_u32 s35, s31, s39
    s_mov_b32 m0, s35
    s_nop 0
    buffer_load_dwordx4 v25, s[16:19], s37 offen sc1 lds
    v_mfma_f32_16x16x32_bf16 v[168:171], v[32:35], v[56:59], v[168:171]
    ds_read_b128 v[80:83], v31 offset:0
    v_mfma_f32_16x16x32_bf16 v[172:175], v[32:35], v[60:63], v[172:175]
    buffer_load_dwordx4 v26, s[16:19], s37 offen offset:1024 sc1 lds
    v_mfma_f32_16x16x32_bf16 v[176:179], v[36:39], v[48:51], v[176:179]
    ds_read_b128 v[68:71], v14 offset:2048
    v_mfma_f32_16x16x32_bf16 v[180:183], v[36:39], v[52:55], v[180:183]
    ds_read_b128 v[84:87], v31 offset:2048
    v_mfma_f32_16x16x32_bf16 v[184:187], v[36:39], v[56:59], v[184:187]
    buffer_load_dwordx4 v27, s[16:19], s37 offen offset:2048 sc1 lds
    v_mfma_f32_16x16x32_bf16 v[188:191], v[36:39], v[60:63], v[188:191]
    v_mfma_f32_16x16x32_bf16 v[192:195], v[40:43], v[48:51], v[192:195]
    ds_read_b128 v[72:75], v14 offset:4096
    v_mfma_f32_16x16x32_bf16 v[196:199], v[40:43], v[52:55], v[196:199]
    ds_read_b128 v[88:91], v31 offset:4096
    v_mfma_f32_16x16x32_bf16 v[200:203], v[40:43], v[56:59], v[200:203]
    buffer_load_dwordx4 v28, s[16:19], s37 offen offset:3072 sc1 lds
    v_mfma_f32_16x16x32_bf16 v[204:207], v[40:43], v[60:63], v[204:207]
    ds_read_b128 v[76:79], v14 offset:6144
    v_mfma_f32_16x16x32_bf16 v[208:211], v[44:47], v[48:51], v[208:211]
    ds_read_b128 v[92:95], v31 offset:6144
    v_mfma_f32_16x16x32_bf16 v[212:215], v[44:47], v[52:55], v[212:215]
    s_add_u32 s37, s37, 128
    v_mfma_f32_16x16x32_bf16 v[216:219], v[44:47], v[56:59], v[216:219]
    v_add_u32 v13, s33, v12
    v_add_u32 v30, s33, v29
    v_mfma_f32_16x16x32_bf16 v[220:223], v[44:47], v[60:63], v[220:223]
    s_cmp_lg_u32 s28, 1
    s_cbranch_scc1 L_hs25
    s_bitcmp1_b32 s49, 5
    s_cbranch_scc1 L_hs25
    s_lshl_b32 s79, s2, 8
    s_add_u32 s79, s79, 25362432
    v_mov_b32 v6, s79
    s_mov_b32 s90, 300000
L_poll26:
    s_sub_u32 s90, s90, 1
    s_cmp_eq_u32 s90, 0
    s_cbranch_scc1 L_pok27
    buffer_load_dwordx4 v[2:5], v6, s[16:19], 0 offen sc1
    s_waitcnt vmcnt(0)
    v_readfirstlane_b32 s88, v2
    v_readfirstlane_b32 s89, v3
    v_readfirstlane_b32 s91, v4
    s_nop 3
    s_bitcmp1_b32 s0, 0
    s_cselect_b32 s49, s89, s88
    s_and_b32 s88, s49, 32
    s_cmp_eq_u32 s88, 32
    s_cbranch_scc1 L_pok27
    s_sleep 2
    s_branch L_poll26
L_pok27:
L_hs25:
    s_waitcnt vmcnt(6) lgkmcnt(0)
    s_barrier
    s_setprio 1
    v_mfma_f32_16x16x32_bf16 v[160:163], v[64:67], v[80:83], v[160:163]
    ds_read_b128 v[32:35], v13 offset:0
    v_mfma_f32_16x16x32_bf16 v[164:167], v[64:67], v[84:87], v[164:167]
    s_add_u32 s35, s32, s38
    s_mov_b32 m0, s35
    s_nop 0
    buffer_load_dwordx4 v10, s[8:11], s36 offen lds
    v_mfma_f32_16x16x32_bf16 v[168:171], v[64:67], v[88:91], v[168:171]
    ds_read_b128 v[48:51], v30 offset:0
    v_mfma_f32_16x16x32_bf16 v[172:175], v[64:67], v[92:95], v[172:175]
    v_mfma_f32_16x16x32_bf16 v[176:179], v[68:71], v[80:83], v[176:179]
    ds_read_b128 v[36:39], v13 offset:2048
    v_mfma_f32_16x16x32_bf16 v[180:183], v[68:71], v[84:87], v[180:183]
    buffer_load_dwordx4 v11, s[8:11], s36 offen offset:1024 lds
    v_mfma_f32_16x16x32_bf16 v[184:187], v[68:71], v[88:91], v[184:187]
    ds_read_b128 v[52:55], v30 offset:2048
    v_mfma_f32_16x16x32_bf16 v[188:191], v[68:71], v[92:95], v[188:191]
    v_mfma_f32_16x16x32_bf16 v[192:195], v[72:75], v[80:83], v[192:195]
    ds_read_b128 v[40:43], v13 offset:4096
    v_mfma_f32_16x16x32_bf16 v[196:199], v[72:75], v[84:87], v[196:199]
    ds_read_b128 v[56:59], v30 offset:4096
    v_mfma_f32_16x16x32_bf16 v[200:203], v[72:75], v[88:91], v[200:203]
    s_add_u32 s36, s36, 128
    v_mfma_f32_16x16x32_bf16 v[204:207], v[72:75], v[92:95], v[204:207]
    v_mfma_f32_16x16x32_bf16 v[208:211], v[76:79], v[80:83], v[208:211]
    ds_read_b128 v[44:47], v13 offset:6144
    v_mfma_f32_16x16x32_bf16 v[212:215], v[76:79], v[84:87], v[212:215]
    ds_read_b128 v[60:63], v30 offset:6144
    v_mfma_f32_16x16x32_bf16 v[216:219], v[76:79], v[88:91], v[216:219]
    v_xor_b32 v14, 64, v13
    v_xor_b32 v31, 64, v30
    v_mfma_f32_16x16x32_bf16 v[220:223], v[76:79], v[92:95], v[220:223]
    s_setprio 0
    s_mov_b32 s31, s32
    s_mov_b32 s32, s33
    s_add_u32 s33, s33, 49152
    s_cmp_eq_u32 s33, 147456
    s_cselect_b32 s33, 0, s33
    s_waitcnt lgkmcnt(0)
    v_mfma_f32_16x16x32_bf16 v[160:163], v[32:35], v[48:51], v[160:163]
    ds_read_b128 v[64:67], v14 offset:0
    v_mfma_f32_16x16x32_bf16 v[164:167], v[32:35], v[52:55], v[164:167]
    s_add_u32 s35, s31, s39
    s_mov_b32 m0, s35
    s_nop 0
    buffer_load_dwordx4 v25, s[16:19], s37 offen sc1 lds
    v_mfma_f32_16x16x32_bf16 v[168:171], v[32:35], v[56:59], v[168:171]
    ds_read_b128 v[80:83], v31 offset:0
    v_mfma_f32_16x16x32_bf16 v[172:175], v[32:35], v[60:63], v[172:175]
    buffer_load_dwordx4 v26, s[16:19], s37 offen offset:1024 sc1 lds
    v_mfma_f32_16x16x32_bf16 v[176:179], v[36:39], v[48:51], v[176:179]
    ds_read_b128 v[68:71], v14 offset:2048
    v_mfma_f32_16x16x32_bf16 v[180:183], v[36:39], v[52:55], v[180:183]
    ds_read_b128 v[84:87], v31 offset:2048
    v_mfma_f32_16x16x32_bf16 v[184:187], v[36:39], v[56:59], v[184:187]
    buffer_load_dwordx4 v27, s[16:19], s37 offen offset:2048 sc1 lds
    v_mfma_f32_16x16x32_bf16 v[188:191], v[36:39], v[60:63], v[188:191]
    v_mfma_f32_16x16x32_bf16 v[192:195], v[40:43], v[48:51], v[192:195]
    ds_read_b128 v[72:75], v14 offset:4096
    v_mfma_f32_16x16x32_bf16 v[196:199], v[40:43], v[52:55], v[196:199]
    ds_read_b128 v[88:91], v31 offset:4096
    v_mfma_f32_16x16x32_bf16 v[200:203], v[40:43], v[56:59], v[200:203]
    buffer_load_dwordx4 v28, s[16:19], s37 offen offset:3072 sc1 lds
    v_mfma_f32_16x16x32_bf16 v[204:207], v[40:43], v[60:63], v[204:207]
    ds_read_b128 v[76:79], v14 offset:6144
    v_mfma_f32_16x16x32_bf16 v[208:211], v[44:47], v[48:51], v[208:211]
    ds_read_b128 v[92:95], v31 offset:6144
    v_mfma_f32_16x16x32_bf16 v[212:215], v[44:47], v[52:55], v[212:215]
    s_add_u32 s37, s37, 128
    v_mfma_f32_16x16x32_bf16 v[216:219], v[44:47], v[56:59], v[216:219]
    v_add_u32 v13, s33, v12
    v_add_u32 v30, s33, v29
    v_mfma_f32_16x16x32_bf16 v[220:223], v[44:47], v[60:63], v[220:223]
    s_cmp_lg_u32 s28, 1
    s_cbranch_scc1 L_hs28
    s_bitcmp1_b32 s49, 6
    s_cbranch_scc1 L_hs28
    s_lshl_b32 s79, s2, 8
    s_add_u32 s79, s79, 25362432
    v_mov_b32 v6, s79
    s_mov_b32 s90, 300000
L_poll29:
    s_sub_u32 s90, s90, 1
    s_cmp_eq_u32 s90, 0
    s_cbranch_scc1 L_pok30
    buffer_load_dwordx4 v[2:5], v6, s[16:19], 0 offen sc1
    s_waitcnt vmcnt(0)
    v_readfirstlane_b32 s88, v2
    v_readfirstlane_b32 s89, v3
    v_readfirstlane_b32 s91, v4
    s_nop 3
    s_bitcmp1_b32 s0, 0
    s_cselect_b32 s49, s89, s88
    s_and_b32 s88, s49, 64
    s_cmp_eq_u32 s88, 64
    s_cbranch_scc1 L_pok30
    s_sleep 2
    s_branch L_poll29
L_pok30:
L_hs28:
    s_waitcnt vmcnt(6) lgkmcnt(0)
    s_barrier
    s_setprio 1
    v_mfma_f32_16x16x32_bf16 v[160:163], v[64:67], v[80:83], v[160:163]
    ds_read_b128 v[32:35], v13 offset:0
    v_mfma_f32_16x16x32_bf16 v[164:167], v[64:67], v[84:87], v[164:167]
    s_add_u32 s35, s32, s38
    s_mov_b32 m0, s35
    s_nop 0
    buffer_load_dwordx4 v10, s[8:11], s36 offen lds
    v_mfma_f32_16x16x32_bf16 v[168:171], v[64:67], v[88:91], v[168:171]
    ds_read_b128 v[48:51], v30 offset:0
    v_mfma_f32_16x16x32_bf16 v[172:175], v[64:67], v[92:95], v[172:175]
    v_mfma_f32_16x16x32_bf16 v[176:179], v[68:71], v[80:83], v[176:179]
    ds_read_b128 v[36:39], v13 offset:2048
    v_mfma_f32_16x16x32_bf16 v[180:183], v[68:71], v[84:87], v[180:183]
    buffer_load_dwordx4 v11, s[8:11], s36 offen offset:1024 lds
    v_mfma_f32_16x16x32_bf16 v[184:187], v[68:71], v[88:91], v[184:187]
    ds_read_b128 v[52:55], v30 offset:2048
    v_mfma_f32_16x16x32_bf16 v[188:191], v[68:71], v[92:95], v[188:191]
    v_mfma_f32_16x16x32_bf16 v[192:195], v[72:75], v[80:83], v[192:195]
    ds_read_b128 v[40:43], v13 offset:4096
    v_mfma_f32_16x16x32_bf16 v[196:199], v[72:75], v[84:87], v[196:199]
    ds_read_b128 v[56:59], v30 offset:4096
    v_mfma_f32_16x16x32_bf16 v[200:203], v[72:75], v[88:91], v[200:203]
    s_add_u32 s36, s36, 128
    v_mfma_f32_16x16x32_bf16 v[204:207], v[72:75], v[92:95], v[204:207]
    v_mfma_f32_16x16x32_bf16 v[208:211], v[76:79], v[80:83], v[208:211]
    ds_read_b128 v[44:47], v13 offset:6144
    v_mfma_f32_16x16x32_bf16 v[212:215], v[76:79], v[84:87], v[212:215]
    ds_read_b128 v[60:63], v30 offset:6144
    v_mfma_f32_16x16x32_bf16 v[216:219], v[76:79], v[88:91], v[216:219]
    v_xor_b32 v14, 64, v13
    v_xor_b32 v31, 64, v30
    v_mfma_f32_16x16x32_bf16 v[220:223], v[76:79], v[92:95], v[220:223]
    s_setprio 0
    s_mov_b32 s31, s32
    s_mov_b32 s32, s33
    s_add_u32 s33, s33, 49152
    s_cmp_eq_u32 s33, 147456
    s_cselect_b32 s33, 0, s33
    s_waitcnt lgkmcnt(0)
    v_mfma_f32_16x16x32_bf16 v[160:163], v[32:35], v[48:51], v[160:163]
    ds_read_b128 v[64:67], v14 offset:0
    v_mfma_f32_16x16x32_bf16 v[164:167], v[32:35], v[52:55], v[164:167]
    s_add_u32 s35, s31, s39
    s_mov_b32 m0, s35
    s_nop 0
    buffer_load_dwordx4 v25, s[16:19], s37 offen sc1 lds
    v_mfma_f32_16x16x32_bf16 v[168:171], v[32:35], v[56:59], v[168:171]
    ds_read_b128 v[80:83], v31 offset:0
    v_mfma_f32_16x16x32_bf16 v[172:175], v[32:35], v[60:63], v[172:175]
    buffer_load_dwordx4 v26, s[16:19], s37 offen offset:1024 sc1 lds
    v_mfma_f32_16x16x32_bf16 v[176:179], v[36:39], v[48:51], v[176:179]
    ds_read_b128 v[68:71], v14 offset:2048
    v_mfma_f32_16x16x32_bf16 v[180:183], v[36:39], v[52:55], v[180:183]
    ds_read_b128 v[84:87], v31 offset:2048
    v_mfma_f32_16x16x32_bf16 v[184:187], v[36:39], v[56:59], v[184:187]
    buffer_load_dwordx4 v27, s[16:19], s37 offen offset:2048 sc1 lds
    v_mfma_f32_16x16x32_bf16 v[188:191], v[36:39], v[60:63], v[188:191]
    v_mfma_f32_16x16x32_bf16 v[192:195], v[40:43], v[48:51], v[192:195]
    ds_read_b128 v[72:75], v14 offset:4096
    v_mfma_f32_16x16x32_bf16 v[196:199], v[40:43], v[52:55], v[196:199]
    ds_read_b128 v[88:91], v31 offset:4096
    v_mfma_f32_16x16x32_bf16 v[200:203], v[40:43], v[56:59], v[200:203]
    buffer_load_dwordx4 v28, s[16:19], s37 offen offset:3072 sc1 lds
    v_mfma_f32_16x16x32_bf16 v[204:207], v[40:43], v[60:63], v[204:207]
    ds_read_b128 v[76:79], v14 offset:6144
    v_mfma_f32_16x16x32_bf16 v[208:211], v[44:47], v[48:51], v[208:211]
    ds_read_b128 v[92:95], v31 offset:6144
    v_mfma_f32_16x16x32_bf16 v[212:215], v[44:47], v[52:55], v[212:215]
    s_add_u32 s37, s37, 128
    v_mfma_f32_16x16x32_bf16 v[216:219], v[44:47], v[56:59], v[216:219]
    v_add_u32 v13, s33, v12
    v_add_u32 v30, s33, v29
    v_mfma_f32_16x16x32_bf16 v[220:223], v[44:47], v[60:63], v[220:223]
    s_cmp_lg_u32 s28, 1
    s_cbranch_scc1 L_hs31
    s_bitcmp1_b32 s49, 7
    s_cbranch_scc1 L_hs31
    s_lshl_b32 s79, s2, 8
    s_add_u32 s79, s79, 25362432
    v_mov_b32 v6, s79
    s_mov_b32 s90, 300000
L_poll32:
    s_sub_u32 s90, s90, 1
    s_cmp_eq_u32 s90, 0
    s_cbranch_scc1 L_pok33
    buffer_load_dwordx4 v[2:5], v6, s[16:19], 0 offen sc1
    s_waitcnt vmcnt(0)
    v_readfirstlane_b32 s88, v2
    v_readfirstlane_b32 s89, v3
    v_readfirstlane_b32 s91, v4
    s_nop 3
    s_bitcmp1_b32 s0, 0
    s_cselect_b32 s49, s89, s88
    s_and_b32 s88, s49, 128
    s_cmp_eq_u32 s88, 128
    s_cbranch_scc1 L_pok33
    s_sleep 2
    s_branch L_poll32
L_pok33:
L_hs31:
    s_waitcnt vmcnt(6) lgkmcnt(0)
    s_barrier
    s_setprio 1
    v_mfma_f32_16x16x32_bf16 v[160:163], v[64:67], v[80:83], v[160:163]
    ds_read_b128 v[32:35], v13 offset:0
    v_mfma_f32_16x16x32_bf16 v[164:167], v[64:67], v[84:87], v[164:167]
    s_add_u32 s35, s32, s38
    s_mov_b32 m0, s35
    s_nop 0
    buffer_load_dwordx4 v10, s[8:11], s36 offen lds
    v_mfma_f32_16x16x32_bf16 v[168:171], v[64:67], v[88:91], v[168:171]
    ds_read_b128 v[48:51], v30 offset:0
    v_mfma_f32_16x16x32_bf16 v[172:175], v[64:67], v[92:95], v[172:175]
    v_mfma_f32_16x16x32_bf16 v[176:179], v[68:71], v[80:83], v[176:179]
    ds_read_b128 v[36:39], v13 offset:2048
    v_mfma_f32_16x16x32_bf16 v[180:183], v[68:71], v[84:87], v[180:183]
    buffer_load_dwordx4 v11, s[8:11], s36 offen offset:1024 lds
    v_mfma_f32_16x16x32_bf16 v[184:187], v[68:71], v[88:91], v[184:187]
    ds_read_b128 v[52:55], v30 offset:2048
    v_mfma_f32_16x16x32_bf16 v[188:191], v[68:71], v[92:95], v[188:191]
    v_mfma_f32_16x16x32_bf16 v[192:195], v[72:75], v[80:83], v[192:195]
    ds_read_b128 v[40:43], v13 offset:4096
    v_mfma_f32_16x16x32_bf16 v[196:199], v[72:75], v[84:87], v[196:199]
    ds_read_b128 v[56:59], v30 offset:4096
    v_mfma_f32_16x16x32_bf16 v[200:203], v[72:75], v[88:91], v[200:203]
    s_add_u32 s36, s36, 128
    v_mfma_f32_16x16x32_bf16 v[204:207], v[72:75], v[92:95], v[204:207]
    v_mfma_f32_16x16x32_bf16 v[208:211], v[76:79], v[80:83], v[208:211]
    ds_read_b128 v[44:47], v13 offset:6144
    v_mfma_f32_16x16x32_bf16 v[212:215], v[76:79], v[84:87], v[212:215]
    ds_read_b128 v[60:63], v30 offset:6144
    v_mfma_f32_16x16x32_bf16 v[216:219], v[76:79], v[88:91], v[216:219]
    v_xor_b32 v14, 64, v13
    v_xor_b32 v31, 64, v30
    v_mfma_f32_16x16x32_bf16 v[220:223], v[76:79], v[92:95], v[220:223]
    s_setprio 0
    s_mov_b32 s31, s32
    s_mov_b32 s32, s33
    s_add_u32 s33, s33, 49152
    s_cmp_eq_u32 s33, 147456
    s_cselect_b32 s33, 0, s33
    s_waitcnt lgkmcnt(0)
    v_mfma_f32_16x16x32_bf16 v[160:163], v[32:35], v[48:51], v[160:163]
    ds_read_b128 v[64:67], v14 offset:0
    v_mfma_f32_16x16x32_bf16 v[164:167], v[32:35], v[52:55], v[164:167]
    s_add_u32 s35, s31, s39
    s_mov_b32 m0, s35
    s_nop 0
    buffer_load_dwordx4 v25, s[16:19], s37 offen sc1 lds
    v_mfma_f32_16x16x32_bf16 v[168:171], v[32:35], v[56:59], v[168:171]
    ds_read_b128 v[80:83], v31 offset:0
    v_mfma_f32_16x16x32_bf16 v[172:175], v[32:35], v[60:63], v[172:175]
    buffer_load_dwordx4 v26, s[16:19], s37 offen offset:1024 sc1 lds
    v_mfma_f32_16x16x32_bf16 v[176:179], v[36:39], v[48:51], v[176:179]
    ds_read_b128 v[68:71], v14 offset:2048
    v_mfma_f32_16x16x32_bf16 v[180:183], v[36:39], v[52:55], v[180:183]
    ds_read_b128 v[84:87], v31 offset:2048
    v_mfma_f32_16x16x32_bf16 v[184:187], v[36:39], v[56:59], v[184:187]
    buffer_load_dwordx4 v27, s[16:19], s37 offen offset:2048 sc1 lds
    v_mfma_f32_16x16x32_bf16 v[188:191], v[36:39], v[60:63], v[188:191]
    v_mfma_f32_16x16x32_bf16 v[192:195], v[40:43], v[48:51], v[192:195]
    ds_read_b128 v[72:75], v14 offset:4096
    v_mfma_f32_16x16x32_bf16 v[196:199], v[40:43], v[52:55], v[196:199]
    ds_read_b128 v[88:91], v31 offset:4096
    v_mfma_f32_16x16x32_bf16 v[200:203], v[40:43], v[56:59], v[200:203]
    buffer_load_dwordx4 v28, s[16:19], s37 offen offset:3072 sc1 lds
    v_mfma_f32_16x16x32_bf16 v[204:207], v[40:43], v[60:63], v[204:207]
    ds_read_b128 v[76:79], v14 offset:6144
    v_mfma_f32_16x16x32_bf16 v[208:211], v[44:47], v[48:51], v[208:211]
    ds_read_b128 v[92:95], v31 offset:6144
    v_mfma_f32_16x16x32_bf16 v[212:215], v[44:47], v[52:55], v[212:215]
    s_add_u32 s37, s37, 128
    v_mfma_f32_16x16x32_bf16 v[216:219], v[44:47], v[56:59], v[216:219]
    v_add_u32 v13, s33, v12
    v_add_u32 v30, s33, v29
    v_mfma_f32_16x16x32_bf16 v[220:223], v[44:47], v[60:63], v[220:223]
    s_cmp_lg_u32 s28, 1
    s_cbranch_scc1 L_hk34
    s_lshl_b32 s79, s2, 8
    s_add_u32 s79, s79, 25362432
    v_mov_b32 v6, s79
    s_mov_b32 s90, 300000
L_poll35:
    s_sub_u32 s90, s90, 1
    s_cmp_eq_u32 s90, 0
    s_cbranch_scc1 L_pok36
    buffer_load_dwordx4 v[2:5], v6, s[16:19], 0 offen sc1
    s_waitcnt vmcnt(0)
    v_readfirstlane_b32 s88, v2
    v_readfirstlane_b32 s89, v3
    v_readfirstlane_b32 s91, v4
    s_nop 3
    s_add_u32 s88, s88, s89
    s_add_u32 s88, s88, s91
    s_cmp_eq_u32 s88, 526
    s_cbranch_scc1 L_pok36
    s_sleep 2
    s_branch L_poll35
L_pok36:
L_hk34:
    s_waitcnt vmcnt(6) lgkmcnt(0)
    s_barrier
    s_setprio 1
    v_mfma_f32_16x16x32_bf16 v[160:163], v[64:67], v[80:83], v[160:163]
    ds_read_b128 v[32:35], v13 offset:0
    v_mfma_f32_16x16x32_bf16 v[164:167], v[64:67], v[84:87], v[164:167]
    s_add_u32 s35, s32, s83
    s_mov_b32 m0, s35
    s_nop 0
    buffer_load_dwordx4 v15, s[24:27], s84 offen lds
    v_mfma_f32_16x16x32_bf16 v[168:171], v[64:67], v[88:91], v[168:171]
    ds_read_b128 v[48:51], v30 offset:0
    v_mfma_f32_16x16x32_bf16 v[172:175], v[64:67], v[92:95], v[172:175]
    v_mfma_f32_16x16x32_bf16 v[176:179], v[68:71], v[80:83], v[176:179]
    ds_read_b128 v[36:39], v13 offset:2048
    v_mfma_f32_16x16x32_bf16 v[180:183], v[68:71], v[84:87], v[180:183]
    buffer_load_dwordx4 v16, s[24:27], s84 offen offset:1024 lds
    v_mfma_f32_16x16x32_bf16 v[184:187], v[68:71], v[88:91], v[184:187]
    ds_read_b128 v[52:55], v30 offset:2048
    v_mfma_f32_16x16x32_bf16 v[188:191], v[68:71], v[92:95], v[188:191]
    v_mfma_f32_16x16x32_bf16 v[192:195], v[72:75], v[80:83], v[192:195]
    ds_read_b128 v[40:43], v13 offset:4096
    v_mfma_f32_16x16x32_bf16 v[196:199], v[72:75], v[84:87], v[196:199]
    ds_read_b128 v[56:59], v30 offset:4096
    v_mfma_f32_16x16x32_bf16 v[200:203], v[72:75], v[88:91], v[200:203]
    s_add_u32 s84, s84, 131072
    v_mfma_f32_16x16x32_bf16 v[204:207], v[72:75], v[92:95], v[204:207]
    v_mfma_f32_16x16x32_bf16 v[208:211], v[76:79], v[80:83], v[208:211]
    ds_read_b128 v[44:47], v13 offset:6144
    v_mfma_f32_16x16x32_bf16 v[212:215], v[76:79], v[84:87], v[212:215]
    ds_read_b128 v[60:63], v30 offset:6144
    v_mfma_f32_16x16x32_bf16 v[216:219], v[76:79], v[88:91], v[216:219]
    v_xor_b32 v14, 64, v13
    v_xor_b32 v31, 64, v30
    v_mfma_f32_16x16x32_bf16 v[220:223], v[76:79], v[92:95], v[220:223]
    s_setprio 0
    s_mov_b32 s31, s32
    s_mov_b32 s32, s33
    s_add_u32 s33, s33, 49152
    s_cmp_eq_u32 s33, 147456
    s_cselect_b32 s33, 0, s33
    s_waitcnt lgkmcnt(0)
    v_mfma_f32_16x16x32_bf16 v[160:163], v[32:35], v[48:51], v[160:163]
    ds_read_b128 v[64:67], v14 offset:0
    v_mfma_f32_16x16x32_bf16 v[164:167], v[32:35], v[52:55], v[164:167]
    s_add_u32 s35, s31, s39
    s_mov_b32 m0, s35
    s_nop 0
    buffer_load_dwordx4 v25, s[16:19], s3 offen sc1 lds
    v_mfma_f32_16x16x32_bf16 v[168:171], v[32:35], v[56:59], v[168:171]
    ds_read_b128 v[80:83], v31 offset:0
    v_mfma_f32_16x16x32_bf16 v[172:175], v[32:35], v[60:63], v[172:175]
    buffer_load_dwordx4 v26, s[16:19], s3 offen offset:1024 sc1 lds
    v_mfma_f32_16x16x32_bf16 v[176:179], v[36:39], v[48:51], v[176:179]
    ds_read_b128 v[68:71], v14 offset:2048
    v_mfma_f32_16x16x32_bf16 v[180:183], v[36:39], v[52:55], v[180:183]
    ds_read_b128 v[84:87], v31 offset:2048
    v_mfma_f32_16x16x32_bf16 v[184:187], v[36:39], v[56:59], v[184:187]
    buffer_load_dwordx4 v27, s[16:19], s3 offen offset:2048 sc1 lds
    v_mfma_f32_16x16x32_bf16 v[188:191], v[36:39], v[60:63], v[188:191]
    v_mfma_f32_16x16x32_bf16 v[192:195], v[40:43], v[48:51], v[192:195]
    ds_read_b128 v[72:75], v14 offset:4096
    v_mfma_f32_16x16x32_bf16 v[196:199], v[40:43], v[52:55], v[196:199]
    ds_read_b128 v[88:91], v31 offset:4096
    v_mfma_f32_16x16x32_bf16 v[200:203], v[40:43], v[56:59], v[200:203]
    buffer_load_dwordx4 v28, s[16:19], s3 offen offset:3072 sc1 lds
    v_mfma_f32_16x16x32_bf16 v[204:207], v[40:43], v[60:63], v[204:207]
    ds_read_b128 v[76:79], v14 offset:6144
    v_mfma_f32_16x16x32_bf16 v[208:211], v[44:47], v[48:51], v[208:211]
    ds_read_b128 v[92:95], v31 offset:6144
    v_mfma_f32_16x16x32_bf16 v[212:215], v[44:47], v[52:55], v[212:215]
    s_add_u32 s3, s3, 128
    v_mfma_f32_16x16x32_bf16 v[216:219], v[44:47], v[56:59], v[216:219]
    v_add_u32 v13, s33, v12
    v_add_u32 v30, s33, v29
    v_mfma_f32_16x16x32_bf16 v[220:223], v[44:47], v[60:63], v[220:223]
    s_waitcnt vmcnt(6) lgkmcnt(0)
    s_barrier
    s_setprio 1
    v_mfma_f32_16x16x32_bf16 v[160:163], v[64:67], v[80:83], v[160:163]
    ds_read_b128 v[32:35], v13 offset:0
    v_mfma_f32_16x16x32_bf16 v[164:167], v[64:67], v[84:87], v[164:167]
    s_add_u32 s35, s32, s83
    s_mov_b32 m0, s35
    s_nop 0
    buffer_load_dwordx4 v15, s[24:27], s84 offen lds
    v_mfma_f32_16x16x32_bf16 v[168:171], v[64:67], v[88:91], v[168:171]
    ds_read_b128 v[48:51], v30 offset:0
    v_mfma_f32_16x16x32_bf16 v[172:175], v[64:67], v[92:95], v[172:175]
    v_mfma_f32_16x16x32_bf16 v[176:179], v[68:71], v[80:83], v[176:179]
    ds_read_b128 v[36:39], v13 offset:2048
    v_mfma_f32_16x16x32_bf16 v[180:183], v[68:71], v[84:87], v[180:183]
    buffer_load_dwordx4 v16, s[24:27], s84 offen offset:1024 lds
    v_mfma_f32_16x16x32_bf16 v[184:187], v[68:71], v[88:91], v[184:187]
    ds_read_b128 v[52:55], v30 offset:2048
    v_mfma_f32_16x16x32_bf16 v[188:191], v[68:71], v[92:95], v[188:191]
    v_mfma_f32_16x16x32_bf16 v[192:195], v[72:75], v[80:83], v[192:195]
    ds_read_b128 v[40:43], v13 offset:4096
    v_mfma_f32_16x16x32_bf16 v[196:199], v[72:75], v[84:87], v[196:199]
    ds_read_b128 v[56:59], v30 offset:4096
    v_mfma_f32_16x16x32_bf16 v[200:203], v[72:75], v[88:91], v[200:203]
    s_add_u32 s84, s84, 131072
    v_mfma_f32_16x16x32_bf16 v[204:207], v[72:75], v[92:95], v[204:207]
    v_mfma_f32_16x16x32_bf16 v[208:211], v[76:79], v[80:83], v[208:211]
    ds_read_b128 v[44:47], v13 offset:6144
    v_mfma_f32_16x16x32_bf16 v[212:215], v[76:79], v[84:87], v[212:215]
    ds_read_b128 v[60:63], v30 offset:6144
    v_mfma_f32_16x16x32_bf16 v[216:219], v[76:79], v[88:91], v[216:219]
    v_xor_b32 v14, 64, v13
    v_xor_b32 v31, 64, v30
    v_mfma_f32_16x16x32_bf16 v[220:223], v[76:79], v[92:95], v[220:223]
    s_setprio 0
    s_mov_b32 s31, s32
    s_mov_b32 s32, s33
    s_add_u32 s33, s33, 49152
    s_cmp_eq_u32 s33, 147456
    s_cselect_b32 s33, 0, s33
    s_waitcnt lgkmcnt(0)
    v_mfma_f32_16x16x32_bf16 v[160:163], v[32:35], v[48:51], v[160:163]
    ds_read_b128 v[64:67], v14 offset:0
    v_mfma_f32_16x16x32_bf16 v[164:167], v[32:35], v[52:55], v[164:167]
    s_add_u32 s35, s31, s39
    s_mov_b32 m0, s35
    s_nop 0
    buffer_load_dwordx4 v25, s[16:19], s3 offen sc1 lds
    v_mfma_f32_16x16x32_bf16 v[168:171], v[32:35], v[56:59], v[168:171]
    ds_read_b128 v[80:83], v31 offset:0
    v_mfma_f32_16x16x32_bf16 v[172:175], v[32:35], v[60:63], v[172:175]
    buffer_load_dwordx4 v26, s[16:19], s3 offen offset:1024 sc1 lds
    v_mfma_f32_16x16x32_bf16 v[176:179], v[36:39], v[48:51], v[176:179]
    ds_read_b128 v[68:71], v14 offset:2048
    v_mfma_f32_16x16x32_bf16 v[180:183], v[36:39], v[52:55], v[180:183]
    ds_read_b128 v[84:87], v31 offset:2048
    v_mfma_f32_16x16x32_bf16 v[184:187], v[36:39], v[56:59], v[184:187]
    buffer_load_dwordx4 v27, s[16:19], s3 offen offset:2048 sc1 lds
    v_mfma_f32_16x16x32_bf16 v[188:191], v[36:39], v[60:63], v[188:191]
    v_mfma_f32_16x16x32_bf16 v[192:195], v[40:43], v[48:51], v[192:195]
    ds_read_b128 v[72:75], v14 offset:4096
    v_mfma_f32_16x16x32_bf16 v[196:199], v[40:43], v[52:55], v[196:199]
    ds_read_b128 v[88:91], v31 offset:4096
    v_mfma_f32_16x16x32_bf16 v[200:203], v[40:43], v[56:59], v[200:203]
    buffer_load_dwordx4 v28, s[16:19], s3 offen offset:3072 sc1 lds
    v_mfma_f32_16x16x32_bf16 v[204:207], v[40:43], v[60:63], v[204:207]
    ds_read_b128 v[76:79], v14 offset:6144
    v_mfma_f32_16x16x32_bf16 v[208:211], v[44:47], v[48:51], v[208:211]
    ds_read_b128 v[92:95], v31 offset:6144
    v_mfma_f32_16x16x32_bf16 v[212:215], v[44:47], v[52:55], v[212:215]
    s_add_u32 s3, s3, 128
    v_mfma_f32_16x16x32_bf16 v[216:219], v[44:47], v[56:59], v[216:219]
    v_add_u32 v21, s33, v17
    v_add_u32 v22, s33, v18
    v_add_u32 v23, s33, v19
    v_add_u32 v24, s33, v20
    v_add_u32 v30, s33, v29
    v_mfma_f32_16x16x32_bf16 v[220:223], v[44:47], v[60:63], v[220:223]
    s_waitcnt vmcnt(6) lgkmcnt(0)
    s_barrier
    s_setprio 1
    v_mfma_f32_16x16x32_bf16 v[160:163], v[64:67], v[80:83], v[160:163]
    ds_read_b64_tr_b16 v[32:33], v21 offset:0
    v_mfma_f32_16x16x32_bf16 v[164:167], v[64:67], v[84:87], v[164:167]
    s_add_u32 s35, s32, s83
    s_mov_b32 m0, s35
    s_nop 0
    buffer_load_dwordx4 v15, s[24:27], s84 offen lds
    v_mfma_f32_16x16x32_bf16 v[168:171], v[64:67], v[88:91], v[168:171]
    ds_read_b128 v[48:51], v30 offset:0
    v_mfma_f32_16x16x32_bf16 v[172:175], v[64:67], v[92:95], v[172:175]
    ds_read_b64_tr_b16 v[34:35], v21 offset:1024
    v_mfma_f32_16x16x32_bf16 v[176:179], v[68:71], v[80:83], v[176:179]
    ds_read_b64_tr_b16 v[36:37], v22 offset:32
    v_mfma_f32_16x16x32_bf16 v[180:183], v[68:71], v[84:87], v[180:183]
    ds_read_b128 v[52:55], v30 offset:2048
    v_mfma_f32_16x16x32_bf16 v[184:187], v[68:71], v[88:91], v[184:187]
    buffer_load_dwordx4 v16, s[24:27], s84 offen offset:1024 lds
    v_mfma_f32_16x16x32_bf16 v[188:191], v[68:71], v[92:95], v[188:191]
    ds_read_b64_tr_b16 v[38:39], v22 offset:1056
    v_mfma_f32_16x16x32_bf16 v[192:195], v[72:75], v[80:83], v[192:195]
    ds_read_b64_tr_b16 v[40:41], v23 offset:64
    v_mfma_f32_16x16x32_bf16 v[196:199], v[72:75], v[84:87], v[196:199]
    ds_read_b128 v[56:59], v30 offset:4096
    v_mfma_f32_16x16x32_bf16 v[200:203], v[72:75], v[88:91], v[200:203]
    ds_read_b64_tr_b16 v[42:43], v23 offset:1088
    v_mfma_f32_16x16x32_bf16 v[204:207], v[72:75], v[92:95], v[204:207]
    s_add_u32 s84, s84, 131072
    v_mfma_f32_16x16x32_bf16 v[208:211], v[76:79], v[80:83], v[208:211]
    ds_read_b64_tr_b16 v[44:45], v24 offset:96
    v_mfma_f32_16x16x32_bf16 v[212:215], v[76:79], v[84:87], v[212:215]
    ds_read_b128 v[60:63], v30 offset:6144
    v_mfma_f32_16x16x32_bf16 v[216:219], v[76:79], v[88:91], v[216:219]
    ds_read_b64_tr_b16 v[46:47], v24 offset:1120
    v_mfma_f32_16x16x32_bf16 v[220:223], v[76:79], v[92:95], v[220:223]
    v_xor_b32 v31, 64, v30
    s_setprio 0
    s_mov_b32 s31, s32
    s_mov_b32 s32, s33
    s_add_u32 s33, s33, 49152
    s_cmp_eq_u32 s33, 147456
    s_cselect_b32 s33, 0, s33
    s_waitcnt lgkmcnt(0)
    v_mfma_f32_16x16x32_bf16 v[96:99], v[32:35], v[48:51], 0
    ds_read_b64_tr_b16 v[64:65], v21 offset:8192
    s_add_u32 s35, s31, s39
    s_mov_b32 m0, s35
    s_nop 0
    buffer_load_dwordx4 v25, s[16:19], s3 offen sc1 lds
    v_mfma_f32_16x16x32_bf16 v[100:103], v[32:35], v[52:55], 0
    ds_read_b128 v[80:83], v31 offset:0
    v_mfma_f32_16x16x32_bf16 v[104:107], v[32:35], v[56:59], 0
    ds_read_b64_tr_b16 v[66:67], v21 offset:9216
    v_mfma_f32_16x16x32_bf16 v[108:111], v[32:35], v[60:63], 0
    buffer_load_dwordx4 v26, s[16:19], s3 offen offset:1024 sc1 lds
    v_mfma_f32_16x16x32_bf16 v[112:115], v[36:39], v[48:51], 0
    ds_read_b64_tr_b16 v[68:69], v22 offset:8224
    v_mfma_f32_16x16x32_bf16 v[116:119], v[36:39], v[52:55], 0
    ds_read_b128 v[84:87], v31 offset:2048
    v_mfma_f32_16x16x32_bf16 v[120:123], v[36:39], v[56:59], 0
    ds_read_b64_tr_b16 v[70:71], v22 offset:9248
    v_mfma_f32_16x16x32_bf16 v[124:127], v[36:39], v[60:63], 0
    buffer_load_dwordx4 v27, s[16:19], s3 offen offset:2048 sc1 lds
    v_mfma_f32_16x16x32_bf16 v[128:131], v[40:43], v[48:51], 0
    ds_read_b64_tr_b16 v[72:73], v23 offset:8256
    ds_read_b128 v[88:91], v31 offset:4096
    v_mfma_f32_16x16x32_bf16 v[132:135], v[40:43], v[52:55], 0
    buffer_load_dwordx4 v28, s[16:19], s3 offen offset:3072 sc1 lds
    v_mfma_f32_16x16x32_bf16 v[136:139], v[40:43], v[56:59], 0
    ds_read_b64_tr_b16 v[74:75], v23 offset:9280
    v_mfma_f32_16x16x32_bf16 v[140:143], v[40:43], v[60:63], 0
    ds_read_b64_tr_b16 v[76:77], v24 offset:8288
    v_mfma_f32_16x16x32_bf16 v[144:147], v[44:47], v[48:51], 0
    ds_read_b128 v[92:95], v31 offset:6144
    v_mfma_f32_16x16x32_bf16 v[148:151], v[44:47], v[52:55], 0
    s_add_u32 s3, s3, 128
    v_mfma_f32_16x16x32_bf16 v[152:155], v[44:47], v[56:59], 0
    ds_read_b64_tr_b16 v[78:79], v24 offset:9312
    v_mfma_f32_16x16x32_bf16 v[156:159], v[44:47], v[60:63], 0
    v_add_u32 v21, s33, v17
    v_add_u32 v22, s33, v18
    v_add_u32 v23, s33, v19
    v_add_u32 v24, s33, v20
    v_add_u32 v30, s33, v29
    s_waitcnt vmcnt(6) lgkmcnt(0)
    s_barrier
    s_setprio 1
    v_mfma_f32_16x16x32_bf16 v[96:99], v[64:67], v[80:83], v[96:99]
    ds_read_b64_tr_b16 v[32:33], v21 offset:0
    v_mfma_f32_16x16x32_bf16 v[100:103], v[64:67], v[84:87], v[100:103]
    s_add_u32 s35, s32, s83
    s_mov_b32 m0, s35
    s_nop 0
    buffer_load_dwordx4 v15, s[24:27], s84 offen lds
    v_mfma_f32_16x16x32_bf16 v[104:107], v[64:67], v[88:91], v[104:107]
    ds_read_b128 v[48:51], v30 offset:0
    v_mfma_f32_16x16x32_bf16 v[108:111], v[64:67], v[92:95], v[108:111]
    ds_read_b64_tr_b16 v[34:35], v21 offset:1024
    v_mfma_f32_16x16x32_bf16 v[112:115], v[68:71], v[80:83], v[112:115]
    ds_read_b64_tr_b16 v[36:37], v22 offset:32
    v_mfma_f32_16x16x32_bf16 v[116:119], v[68:71], v[84:87], v[116:119]
    ds_read_b128 v[52:55], v30 offset:2048
    v_mfma_f32_16x16x32_bf16 v[120:123], v[68:71], v[88:91], v[120:123]
    buffer_load_dwordx4 v16, s[24:27], s84 offen offset:1024 lds
    v_mfma_f32_16x16x32_bf16 v[124:127], v[68:71], v[92:95], v[124:127]
    ds_read_b64_tr_b16 v[38:39], v22 offset:1056
    v_mfma_f32_16x16x32_bf16 v[128:131], v[72:75], v[80:83], v[128:131]
    ds_read_b64_tr_b16 v[40:41], v23 offset:64
    v_mfma_f32_16x16x32_bf16 v[132:135], v[72:75], v[84:87], v[132:135]
    ds_read_b128 v[56:59], v30 offset:4096
    v_mfma_f32_16x16x32_bf16 v[136:139], v[72:75], v[88:91], v[136:139]
    ds_read_b64_tr_b16 v[42:43], v23 offset:1088
    v_mfma_f32_16x16x32_bf16 v[140:143], v[72:75], v[92:95], v[140:143]
    s_add_u32 s84, s84, 131072
    v_mfma_f32_16x16x32_bf16 v[144:147], v[76:79], v[80:83], v[144:147]
    ds_read_b64_tr_b16 v[44:45], v24 offset:96
    v_mfma_f32_16x16x32_bf16 v[148:151], v[76:79], v[84:87], v[148:151]
    ds_read_b128 v[60:63], v30 offset:6144
    v_mfma_f32_16x16x32_bf16 v[152:155], v[76:79], v[88:91], v[152:155]
    ds_read_b64_tr_b16 v[46:47], v24 offset:1120
    v_mfma_f32_16x16x32_bf16 v[156:159], v[76:79], v[92:95], v[156:159]
    v_xor_b32 v31, 64, v30
    s_setprio 0
    s_mov_b32 s34, 8
L_gl37:
    s_mov_b32 s31, s32
    s_mov_b32 s32, s33
    s_add_u32 s33, s33, 49152
    s_cmp_eq_u32 s33, 147456
    s_cselect_b32 s33, 0, s33
    s_waitcnt lgkmcnt(0)
    v_mfma_f32_16x16x32_bf16 v[96:99], v[32:35], v[48:51], v[96:99]
    ds_read_b64_tr_b16 v[64:65], v21 offset:8192
    s_add_u32 s35, s31, s39
    s_mov_b32 m0, s35
    s_nop 0
    buffer_load_dwordx4 v25, s[16:19], s3 offen sc1 lds
    v_mfma_f32_16x16x32_bf16 v[100:103], v[32:35], v[52:55], v[100:103]
    ds_read_b128 v[80:83], v31 offset:0
    v_mfma_f32_16x16x32_bf16 v[104:107], v[32:35], v[56:59], v[104:107]
    ds_read_b64_tr_b16 v[66:67], v21 offset:9216
    v_mfma_f32_16x16x32_bf16 v[108:111], v[32:35], v[60:63], v[108:111]
    buffer_load_dwordx4 v26, s[16:19], s3 offen offset:1024 sc1 lds
    v_mfma_f32_16x16x32_bf16 v[112:115], v[36:39], v[48:51], v[112:115]
    ds_read_b64_tr_b16 v[68:69], v22 offset:8224
    v_mfma_f32_16x16x32_bf16 v[116:119], v[36:39], v[52:55], v[116:119]
    ds_read_b128 v[84:87], v31 offset:2048
    v_mfma_f32_16x16x32_bf16 v[120:123], v[36:39], v[56:59], v[120:123]
    ds_read_b64_tr_b16 v[70:71], v22 offset:9248
    v_mfma_f32_16x16x32_bf16 v[124:127], v[36:39], v[60:63], v[124:127]
    buffer_load_dwordx4 v27, s[16:19], s3 offen offset:2048 sc1 lds
    v_mfma_f32_16x16x32_bf16 v[128:131], v[40:43], v[48:51], v[128:131]
    ds_read_b64_tr_b16 v[72:73], v23 offset:8256
    ds_read_b128 v[88:91], v31 offset:4096
    v_mfma_f32_16x16x32_bf16 v[132:135], v[40:43], v[52:55], v[132:135]
    buffer_load_dwordx4 v28, s[16:19], s3 offen offset:3072 sc1 lds
    v_mfma_f32_16x16x32_bf16 v[136:139], v[40:43], v[56:59], v[136:139]
    ds_read_b64_tr_b16 v[74:75], v23 offset:9280
    v_mfma_f32_16x16x32_bf16 v[140:143], v[40:43], v[60:63], v[140:143]
    ds_read_b64_tr_b16 v[76:77], v24 offset:8288
    v_mfma_f32_16x16x32_bf16 v[144:147], v[44:47], v[48:51], v[144:147]
    ds_read_b128 v[92:95], v31 offset:6144
    v_mfma_f32_16x16x32_bf16 v[148:151], v[44:47], v[52:55], v[148:151]
    s_add_u32 s3, s3, 128
    v_mfma_f32_16x16x32_bf16 v[152:155], v[44:47], v[56:59], v[152:155]
    ds_read_b64_tr_b16 v[78:79], v24 offset:9312
    v_mfma_f32_16x16x32_bf16 v[156:159], v[44:47], v[60:63], v[156:159]
    v_add_u32 v21, s33, v17
    v_add_u32 v22, s33, v18
    v_add_u32 v23, s33, v19
    v_add_u32 v24, s33, v20
    v_add_u32 v30, s33, v29
    s_waitcnt vmcnt(6) lgkmcnt(0)
    s_barrier
    s_setprio 1
    v_mfma_f32_16x16x32_bf16 v[96:99], v[64:67], v[80:83], v[96:99]
    ds_read_b64_tr_b16 v[32:33], v21 offset:0
    v_mfma_f32_16x16x32_bf16 v[100:103], v[64:67], v[84:87], v[100:103]
    s_add_u32 s35, s32, s83
    s_mov_b32 m0, s35
    s_nop 0
    buffer_load_dwordx4 v15, s[24:27], s84 offen lds
    v_mfma_f32_16x16x32_bf16 v[104:107], v[64:67], v[88:91], v[104:107]
    ds_read_b128 v[48:51], v30 offset:0
    v_mfma_f32_16x16x32_bf16 v[108:111], v[64:67], v[92:95], v[108:111]
    ds_read_b64_tr_b16 v[34:35], v21 offset:1024
    v_mfma_f32_16x16x32_bf16 v[112:115], v[68:71], v[80:83], v[112:115]
    ds_read_b64_tr_b16 v[36:37], v22 offset:32
    v_mfma_f32_16x16x32_bf16 v[116:119], v[68:71], v[84:87], v[116:119]
    ds_read_b128 v[52:55], v30 offset:2048
    v_mfma_f32_16x16x32_bf16 v[120:123], v[68:71], v[88:91], v[120:123]
    buffer_load_dwordx4 v16, s[24:27], s84 offen offset:1024 lds
    v_mfma_f32_16x16x32_bf16 v[124:127], v[68:71], v[92:95], v[124:127]
    ds_read_b64_tr_b16 v[38:39], v22 offset:1056
    v_mfma_f32_16x16x32_bf16 v[128:131], v[72:75], v[80:83], v[128:131]
    ds_read_b64_tr_b16 v[40:41], v23 offset:64
    v_mfma_f32_16x16x32_bf16 v[132:135], v[72:75], v[84:87], v[132:135]
    ds_read_b128 v[56:59], v30 offset:4096
    v_mfma_f32_16x16x32_bf16 v[136:139], v[72:75], v[88:91], v[136:139]
    ds_read_b64_tr_b16 v[42:43], v23 offset:1088
    v_mfma_f32_16x16x32_bf16 v[140:143], v[72:75], v[92:95], v[140:143]
    s_add_u32 s84, s84, 131072
    v_mfma_f32_16x16x32_bf16 v[144:147], v[76:79], v[80:83], v[144:147]
    ds_read_b64_tr_b16 v[44:45], v24 offset:96
    v_mfma_f32_16x16x32_bf16 v[148:151], v[76:79], v[84:87], v[148:151]
    ds_read_b128 v[60:63], v30 offset:6144
    v_mfma_f32_16x16x32_bf16 v[152:155], v[76:79], v[88:91], v[152:155]
    ds_read_b64_tr_b16 v[46:47], v24 offset:1120
    v_mfma_f32_16x16x32_bf16 v[156:159], v[76:79], v[92:95], v[156:159]
    v_xor_b32 v31, 64, v30
    s_setprio 0
    s_sub_u32 s34, s34, 1
    s_cmp_lg_u32 s34, 0
    s_cbranch_scc1 L_gl37
    s_mov_b32 s31, s32
    s_mov_b32 s32, s33
    s_add_u32 s33, s33, 49152
    s_cmp_eq_u32 s33, 147456
    s_cselect_b32 s33, 0, s33
    s_waitcnt lgkmcnt(0)
    v_mfma_f32_16x16x32_bf16 v[96:99], v[32:35], v[48:51], v[96:99]
    ds_read_b64_tr_b16 v[64:65], v21 offset:8192
    s_add_u32 s35, s31, s39
    s_mov_b32 m0, s35
    s_nop 0
    buffer_load_dwordx4 v25, s[16:19], s3 offen sc1 lds
    v_mfma_f32_16x16x32_bf16 v[100:103], v[32:35], v[52:55], v[100:103]
    ds_read_b128 v[80:83], v31 offset:0
    v_mfma_f32_16x16x32_bf16 v[104:107], v[32:35], v[56:59], v[104:107]
    ds_read_b64_tr_b16 v[66:67], v21 offset:9216
    v_mfma_f32_16x16x32_bf16 v[108:111], v[32:35], v[60:63], v[108:111]
    buffer_load_dwordx4 v26, s[16:19], s3 offen offset:1024 sc1 lds
    v_mfma_f32_16x16x32_bf16 v[112:115], v[36:39], v[48:51], v[112:115]
    ds_read_b64_tr_b16 v[68:69], v22 offset:8224
    v_mfma_f32_16x16x32_bf16 v[116:119], v[36:39], v[52:55], v[116:119]
    ds_read_b128 v[84:87], v31 offset:2048
    v_mfma_f32_16x16x32_bf16 v[120:123], v[36:39], v[56:59], v[120:123]
    ds_read_b64_tr_b16 v[70:71], v22 offset:9248
    v_mfma_f32_16x16x32_bf16 v[124:127], v[36:39], v[60:63], v[124:127]
    buffer_load_dwordx4 v27, s[16:19], s3 offen offset:2048 sc1 lds
    v_mfma_f32_16x16x32_bf16 v[128:131], v[40:43], v[48:51], v[128:131]
    ds_read_b64_tr_b16 v[72:73], v23 offset:8256
    ds_read_b128 v[88:91], v31 offset:4096
    v_mfma_f32_16x16x32_bf16 v[132:135], v[40:43], v[52:55], v[132:135]
    buffer_load_dwordx4 v28, s[16:19], s3 offen offset:3072 sc1 lds
    v_mfma_f32_16x16x32_bf16 v[136:139], v[40:43], v[56:59], v[136:139]
    ds_read_b64_tr_b16 v[74:75], v23 offset:9280
    v_mfma_f32_16x16x32_bf16 v[140:143], v[40:43], v[60:63], v[140:143]
    ds_read_b64_tr_b16 v[76:77], v24 offset:8288
    v_mfma_f32_16x16x32_bf16 v[144:147], v[44:47], v[48:51], v[144:147]
    ds_read_b128 v[92:95], v31 offset:6144
    v_mfma_f32_16x16x32_bf16 v[148:151], v[44:47], v[52:55], v[148:151]
    s_add_u32 s3, s3, 128
    v_mfma_f32_16x16x32_bf16 v[152:155], v[44:47], v[56:59], v[152:155]
    ds_read_b64_tr_b16 v[78:79], v24 offset:9312
    v_mfma_f32_16x16x32_bf16 v[156:159], v[44:47], v[60:63], v[156:159]
    v_add_u32 v21, s33, v17
    v_add_u32 v22, s33, v18
    v_add_u32 v23, s33, v19
    v_add_u32 v24, s33, v20
    v_add_u32 v30, s33, v29
    s_waitcnt vmcnt(6) lgkmcnt(0)
    s_barrier
    s_setprio 1
    v_mfma_f32_16x16x32_bf16 v[96:99], v[64:67], v[80:83], v[96:99]
    ds_read_b64_tr_b16 v[32:33], v21 offset:0
    ds_read_b128 v[48:51], v30 offset:0
    v_mfma_f32_16x16x32_bf16 v[100:103], v[64:67], v[84:87], v[100:103]
    ds_read_b64_tr_b16 v[34:35], v21 offset:1024
    ds_read_b64_tr_b16 v[36:37], v22 offset:32
    v_mfma_f32_16x16x32_bf16 v[104:107], v[64:67], v[88:91], v[104:107]
    ds_read_b128 v[52:55], v30 offset:2048
    v_mfma_f32_16x16x32_bf16 v[108:111], v[64:67], v[92:95], v[108:111]
    ds_read_b64_tr_b16 v[38:39], v22 offset:1056
    ds_read_b64_tr_b16 v[40:41], v23 offset:64
    v_mfma_f32_16x16x32_bf16 v[112:115], v[68:71], v[80:83], v[112:115]
    ds_read_b128 v[56:59], v30 offset:4096
    v_mfma_f32_16x16x32_bf16 v[116:119], v[68:71], v[84:87], v[116:119]
    ds_read_b64_tr_b16 v[42:43], v23 offset:1088
    ds_read_b64_tr_b16 v[44:45], v24 offset:96
    v_mfma_f32_16x16x32_bf16 v[120:123], v[68:71], v[88:91], v[120:123]
    ds_read_b128 v[60:63], v30 offset:6144
    v_mfma_f32_16x16x32_bf16 v[124:127], v[68:71], v[92:95], v[124:127]
    ds_read_b64_tr_b16 v[46:47], v24 offset:1120
    v_xor_b32 v31, 64, v30
    v_mfma_f32_16x16x32_bf16 v[128:131], v[72:75], v[80:83], v[128:131]
    s_mul_i32 s76, s86, 256
    s_mul_i32 s77, s81, 64
    s_add_u32 s76, s76, s77
    v_and_b32 v232, 15, v0
    v_add_u32 v232, s76, v232
    v_lshlrev_b32 v233, 3, v232
    s_add_u32 s76, s0, 0
    s_and_b32 s76, s76, 3
    s_lshl_b32 s76, s76, 7
    s_add_u32 s76, s76, 25165824
    buffer_load_dwordx2 v[224:225], v233, s[16:19], s76 offen sc1
    v_mfma_f32_16x16x32_bf16 v[132:135], v[72:75], v[84:87], v[132:135]
    s_add_u32 s76, s0, 1
    s_and_b32 s76, s76, 3
    s_lshl_b32 s76, s76, 7
    s_add_u32 s76, s76, 25165824
    buffer_load_dwordx2 v[226:227], v233, s[16:19], s76 offen sc1
    v_mfma_f32_16x16x32_bf16 v[136:139], v[72:75], v[88:91], v[136:139]
    s_add_u32 s76, s0, 2
    s_and_b32 s76, s76, 3
    s_lshl_b32 s76, s76, 7
    s_add_u32 s76, s76, 25165824
    buffer_load_dwordx2 v[228:229], v233, s[16:19], s76 offen sc1
    s_add_u32 s76, s0, 3
    s_and_b32 s76, s76, 3
    s_lshl_b32 s76, s76, 7
    s_add_u32 s76, s76, 25165824
    buffer_load_dwordx2 v[230:231], v233, s[16:19], s76 offen sc1
    v_mfma_f32_16x16x32_bf16 v[140:143], v[72:75], v[92:95], v[140:143]
    s_lshl_b32 s76, s0, 4
    v_add_u32 v232, s76, v232
    v_lshrrev_b32 v234, 4, v0
    v_lshlrev_b32 v234, 2, v234
    s_lshl_b32 s76, s87, 7
    s_lshl_b32 s77, s80, 6
    s_add_u32 s76, s76, s77
    v_add_u32 v234, s76, v234
    v_lshlrev_b32 v234, 1, v234
    v_lshl_add_u32 v233, v232, 11, v234
    v_lshlrev_b32 v235, 4, v0
    v_mfma_f32_16x16x32_bf16 v[144:147], v[76:79], v[80:83], v[144:147]
    s_add_u32 s77, s0, 1
    s_and_b32 s77, s77, 3
    s_mul_i32 s76, s77, 2
    s_and_b32 s78, s2, 1
    s_add_u32 s76, s76, s78
    s_lshr_b32 s78, s87, 2
    s_xor_b32 s78, s78, s77
    s_and_b32 s78, s78, 1
    s_xor_b32 s78, s78, 1
    s_lshl_b32 s78, s78, 7
    s_or_b32 s76, s76, s78
    s_and_b32 s78, s2, 0x78
    s_or_b32 s76, s76, s78
    s_lshl_b32 s76, s76, 3
    s_add_u32 s76, s76, s28
    s_mul_i32 s76, s76, 12288
    s_add_u32 s44, s76, 33562624
    s_add_u32 s77, s0, 2
    s_and_b32 s77, s77, 3
    s_mul_i32 s76, s77, 2
    s_and_b32 s78, s2, 1
    s_add_u32 s76, s76, s78
    s_lshr_b32 s78, s87, 2
    s_xor_b32 s78, s78, s77
    s_and_b32 s78, s78, 1
    s_xor_b32 s78, s78, 1
    s_lshl_b32 s78, s78, 7
    s_or_b32 s76, s76, s78
    s_and_b32 s78, s2, 0x78
    s_or_b32 s76, s76, s78
    s_lshl_b32 s76, s76, 3
    s_add_u32 s76, s76, s28
    s_mul_i32 s76, s76, 12288
    s_add_u32 s45, s76, 33558528
    v_mfma_f32_16x16x32_bf16 v[148:151], v[76:79], v[84:87], v[148:151]
    s_add_u32 s77, s0, 3
    s_and_b32 s77, s77, 3
    s_mul_i32 s76, s77, 2
    s_and_b32 s78, s2, 1
    s_add_u32 s76, s76, s78
    s_lshr_b32 s78, s87, 2
    s_xor_b32 s78, s78, s77
    s_and_b32 s78, s78, 1
    s_xor_b32 s78, s78, 1
    s_lshl_b32 s78, s78, 7
    s_or_b32 s76, s76, s78
    s_and_b32 s78, s2, 0x78
    s_or_b32 s76, s76, s78
    s_lshl_b32 s76, s76, 3
    s_add_u32 s76, s76, s28
    s_mul_i32 s76, s76, 12288
    s_add_u32 s46, s76, 33554432
    v_mfma_f32_16x16x32_bf16 v[152:155], v[76:79], v[88:91], v[152:155]
    buffer_load_dword v250, v233, s[4:7], 0 offen
    s_mov_b32 s72, s56
    s_mov_b32 s73, s57
    s_mov_b32 s74, 2048
    s_mov_b32 s75, 0x20000
    buffer_load_dword v250, v234, s[72:75], 0 offen
    v_mfma_f32_16x16x32_bf16 v[156:159], v[76:79], v[92:95], v[156:159]
    s_mov_b32 s72, s66
    s_mov_b32 s73, s67
    buffer_load_dword v250, v234, s[72:75], 0 offen
    s_setprio 0
    s_mov_b32 s31, s32
    s_mov_b32 s32, s33
    s_add_u32 s33, s33, 49152
    s_cmp_eq_u32 s33, 147456
    s_cselect_b32 s33, 0, s33
    s_waitcnt lgkmcnt(0)
    v_mfma_f32_16x16x32_bf16 v[96:99], v[32:35], v[48:51], v[96:99]
    ds_read_b64_tr_b16 v[64:65], v21 offset:8192
    v_mfma_f32_16x16x32_bf16 v[100:103], v[32:35], v[52:55], v[100:103]
    ds_read_b128 v[80:83], v31 offset:0
    v_mfma_f32_16x16x32_bf16 v[104:107], v[32:35], v[56:59], v[104:107]
    ds_read_b64_tr_b16 v[66:67], v21 offset:9216
    v_mfma_f32_16x16x32_bf16 v[108:111], v[32:35], v[60:63], v[108:111]
    ds_read_b64_tr_b16 v[68:69], v22 offset:8224
    v_mfma_f32_16x16x32_bf16 v[112:115], v[36:39], v[48:51], v[112:115]
    ds_read_b128 v[84:87], v31 offset:2048
    v_mfma_f32_16x16x32_bf16 v[116:119], v[36:39], v[52:55], v[116:119]
    v_mfma_f32_16x16x32_bf16 v[120:123], v[36:39], v[56:59], v[120:123]
    ds_read_b64_tr_b16 v[70:71], v22 offset:9248
    v_mfma_f32_16x16x32_bf16 v[124:127], v[36:39], v[60:63], v[124:127]
    ds_read_b64_tr_b16 v[72:73], v23 offset:8256
    v_mfma_f32_16x16x32_bf16 v[128:131], v[40:43], v[48:51], v[128:131]
    ds_read_b128 v[88:91], v31 offset:4096
    v_mfma_f32_16x16x32_bf16 v[132:135], v[40:43], v[52:55], v[132:135]
    ds_read_b64_tr_b16 v[74:75], v23 offset:9280
    v_mfma_f32_16x16x32_bf16 v[136:139], v[40:43], v[56:59], v[136:139]
    v_mfma_f32_16x16x32_bf16 v[140:143], v[40:43], v[60:63], v[140:143]
    ds_read_b64_tr_b16 v[76:77], v24 offset:8288
    v_mfma_f32_16x16x32_bf16 v[144:147], v[44:47], v[48:51], v[144:147]
    ds_read_b128 v[92:95], v31 offset:6144
    v_mfma_f32_16x16x32_bf16 v[148:151], v[44:47], v[52:55], v[148:151]
    ds_read_b64_tr_b16 v[78:79], v24 offset:9312
    v_mfma_f32_16x16x32_bf16 v[152:155], v[44:47], v[56:59], v[152:155]
    v_add_u32 v21, s33, v17
    v_add_u32 v22, s33, v18
    v_add_u32 v23, s33, v19
    v_add_u32 v24, s33, v20
    v_add_u32 v30, s33, v29
    v_mfma_f32_16x16x32_bf16 v[156:159], v[44:47], v[60:63], v[156:159]
    s_waitcnt vmcnt(7) lgkmcnt(0)
    s_barrier
    s_setprio 1
    v_mfma_f32_16x16x32_bf16 v[96:99], v[64:67], v[80:83], v[96:99]
    ds_read_b64_tr_b16 v[32:33], v21 offset:0
    v_mfma_f32_16x16x32_bf16 v[100:103], v[64:67], v[84:87], v[100:103]
    ds_read_b128 v[48:51], v30 offset:0
    v_mfma_f32_16x16x32_bf16 v[104:107], v[64:67], v[88:91], v[104:107]
    ds_read_b64_tr_b16 v[34:35], v21 offset:1024
    v_mfma_f32_16x16x32_bf16 v[108:111], v[64:67], v[92:95], v[108:111]
    ds_read_b64_tr_b16 v[36:37], v22 offset:32
    v_mfma_f32_16x16x32_bf16 v[112:115], v[68:71], v[80:83], v[112:115]
    ds_read_b128 v[52:55], v30 offset:2048
    v_mfma_f32_16x16x32_bf16 v[116:119], v[68:71], v[84:87], v[116:119]
    v_mfma_f32_16x16x32_bf16 v[120:123], v[68:71], v[88:91], v[120:123]
    ds_read_b64_tr_b16 v[38:39], v22 offset:1056
    v_mfma_f32_16x16x32_bf16 v[124:127], v[68:71], v[92:95], v[124:127]
    ds_read_b64_tr_b16 v[40:41], v23 offset:64
    v_mfma_f32_16x16x32_bf16 v[128:131], v[72:75], v[80:83], v[128:131]
    ds_read_b128 v[56:59], v30 offset:4096
    v_mfma_f32_16x16x32_bf16 v[132:135], v[72:75], v[84:87], v[132:135]
    ds_read_b64_tr_b16 v[42:43], v23 offset:1088
    v_mfma_f32_16x16x32_bf16 v[136:139], v[72:75], v[88:91], v[136:139]
    v_mfma_f32_16x16x32_bf16 v[140:143], v[72:75], v[92:95], v[140:143]
    ds_read_b64_tr_b16 v[44:45], v24 offset:96
    v_mfma_f32_16x16x32_bf16 v[144:147], v[76:79], v[80:83], v[144:147]
    ds_read_b128 v[60:63], v30 offset:6144
    v_mfma_f32_16x16x32_bf16 v[148:151], v[76:79], v[84:87], v[148:151]
    ds_read_b64_tr_b16 v[46:47], v24 offset:1120
    v_mfma_f32_16x16x32_bf16 v[152:155], v[76:79], v[88:91], v[152:155]
    v_xor_b32 v31, 64, v30
    v_mfma_f32_16x16x32_bf16 v[156:159], v[76:79], v[92:95], v[156:159]
    s_setprio 0
    s_mov_b32 s31, s32
    s_mov_b32 s32, s33
    s_add_u32 s33, s33, 49152
    s_cmp_eq_u32 s33, 147456
    s_cselect_b32 s33, 0, s33
    s_waitcnt lgkmcnt(0)
    v_mfma_f32_16x16x32_bf16 v[96:99], v[32:35], v[48:51], v[96:99]
    ds_read_b64_tr_b16 v[64:65], v21 offset:8192
    v_mfma_f32_16x16x32_bf16 v[100:103], v[32:35], v[52:55], v[100:103]
    ds_read_b128 v[80:83], v31 offset:0
    v_mfma_f32_16x16x32_bf16 v[104:107], v[32:35], v[56:59], v[104:107]
    ds_read_b64_tr_b16 v[66:67], v21 offset:9216
    v_mfma_f32_16x16x32_bf16 v[108:111], v[32:35], v[60:63], v[108:111]
    v_mfma_f32_16x16x32_bf16 v[112:115], v[36:39], v[48:51], v[112:115]
    ds_read_b64_tr_b16 v[68:69], v22 offset:8224
    v_mfma_f32_16x16x32_bf16 v[116:119], v[36:39], v[52:55], v[116:119]
    ds_read_b128 v[84:87], v31 offset:2048
    v_mfma_f32_16x16x32_bf16 v[120:123], v[36:39], v[56:59], v[120:123]
    ds_read_b64_tr_b16 v[70:71], v22 offset:9248
    v_mfma_f32_16x16x32_bf16 v[124:127], v[36:39], v[60:63], v[124:127]
    v_mfma_f32_16x16x32_bf16 v[128:131], v[40:43], v[48:51], v[128:131]
    ds_read_b64_tr_b16 v[72:73], v23 offset:8256
    v_mfma_f32_16x16x32_bf16 v[132:135], v[40:43], v[52:55], v[132:135]
    ds_read_b128 v[88:91], v31 offset:4096
    v_mfma_f32_16x16x32_bf16 v[136:139], v[40:43], v[56:59], v[136:139]
    ds_read_b64_tr_b16 v[74:75], v23 offset:9280
    v_mfma_f32_16x16x32_bf16 v[140:143], v[40:43], v[60:63], v[140:143]
    v_mfma_f32_16x16x32_bf16 v[144:147], v[44:47], v[48:51], v[144:147]
    ds_read_b64_tr_b16 v[76:77], v24 offset:8288
    v_mfma_f32_16x16x32_bf16 v[148:151], v[44:47], v[52:55], v[148:151]
    ds_read_b128 v[92:95], v31 offset:6144
    v_mfma_f32_16x16x32_bf16 v[152:155], v[44:47], v[56:59], v[152:155]
    ds_read_b64_tr_b16 v[78:79], v24 offset:9312
    v_mfma_f32_16x16x32_bf16 v[156:159], v[44:47], v[60:63], v[156:159]
    s_waitcnt lgkmcnt(0)
    v_mfma_f32_16x16x32_bf16 v[96:99], v[64:67], v[80:83], v[96:99]
    v_mfma_f32_16x16x32_bf16 v[100:103], v[64:67], v[84:87], v[100:103]
    v_mfma_f32_16x16x32_bf16 v[104:107], v[64:67], v[88:91], v[104:107]
    v_mfma_f32_16x16x32_bf16 v[108:111], v[64:67], v[92:95], v[108:111]
    v_mfma_f32_16x16x32_bf16 v[112:115], v[68:71], v[80:83], v[112:115]
    v_mfma_f32_16x16x32_bf16 v[116:119], v[68:71], v[84:87], v[116:119]
    v_mfma_f32_16x16x32_bf16 v[120:123], v[68:71], v[88:91], v[120:123]
    v_mfma_f32_16x16x32_bf16 v[124:127], v[68:71], v[92:95], v[124:127]
    v_mfma_f32_16x16x32_bf16 v[128:131], v[72:75], v[80:83], v[128:131]
    v_mfma_f32_16x16x32_bf16 v[132:135], v[72:75], v[84:87], v[132:135]
    v_mfma_f32_16x16x32_bf16 v[136:139], v[72:75], v[88:91], v[136:139]
    v_mfma_f32_16x16x32_bf16 v[140:143], v[72:75], v[92:95], v[140:143]
    v_mfma_f32_16x16x32_bf16 v[144:147], v[76:79], v[80:83], v[144:147]
    v_mfma_f32_16x16x32_bf16 v[148:151], v[76:79], v[84:87], v[148:151]
    v_mfma_f32_16x16x32_bf16 v[152:155], v[76:79], v[88:91], v[152:155]
    v_mfma_f32_16x16x32_bf16 v[156:159], v[76:79], v[92:95], v[156:159]
    s_nop 7
    s_waitcnt vmcnt(0)
    buffer_load_dwordx2 v[64:65], v233, s[4:7], 0 offen offset:0
    buffer_load_dwordx2 v[66:67], v233, s[4:7], 0 offen offset:32
    buffer_load_dwordx2 v[68:69], v233, s[4:7], 0 offen offset:64
    buffer_load_dwordx2 v[70:71], v233, s[4:7], 0 offen offset:96
    s_mov_b32 s72, s56
    s_mov_b32 s73, s57
    s_mov_b32 s74, 2048
    s_mov_b32 s75, 0x20000
    buffer_load_dwordx2 v[72:73], v234, s[72:75], 0 offen offset:0
    buffer_load_dwordx2 v[74:75], v234, s[72:75], 0 offen offset:32
    buffer_load_dwordx2 v[76:77], v234, s[72:75], 0 offen offset:64
    buffer_load_dwordx2 v[78:79], v234, s[72:75], 0 offen offset:96
    s_mov_b32 s72, s66
    s_mov_b32 s73, s67
    buffer_load_dwordx2 v[80:81], v234, s[72:75], 0 offen offset:0
    buffer_load_dwordx2 v[82:83], v234, s[72:75], 0 offen offset:32
    buffer_load_dwordx2 v[84:85], v234, s[72:75], 0 offen offset:64
    buffer_load_dwordx2 v[86:87], v234, s[72:75], 0 offen offset:96
    v_mul_f32 v100, v227, v100
    v_fmac_f32 v100, v226, v164
    v_mul_f32 v101, v227, v101
    v_fmac_f32 v101, v226, v165
    v_mul_f32 v102, v227, v102
    v_fmac_f32 v102, v226, v166
    v_mul_f32 v103, v227, v103
    v_fmac_f32 v103, v226, v167
    v_mul_f32 v116, v227, v116
    v_fmac_f32 v116, v226, v180
    v_mul_f32 v117, v227, v117
    v_fmac_f32 v117, v226, v181
    v_mul_f32 v118, v227, v118
    v_fmac_f32 v118, v226, v182
    v_mul_f32 v119, v227, v119
    v_fmac_f32 v119, v226, v183
    v_mul_f32 v132, v227, v132
    v_fmac_f32 v132, v226, v196
    v_mul_f32 v133, v227, v133
    v_fmac_f32 v133, v226, v197
    v_mul_f32 v134, v227, v134
    v_fmac_f32 v134, v226, v198
    v_mul_f32 v135, v227, v135
    v_fmac_f32 v135, v226, v199
    v_mul_f32 v148, v227, v148
    v_fmac_f32 v148, v226, v212
    v_mul_f32 v149, v227, v149
    v_fmac_f32 v149, v226, v213
    v_mul_f32 v150, v227, v150
    v_fmac_f32 v150, v226, v214
    v_mul_f32 v151, v227, v151
    v_fmac_f32 v151, v226, v215
    v_cvt_pk_bf16_f32 v100, v100, v101
    v_cvt_pk_bf16_f32 v101, v102, v103
    v_cvt_pk_bf16_f32 v102, v116, v117
    v_cvt_pk_bf16_f32 v103, v118, v119
    buffer_store_dwordx4 v[100:103], v235, s[16:19], s44 offen offset:0 sc1
    v_cvt_pk_bf16_f32 v132, v132, v133
    v_cvt_pk_bf16_f32 v133, v134, v135
    v_cvt_pk_bf16_f32 v134, v148, v149
    v_cvt_pk_bf16_f32 v135, v150, v151
    buffer_store_dwordx4 v[132:135], v235, s[16:19], s44 offen offset:1024 sc1
    v_mul_f32 v104, v229, v104
    v_fmac_f32 v104, v228, v168
    v_mul_f32 v105, v229, v105
    v_fmac_f32 v105, v228, v169
    v_mul_f32 v106, v229, v106
    v_fmac_f32 v106, v228, v170
    v_mul_f32 v107, v229, v107
    v_fmac_f32 v107, v228, v171
    v_mul_f32 v120, v229, v120
    v_fmac_f32 v120, v228, v184
    v_mul_f32 v121, v229, v121
    v_fmac_f32 v121, v228, v185
    v_mul_f32 v122, v229, v122
    v_fmac_f32 v122, v228, v186
    v_mul_f32 v123, v229, v123
    v_fmac_f32 v123, v228, v187
    v_mul_f32 v136, v229, v136
    v_fmac_f32 v136, v228, v200
    v_mul_f32 v137, v229, v137
    v_fmac_f32 v137, v228, v201
    v_mul_f32 v138, v229, v138
    v_fmac_f32 v138, v228, v202
    v_mul_f32 v139, v229, v139
    v_fmac_f32 v139, v228, v203
    v_mul_f32 v152, v229, v152
    v_fmac_f32 v152, v228, v216
    v_mul_f32 v153, v229, v153
    v_fmac_f32 v153, v228, v217
    v_mul_f32 v154, v229, v154
    v_fmac_f32 v154, v228, v218
    v_mul_f32 v155, v229, v155
    v_fmac_f32 v155, v228, v219
    v_cvt_pk_bf16_f32 v104, v104, v105
    v_cvt_pk_bf16_f32 v105, v106, v107
    v_cvt_pk_bf16_f32 v106, v120, v121
    v_cvt_pk_bf16_f32 v107, v122, v123
    buffer_store_dwordx4 v[104:107], v235, s[16:19], s45 offen offset:0 sc1
    v_cvt_pk_bf16_f32 v136, v136, v137
    v_cvt_pk_bf16_f32 v137, v138, v139
    v_cvt_pk_bf16_f32 v138, v152, v153
    v_cvt_pk_bf16_f32 v139, v154, v155
    buffer_store_dwordx4 v[136:139], v235, s[16:19], s45 offen offset:1024 sc1
    v_mul_f32 v108, v231, v108
    v_fmac_f32 v108, v230, v172
    v_mul_f32 v109, v231, v109
    v_fmac_f32 v109, v230, v173
    v_mul_f32 v110, v231, v110
    v_fmac_f32 v110, v230, v174
    v_mul_f32 v111, v231, v111
    v_fmac_f32 v111, v230, v175
    v_mul_f32 v124, v231, v124
    v_fmac_f32 v124, v230, v188
    v_mul_f32 v125, v231, v125
    v_fmac_f32 v125, v230, v189
    v_mul_f32 v126, v231, v126
    v_fmac_f32 v126, v230, v190
    v_mul_f32 v127, v231, v127
    v_fmac_f32 v127, v230, v191
    v_mul_f32 v140, v231, v140
    v_fmac_f32 v140, v230, v204
    v_mul_f32 v141, v231, v141
    v_fmac_f32 v141, v230, v205
    v_mul_f32 v142, v231, v142
    v_fmac_f32 v142, v230, v206
    v_mul_f32 v143, v231, v143
    v_fmac_f32 v143, v230, v207
    v_mul_f32 v156, v231, v156
    v_fmac_f32 v156, v230, v220
    v_mul_f32 v157, v231, v157
    v_fmac_f32 v157, v230, v221
    v_mul_f32 v158, v231, v158
    v_fmac_f32 v158, v230, v222
    v_mul_f32 v159, v231, v159
    v_fmac_f32 v159, v230, v223
    v_cvt_pk_bf16_f32 v108, v108, v109
    v_cvt_pk_bf16_f32 v109, v110, v111
    v_cvt_pk_bf16_f32 v110, v124, v125
    v_cvt_pk_bf16_f32 v111, v126, v127
    buffer_store_dwordx4 v[108:111], v235, s[16:19], s46 offen offset:0 sc1
    v_cvt_pk_bf16_f32 v140, v140, v141
    v_cvt_pk_bf16_f32 v141, v142, v143
    v_cvt_pk_bf16_f32 v142, v156, v157
    v_cvt_pk_bf16_f32 v143, v158, v159
    buffer_store_dwordx4 v[140:143], v235, s[16:19], s46 offen offset:1024 sc1
    v_mul_f32 v96, v225, v96
    v_fmac_f32 v96, v224, v160
    v_mul_f32 v97, v225, v97
    v_fmac_f32 v97, v224, v161
    v_mul_f32 v98, v225, v98
    v_fmac_f32 v98, v224, v162
    v_mul_f32 v99, v225, v99
    v_fmac_f32 v99, v224, v163
    v_mul_f32 v112, v225, v112
    v_fmac_f32 v112, v224, v176
    v_mul_f32 v113, v225, v113
    v_fmac_f32 v113, v224, v177
    v_mul_f32 v114, v225, v114
    v_fmac_f32 v114, v224, v178
    v_mul_f32 v115, v225, v115
    v_fmac_f32 v115, v224, v179
    v_mul_f32 v128, v225, v128
    v_fmac_f32 v128, v224, v192
    v_mul_f32 v129, v225, v129
    v_fmac_f32 v129, v224, v193
    v_mul_f32 v130, v225, v130
    v_fmac_f32 v130, v224, v194
    v_mul_f32 v131, v225, v131
    v_fmac_f32 v131, v224, v195
    v_mul_f32 v144, v225, v144
    v_fmac_f32 v144, v224, v208
    v_mul_f32 v145, v225, v145
    v_fmac_f32 v145, v224, v209
    v_mul_f32 v146, v225, v146
    v_fmac_f32 v146, v224, v210
    v_mul_f32 v147, v225, v147
    v_fmac_f32 v147, v224, v211
    s_and_b32 s76, s2, 1
    v_mul_u32_u24 v7, 2, v0
    v_add_u32 v7, s76, v7
    s_lshr_b32 s76, s87, 2
    v_and_b32 v8, 1, v0
    v_xor_b32 v8, s76, v8
    v_xor_b32 v8, 1, v8
    s_lshr_b32 s76, s2, 3
    s_and_b32 s76, s76, 15
    v_lshlrev_b32 v8, 4, v8
    v_add_u32 v8, s76, v8
    v_lshl_or_b32 v8, v8, 3, v7
    v_lshlrev_b32 v8, 8, v8
    v_subrev_u32 v7, s0, v0
    v_and_b32 v7, 3, v7
    v_sub_u32 v7, 3, v7
    v_lshl_add_u32 v8, v7, 2, v8
    v_mov_b32 v9, 1
    s_lshl_b32 s76, 1, s0
    s_andn2_b32 s76, 15, s76
    s_lshl_b32 s77, s28, 4
    s_add_u32 s77, s77, 25362464
    s_lshl_b32 s79, s2, 8
    s_add_u32 s79, s79, s77
    s_waitcnt vmcnt(6)
    v_lshlrev_b32 v2, 16, v64
    v_and_b32 v3, 0xffff0000, v64
    v_lshlrev_b32 v4, 16, v72
    v_and_b32 v5, 0xffff0000, v72
    v_mul_f32 v2, v2, v4
    v_mul_f32 v3, v3, v5
    v_cvt_pk_bf16_f32 v2, v2, v3
    v_and_b32 v3, 0xffff0000, v2
    v_lshlrev_b32 v2, 16, v2
    v_fmac_f32 v96, v224, v2
    v_fmac_f32 v97, v224, v3
    v_lshlrev_b32 v2, 16, v80
    v_and_b32 v3, 0xffff0000, v80
    v_fmac_f32 v96, v225, v2
    v_fmac_f32 v97, v225, v3
    v_lshlrev_b32 v2, 16, v65
    v_and_b32 v3, 0xffff0000, v65
    v_lshlrev_b32 v4, 16, v73
    v_and_b32 v5, 0xffff0000, v73
    v_mul_f32 v2, v2, v4
    v_mul_f32 v3, v3, v5
    v_cvt_pk_bf16_f32 v2, v2, v3
    v_and_b32 v3, 0xffff0000, v2
    v_lshlrev_b32 v2, 16, v2
    v_fmac_f32 v98, v224, v2
    v_fmac_f32 v99, v224, v3
    v_lshlrev_b32 v2, 16, v81
    v_and_b32 v3, 0xffff0000, v81
    v_fmac_f32 v98, v225, v2
    v_fmac_f32 v99, v225, v3
    v_lshlrev_b32 v2, 16, v66
    v_and_b32 v3, 0xffff0000, v66
    v_lshlrev_b32 v4, 16, v74
    v_and_b32 v5, 0xffff0000, v74
    v_mul_f32 v2, v2, v4
    v_mul_f32 v3, v3, v5
    v_cvt_pk_bf16_f32 v2, v2, v3
    v_and_b32 v3, 0xffff0000, v2
    v_lshlrev_b32 v2, 16, v2
    v_fmac_f32 v112, v224, v2
    v_fmac_f32 v113, v224, v3
    v_lshlrev_b32 v2, 16, v82
    v_and_b32 v3, 0xffff0000, v82
    v_fmac_f32 v112, v225, v2
    v_fmac_f32 v113, v225, v3
    v_lshlrev_b32 v2, 16, v67
    v_and_b32 v3, 0xffff0000, v67
    v_lshlrev_b32 v4, 16, v75
    v_and_b32 v5, 0xffff0000, v75
    v_mul_f32 v2, v2, v4
    v_mul_f32 v3, v3, v5
    v_cvt_pk_bf16_f32 v2, v2, v3
    v_and_b32 v3, 0xffff0000, v2
    v_lshlrev_b32 v2, 16, v2
    v_fmac_f32 v114, v224, v2
    v_fmac_f32 v115, v224, v3
    v_lshlrev_b32 v2, 16, v83
    v_and_b32 v3, 0xffff0000, v83
    v_fmac_f32 v114, v225, v2
    v_fmac_f32 v115, v225, v3
    v_lshlrev_b32 v2, 16, v68
    v_and_b32 v3, 0xffff0000, v68
    v_lshlrev_b32 v4, 16, v76
    v_and_b32 v5, 0xffff0000, v76
    v_mul_f32 v2, v2, v4
    v_mul_f32 v3, v3, v5
    v_cvt_pk_bf16_f32 v2, v2, v3
    v_and_b32 v3, 0xffff0000, v2
    v_lshlrev_b32 v2, 16, v2
    v_fmac_f32 v128, v224, v2
    v_fmac_f32 v129, v224, v3
    v_lshlrev_b32 v2, 16, v84
    v_and_b32 v3, 0xffff0000, v84
    v_fmac_f32 v128, v225, v2
    v_fmac_f32 v129, v225, v3
    v_lshlrev_b32 v2, 16, v69
    v_and_b32 v3, 0xffff0000, v69
    v_lshlrev_b32 v4, 16, v77
    v_and_b32 v5, 0xffff0000, v77
    v_mul_f32 v2, v2, v4
    v_mul_f32 v3, v3, v5
    v_cvt_pk_bf16_f32 v2, v2, v3
    v_and_b32 v3, 0xffff0000, v2
    v_lshlrev_b32 v2, 16, v2
    v_fmac_f32 v130, v224, v2
    v_fmac_f32 v131, v224, v3
    v_lshlrev_b32 v2, 16, v85
    v_and_b32 v3, 0xffff0000, v85
    v_fmac_f32 v130, v225, v2
    v_fmac_f32 v131, v225, v3
    v_lshlrev_b32 v2, 16, v70
    v_and_b32 v3, 0xffff0000, v70
    v_lshlrev_b32 v4, 16, v78
    v_and_b32 v5, 0xffff0000, v78
    v_mul_f32 v2, v2, v4
    v_mul_f32 v3, v3, v5
    v_cvt_pk_bf16_f32 v2, v2, v3
    v_and_b32 v3, 0xffff0000, v2
    v_lshlrev_b32 v2, 16, v2
    v_fmac_f32 v144, v224, v2
    v_fmac_f32 v145, v224, v3
    v_lshlrev_b32 v2, 16, v86
    v_and_b32 v3, 0xffff0000, v86
    v_fmac_f32 v144, v225, v2
    v_fmac_f32 v145, v225, v3
    v_lshlrev_b32 v2, 16, v71
    v_and_b32 v3, 0xffff0000, v71
    v_lshlrev_b32 v4, 16, v79
    v_and_b32 v5, 0xffff0000, v79
    v_mul_f32 v2, v2, v4
    v_mul_f32 v3, v3, v5
    v_cvt_pk_bf16_f32 v2, v2, v3
    v_and_b32 v3, 0xffff0000, v2
    v_lshlrev_b32 v2, 16, v2
    v_fmac_f32 v146, v224, v2
    v_fmac_f32 v147, v224, v3
    v_lshlrev_b32 v2, 16, v87
    v_and_b32 v3, 0xffff0000, v87
    v_fmac_f32 v146, v225, v2
    v_fmac_f32 v147, v225, v3
    s_waitcnt vmcnt(0)
    s_mov_b32 exec_lo, s76
    s_mov_b32 exec_hi, 0
    buffer_store_dword v9, v8, s[16:19], s77 offen sc1
    s_mov_b64 exec, -1
    v_mov_b32 v6, s79
    s_mov_b32 s90, 300000
L_poll38:
    s_sub_u32 s90, s90, 1
    s_cmp_eq_u32 s90, 0
    s_cbranch_scc1 L_pok39
    buffer_load_dwordx4 v[2:5], v6, s[16:19], 0 offen sc1
    s_waitcnt vmcnt(0)
    v_readfirstlane_b32 s88, v2
    v_readfirstlane_b32 s89, v3
    v_readfirstlane_b32 s91, v4
    s_nop 3
    s_and_b32 s88, s88, s89
    s_and_b32 s88, s88, s91
    s_cmp_lg_u32 s88, 0
    s_cbranch_scc1 L_pok39
    s_sleep 1
    s_branch L_poll38
L_pok39:
    s_lshl_b32 s76, s2, 3
    s_add_u32 s76, s76, s28
    s_mul_i32 s76, s76, 12288
    s_add_u32 s76, s76, 33554432
    buffer_load_dwordx4 v[32:35], v235, s[16:19], s76 offen offset:0 sc1
    buffer_load_dwordx4 v[36:39], v235, s[16:19], s76 offen offset:1024 sc1
    s_add_u32 s76, s76, 4096
    buffer_load_dwordx4 v[40:43], v235, s[16:19], s76 offen offset:0 sc1
    buffer_load_dwordx4 v[44:47], v235, s[16:19], s76 offen offset:1024 sc1
    s_add_u32 s76, s76, 4096
    buffer_load_dwordx4 v[48:51], v235, s[16:19], s76 offen offset:0 sc1
    buffer_load_dwordx4 v[52:55], v235, s[16:19], s76 offen offset:1024 sc1
    s_mov_b32 s72, s70
    s_mov_b32 s73, s71
    s_mov_b32 s74, 8388608
    s_mov_b32 s75, 0x20000
    v_lshlrev_b32 v2, 12, v232
    v_lshl_add_u32 v2, v234, 1, v2
    s_waitcnt vmcnt(0)
    v_lshlrev_b32 v4, 16, v32
    v_and_b32 v5, 0xffff0000, v32
    v_add_f32 v96, v96, v4
    v_add_f32 v97, v97, v5
    v_lshlrev_b32 v4, 16, v33
    v_and_b32 v5, 0xffff0000, v33
    v_add_f32 v98, v98, v4
    v_add_f32 v99, v99, v5
    v_lshlrev_b32 v4, 16, v40
    v_and_b32 v5, 0xffff0000, v40
    v_add_f32 v96, v96, v4
    v_add_f32 v97, v97, v5
    v_lshlrev_b32 v4, 16, v41
    v_and_b32 v5, 0xffff0000, v41
    v_add_f32 v98, v98, v4
    v_add_f32 v99, v99, v5
    v_lshlrev_b32 v4, 16, v48
    v_and_b32 v5, 0xffff0000, v48
    v_add_f32 v96, v96, v4
    v_add_f32 v97, v97, v5
    v_lshlrev_b32 v4, 16, v49
    v_and_b32 v5, 0xffff0000, v49
    v_add_f32 v98, v98, v4
    v_add_f32 v99, v99, v5
    buffer_store_dwordx4 v[96:99], v2, s[72:75], 0 offen offset:0
    v_lshlrev_b32 v4, 16, v34
    v_and_b32 v5, 0xffff0000, v34
    v_add_f32 v112, v112, v4
    v_add_f32 v113, v113, v5
    v_lshlrev_b32 v4, 16, v35
    v_and_b32 v5, 0xffff0000, v35
    v_add_f32 v114, v114, v4
    v_add_f32 v115, v115, v5
    v_lshlrev_b32 v4, 16, v42
    v_and_b32 v5, 0xffff0000, v42
    v_add_f32 v112, v112, v4
    v_add_f32 v113, v113, v5
    v_lshlrev_b32 v4, 16, v43
    v_and_b32 v5, 0xffff0000, v43
    v_add_f32 v114, v114, v4
    v_add_f32 v115, v115, v5
    v_lshlrev_b32 v4, 16, v50
    v_and_b32 v5, 0xffff0000, v50
    v_add_f32 v112, v112, v4
    v_add_f32 v113, v113, v5
    v_lshlrev_b32 v4, 16, v51
    v_and_b32 v5, 0xffff0000, v51
    v_add_f32 v114, v114, v4
    v_add_f32 v115, v115, v5
    buffer_store_dwordx4 v[112:115], v2, s[72:75], 0 offen offset:64
    v_lshlrev_b32 v4, 16, v36
    v_and_b32 v5, 0xffff0000, v36
    v_add_f32 v128, v128, v4
    v_add_f32 v129, v129, v5
    v_lshlrev_b32 v4, 16, v37
    v_and_b32 v5, 0xffff0000, v37
    v_add_f32 v130, v130, v4
    v_add_f32 v131, v131, v5
    v_lshlrev_b32 v4, 16, v44
    v_and_b32 v5, 0xffff0000, v44
    v_add_f32 v128, v128, v4
    v_add_f32 v129, v129, v5
    v_lshlrev_b32 v4, 16, v45
    v_and_b32 v5, 0xffff0000, v45
    v_add_f32 v130, v130, v4
    v_add_f32 v131, v131, v5
    v_lshlrev_b32 v4, 16, v52
    v_and_b32 v5, 0xffff0000, v52
    v_add_f32 v128, v128, v4
    v_add_f32 v129, v129, v5
    v_lshlrev_b32 v4, 16, v53
    v_and_b32 v5, 0xffff0000, v53
    v_add_f32 v130, v130, v4
    v_add_f32 v131, v131, v5
    buffer_store_dwordx4 v[128:131], v2, s[72:75], 0 offen offset:128
    v_lshlrev_b32 v4, 16, v38
    v_and_b32 v5, 0xffff0000, v38
    v_add_f32 v144, v144, v4
    v_add_f32 v145, v145, v5
    v_lshlrev_b32 v4, 16, v39
    v_and_b32 v5, 0xffff0000, v39
    v_add_f32 v146, v146, v4
    v_add_f32 v147, v147, v5
    v_lshlrev_b32 v4, 16, v46
    v_and_b32 v5, 0xffff0000, v46
    v_add_f32 v144, v144, v4
    v_add_f32 v145, v145, v5
    v_lshlrev_b32 v4, 16, v47
    v_and_b32 v5, 0xffff0000, v47
    v_add_f32 v146, v146, v4
    v_add_f32 v147, v147, v5
    v_lshlrev_b32 v4, 16, v54
    v_and_b32 v5, 0xffff0000, v54
    v_add_f32 v144, v144, v4
    v_add_f32 v145, v145, v5
    v_lshlrev_b32 v4, 16, v55
    v_and_b32 v5, 0xffff0000, v55
    v_add_f32 v146, v146, v4
    v_add_f32 v147, v147, v5
    buffer_store_dwordx4 v[144:147], v2, s[72:75], 0 offen offset:192
    s_branch L_fin
L_ssm:
    s_lshr_b32 s80, s28, 1
    s_and_b32 s81, s28, 1
    v_and_b32 v2, 7, v0
    v_lshrrev_b32 v3, 4, v0
    v_xor_b32 v2, v2, v3
    v_lshlrev_b32 v2, 4, v2
    v_lshrrev_b32 v3, 5, v0
    v_lshlrev_b32 v3, 4, v3
    v_bfe_u32 v4, v0, 3, 2
    v_add_u32 v3, v3, v4
    v_lshl_add_u32 v5, v3, 11, v2
    s_lshl_b32 s76, s28, 1
    s_and_b32 s76, s76, 3
    s_lshl_b32 s76, s76, 2
    s_lshl_b32 s77, s80, 6
    s_add_u32 s76, s76, s77
    s_lshl_b32 s77, s29, 8
    s_add_u32 s76, s76, s77
    s_lshl_b32 s76, s76, 11
    v_add_u32 v10, s76, v5
    s_lshl_b32 s76, s28, 1
    s_and_b32 s76, s76, 3
    s_lshl_b32 s76, s76, 2
    s_lshl_b32 s77, s80, 6
    s_add_u32 s76, s76, s77
    s_lshl_b32 s77, s29, 8
    s_add_u32 s76, s76, s77
    s_add_u32 s76, s76, 32
    s_lshl_b32 s76, s76, 11
    s_sub_u32 s76, s76, 1024
    v_xor_b32 v11, 64, v5
    v_add_u32 v11, s76, v11
    s_lshl_b32 s76, s28, 1
    s_add_u32 s76, s76, 1
    s_and_b32 s76, s76, 3
    s_lshl_b32 s76, s76, 2
    s_lshl_b32 s77, s80, 6
    s_add_u32 s76, s76, s77
    s_lshl_b32 s77, s29, 8
    s_add_u32 s76, s76, s77
    s_lshl_b32 s76, s76, 11
    s_sub_u32 s76, s76, 2048
    v_add_u32 v12, s76, v5
    s_lshl_b32 s76, s28, 1
    s_add_u32 s76, s76, 1
    s_and_b32 s76, s76, 3
    s_lshl_b32 s76, s76, 2
    s_lshl_b32 s77, s80, 6
    s_add_u32 s76, s76, s77
    s_lshl_b32 s77, s29, 8
    s_add_u32 s76, s76, s77
    s_add_u32 s76, s76, 32
    s_lshl_b32 s76, s76, 11
    s_sub_u32 s76, s76, 3072
    v_xor_b32 v13, 64, v5
    v_add_u32 v13, s76, v13
    v_lshrrev_b32 v3, 3, v0
    v_lshl_add_u32 v5, v3, 12, v2
    s_lshr_b32 s76, s28, 2
    s_lshl_b32 s76, s76, 5
    s_and_b32 s77, s28, 1
    s_lshl_b32 s78, s77, 6
    s_lshl_b32 s77, s77, 4
    s_add_u32 s76, s76, s77
    s_bfe_u32 s77, s28, 0x10001
    s_add_u32 s76, s76, s77
    s_lshl_b32 s77, s30, 6
    s_add_u32 s76, s76, s77
    s_lshl_b32 s76, s76, 11
    v_xor_b32 v17, s78, v5
    v_add_u32 v17, s76, v17
    v_mov_b32 v18, v17
    s_lshl_b32 s38, s28, 12
    s_lshl_b32 s39, s28, 10
    s_add_u32 s39, s39, 32768
    s_lshl_b32 s37, s82, 7
    s_waitcnt lgkmcnt(0)
    s_mov_b32 s4, s40
    s_mov_b32 s5, s41
    s_mov_b32 s6, 4194304
    s_mov_b32 s7, 0x20000
    s_mov_b32 s16, s74
    s_mov_b32 s17, s75
    s_mov_b32 s18, 268435456
    s_mov_b32 s19, 0x20000
    s_mov_b32 s20, s72
    s_mov_b32 s21, s73
    s_mov_b32 s22, 256
    s_mov_b32 s23, 0x20000
    s_mov_b32 s8, s46
    s_mov_b32 s9, s47
    s_mov_b32 s10, 2097152
    s_mov_b32 s11, 0x20000
    s_mov_b32 s12, s48
    s_mov_b32 s13, s49
    s_mov_b32 s14, 2097152
    s_mov_b32 s15, 0x20000
    s_mov_b32 s36, s37
    s_lshl_b32 s76, s29, 4
    s_add_u32 s76, s76, s30
    s_mul_i32 s84, s76, 57344
    s_mul_i32 s77, s28, 7168
    s_add_u32 s84, s84, s77
    s_mov_b32 s72, s64
    s_mov_b32 s73, s65
    s_add_u32 s74, s84, 7168
    s_mov_b32 s75, 0x20000
    s_lshr_b32 s77, s76, 6
    s_cmp_eq_u32 s77, 0
    s_cselect_b32 s24, s50, s52
    s_cselect_b32 s25, s51, s53
    s_and_b32 s83, s76, 63
    s_lshl_b32 s83, s83, 15
    s_lshl_b32 s77, s28, 12
    s_add_u32 s83, s83, s77
    s_add_u32 s26, s83, 4096
    s_mov_b32 s27, 0x20000
    v_lshlrev_b32 v236, 4, v0
    s_mov_b32 s32, 0
    s_add_u32 s35, s32, s38
    s_mov_b32 m0, s35
    s_nop 0
    buffer_load_dwordx4 v10, s[4:7], s36 offen lds
    buffer_load_dwordx4 v11, s[4:7], s36 offen offset:1024 lds
    buffer_load_dwordx4 v12, s[4:7], s36 offen offset:2048 lds
    buffer_load_dwordx4 v13, s[4:7], s36 offen offset:3072 lds
    s_add_u32 s36, s36, 128
    s_and_b32 s36, s36, 2047
    s_add_u32 s35, s32, s39
    s_mov_b32 m0, s35
    s_nop 0
    buffer_load_dwordx4 v17, s[8:11], s37 offen lds
    s_add_u32 s35, s32, s39
    s_add_u32 s35, s35, 8192
    s_mov_b32 m0, s35
    s_nop 0
    buffer_load_dwordx4 v18, s[12:15], s37 offen lds
    s_add_u32 s37, s37, 128
    s_and_b32 s37, s37, 2047
    s_add_u32 s32, s32, 49152
    s_mul_i32 s76, s80, 4
    v_and_b32 v2, 15, v0
    v_lshrrev_b32 v3, 4, v0
    v_lshrrev_b32 v4, 1, v2
    v_xor_b32 v3, v3, v4
    v_lshlrev_b32 v3, 4, v3
    v_lshl_add_u32 v2, v2, 7, v3
    s_lshl_b32 s88, s76, 11
    v_add_u32 v14, s88, v2
    s_lshl_b32 s76, s81, 1
    v_and_b32 v2, 15, v0
    v_lshrrev_b32 v3, 4, v0
    v_lshrrev_b32 v4, 1, v2
    v_xor_b32 v3, v3, v4
    v_lshlrev_b32 v3, 4, v3
    v_lshl_add_u32 v2, v2, 7, v3
    s_lshl_b32 s88, s76, 11
    s_add_u32 s88, s88, 32768
    v_add_u32 v19, s88, v2
    s_add_u32 s35, s32, s38
    s_mov_b32 m0, s35
    s_nop 0
    buffer_load_dwordx4 v10, s[4:7], s36 offen lds
    buffer_load_dwordx4 v11, s[4:7], s36 offen offset:1024 lds
    buffer_load_dwordx4 v12, s[4:7], s36 offen offset:2048 lds
    buffer_load_dwordx4 v13, s[4:7], s36 offen offset:3072 lds
    s_add_u32 s36, s36, 128
    s_and_b32 s36, s36, 2047
    s_add_u32 s35, s32, s39
    s_mov_b32 m0, s35
    s_nop 0
    buffer_load_dwordx4 v17, s[8:11], s37 offen lds
    s_add_u32 s35, s32, s39
    s_add_u32 s35, s35, 8192
    s_mov_b32 m0, s35
    s_nop 0
    buffer_load_dwordx4 v18, s[12:15], s37 offen lds
    s_add_u32 s37, s37, 128
    s_and_b32 s37, s37, 2047
    s_add_u32 s32, s32, 49152
    s_add_u32 s35, s32, s39
    s_mov_b32 m0, s35
    s_nop 0
    buffer_load_dwordx4 v17, s[8:11], s37 offen lds
    s_add_u32 s35, s32, s39
    s_add_u32 s35, s35, 8192
    s_mov_b32 m0, s35
    s_nop 0
    buffer_load_dwordx4 v18, s[12:15], s37 offen lds
    s_add_u32 s37, s37, 128
    s_and_b32 s37, s37, 2047
    s_add_u32 s32, s32, 49152
    s_waitcnt vmcnt(8)
    s_barrier
    v_mov_b32 v15, v14
    v_xor_b32 v16, 64, v14
    v_mov_b32 v20, v19
    v_xor_b32 v21, 64, v19
    s_mov_b32 s33, 0
    s_mov_b32 s32, 98304
    ds_read_b128 v[22:25], v15 offset:0
    ds_read_b128 v[38:41], v20 offset:0
    ds_read_b128 v[26:29], v15 offset:2048
    ds_read_b128 v[42:45], v20 offset:8192
    ds_read_b128 v[30:33], v15 offset:4096
    ds_read_b128 v[46:49], v20 offset:2048
    ds_read_b128 v[34:37], v15 offset:6144
    ds_read_b128 v[50:53], v20 offset:10240
    s_mov_b32 s31, s32
    s_mov_b32 s32, s33
    s_add_u32 s33, s33, 49152
    s_cmp_eq_u32 s33, 147456
    s_cselect_b32 s33, 0, s33
    s_waitcnt lgkmcnt(0)
    v_mfma_f32_16x16x32_bf16 v[86:89], v[22:25], v[38:41], 0
    ds_read_b128 v[54:57], v16 offset:0
    v_mfma_f32_16x16x32_bf16 v[90:93], v[22:25], v[42:45], 0
    s_add_u32 s35, s31, s38
    s_mov_b32 m0, s35
    s_nop 0
    buffer_load_dwordx4 v10, s[4:7], s36 offen lds
    v_mfma_f32_16x16x32_bf16 v[94:97], v[22:25], v[46:49], 0
    ds_read_b128 v[70:73], v21 offset:0
    v_mfma_f32_16x16x32_bf16 v[98:101], v[22:25], v[50:53], 0
    buffer_load_dwordx4 v11, s[4:7], s36 offen offset:1024 lds
    v_mfma_f32_16x16x32_bf16 v[102:105], v[26:29], v[38:41], 0
    ds_read_b128 v[58:61], v16 offset:2048
    v_mfma_f32_16x16x32_bf16 v[106:109], v[26:29], v[42:45], 0
    ds_read_b128 v[74:77], v21 offset:8192
    v_mfma_f32_16x16x32_bf16 v[110:113], v[26:29], v[46:49], 0
    buffer_load_dwordx4 v12, s[4:7], s36 offen offset:2048 lds
    v_mfma_f32_16x16x32_bf16 v[114:117], v[26:29], v[50:53], 0
    v_mfma_f32_16x16x32_bf16 v[118:121], v[30:33], v[38:41], 0
    ds_read_b128 v[62:65], v16 offset:4096
    v_mfma_f32_16x16x32_bf16 v[122:125], v[30:33], v[42:45], 0
    ds_read_b128 v[78:81], v21 offset:2048
    v_mfma_f32_16x16x32_bf16 v[126:129], v[30:33], v[46:49], 0
    buffer_load_dwordx4 v13, s[4:7], s36 offen offset:3072 lds
    v_mfma_f32_16x16x32_bf16 v[130:133], v[30:33], v[50:53], 0
    ds_read_b128 v[66:69], v16 offset:6144
    v_mfma_f32_16x16x32_bf16 v[134:137], v[34:37], v[38:41], 0
    ds_read_b128 v[82:85], v21 offset:10240
    v_mfma_f32_16x16x32_bf16 v[138:141], v[34:37], v[42:45], 0
    s_add_u32 s36, s36, 128
    s_and_b32 s36, s36, 2047
    v_mfma_f32_16x16x32_bf16 v[142:145], v[34:37], v[46:49], 0
    v_add_u32 v15, s33, v14
    v_add_u32 v20, s33, v19
    v_mfma_f32_16x16x32_bf16 v[146:149], v[34:37], v[50:53], 0
    s_waitcnt vmcnt(6) lgkmcnt(0)
    s_barrier
    s_setprio 1
    v_mfma_f32_16x16x32_bf16 v[86:89], v[54:57], v[70:73], v[86:89]
    ds_read_b128 v[22:25], v15 offset:0
    v_mfma_f32_16x16x32_bf16 v[90:93], v[54:57], v[74:77], v[90:93]
    s_add_u32 s35, s32, s39
    s_mov_b32 m0, s35
    s_nop 0
    buffer_load_dwordx4 v17, s[8:11], s37 offen lds
    v_mfma_f32_16x16x32_bf16 v[94:97], v[54:57], v[78:81], v[94:97]
    ds_read_b128 v[38:41], v20 offset:0
    v_mfma_f32_16x16x32_bf16 v[98:101], v[54:57], v[82:85], v[98:101]
    v_mfma_f32_16x16x32_bf16 v[102:105], v[58:61], v[70:73], v[102:105]
    ds_read_b128 v[26:29], v15 offset:2048
    v_mfma_f32_16x16x32_bf16 v[106:109], v[58:61], v[74:77], v[106:109]
    s_add_u32 s35, s32, s39
    s_add_u32 s35, s35, 8192
    s_mov_b32 m0, s35
    s_nop 0
    buffer_load_dwordx4 v18, s[12:15], s37 offen lds
    v_mfma_f32_16x16x32_bf16 v[110:113], v[58:61], v[78:81], v[110:113]
    ds_read_b128 v[42:45], v20 offset:8192
    v_mfma_f32_16x16x32_bf16 v[114:117], v[58:61], v[82:85], v[114:117]
    v_mfma_f32_16x16x32_bf16 v[118:121], v[62:65], v[70:73], v[118:121]
    ds_read_b128 v[30:33], v15 offset:4096
    v_mfma_f32_16x16x32_bf16 v[122:125], v[62:65], v[74:77], v[122:125]
    ds_read_b128 v[46:49], v20 offset:2048
    v_mfma_f32_16x16x32_bf16 v[126:129], v[62:65], v[78:81], v[126:129]
    s_add_u32 s37, s37, 128
    s_and_b32 s37, s37, 2047
    v_mfma_f32_16x16x32_bf16 v[130:133], v[62:65], v[82:85], v[130:133]
    v_mfma_f32_16x16x32_bf16 v[134:137], v[66:69], v[70:73], v[134:137]
    ds_read_b128 v[34:37], v15 offset:6144
    v_mfma_f32_16x16x32_bf16 v[138:141], v[66:69], v[74:77], v[138:141]
    ds_read_b128 v[50:53], v20 offset:10240
    v_mfma_f32_16x16x32_bf16 v[142:145], v[66:69], v[78:81], v[142:145]
    v_xor_b32 v16, 64, v15
    v_xor_b32 v21, 64, v20
    v_mfma_f32_16x16x32_bf16 v[146:149], v[66:69], v[82:85], v[146:149]
    s_setprio 0
    s_mov_b32 s34, 2
L_gl41:
    s_mov_b32 s31, s32
    s_mov_b32 s32, s33
    s_add_u32 s33, s33, 49152
    s_cmp_eq_u32 s33, 147456
    s_cselect_b32 s33, 0, s33
    s_waitcnt lgkmcnt(0)
    v_mfma_f32_16x16x32_bf16 v[86:89], v[22:25], v[38:41], v[86:89]
    ds_read_b128 v[54:57], v16 offset:0
    v_mfma_f32_16x16x32_bf16 v[90:93], v[22:25], v[42:45], v[90:93]
    s_add_u32 s35, s31, s38
    s_mov_b32 m0, s35
    s_nop 0
    buffer_load_dwordx4 v10, s[4:7], s36 offen lds
    v_mfma_f32_16x16x32_bf16 v[94:97], v[22:25], v[46:49], v[94:97]
    ds_read_b128 v[70:73], v21 offset:0
    v_mfma_f32_16x16x32_bf16 v[98:101], v[22:25], v[50:53], v[98:101]
    buffer_load_dwordx4 v11, s[4:7], s36 offen offset:1024 lds
    v_mfma_f32_16x16x32_bf16 v[102:105], v[26:29], v[38:41], v[102:105]
    ds_read_b128 v[58:61], v16 offset:2048
    v_mfma_f32_16x16x32_bf16 v[106:109], v[26:29], v[42:45], v[106:109]
    ds_read_b128 v[74:77], v21 offset:8192
    v_mfma_f32_16x16x32_bf16 v[110:113], v[26:29], v[46:49], v[110:113]
    buffer_load_dwordx4 v12, s[4:7], s36 offen offset:2048 lds
    v_mfma_f32_16x16x32_bf16 v[114:117], v[26:29], v[50:53], v[114:117]
    v_mfma_f32_16x16x32_bf16 v[118:121], v[30:33], v[38:41], v[118:121]
    ds_read_b128 v[62:65], v16 offset:4096
    v_mfma_f32_16x16x32_bf16 v[122:125], v[30:33], v[42:45], v[122:125]
    ds_read_b128 v[78:81], v21 offset:2048
    v_mfma_f32_16x16x32_bf16 v[126:129], v[30:33], v[46:49], v[126:129]
    buffer_load_dwordx4 v13, s[4:7], s36 offen offset:3072 lds
    v_mfma_f32_16x16x32_bf16 v[130:133], v[30:33], v[50:53], v[130:133]
    ds_read_b128 v[66:69], v16 offset:6144
    v_mfma_f32_16x16x32_bf16 v[134:137], v[34:37], v[38:41], v[134:137]
    ds_read_b128 v[82:85], v21 offset:10240
    v_mfma_f32_16x16x32_bf16 v[138:141], v[34:37], v[42:45], v[138:141]
    s_add_u32 s36, s36, 128
    s_and_b32 s36, s36, 2047
    v_mfma_f32_16x16x32_bf16 v[142:145], v[34:37], v[46:49], v[142:145]
    v_add_u32 v15, s33, v14
    v_add_u32 v20, s33, v19
    v_mfma_f32_16x16x32_bf16 v[146:149], v[34:37], v[50:53], v[146:149]
    s_waitcnt vmcnt(6) lgkmcnt(0)
    s_barrier
    s_setprio 1
    v_mfma_f32_16x16x32_bf16 v[86:89], v[54:57], v[70:73], v[86:89]
    ds_read_b128 v[22:25], v15 offset:0
    v_mfma_f32_16x16x32_bf16 v[90:93], v[54:57], v[74:77], v[90:93]
    s_add_u32 s35, s32, s39
    s_mov_b32 m0, s35
    s_nop 0
    buffer_load_dwordx4 v17, s[8:11], s37 offen lds
    v_mfma_f32_16x16x32_bf16 v[94:97], v[54:57], v[78:81], v[94:97]
    ds_read_b128 v[38:41], v20 offset:0
    v_mfma_f32_16x16x32_bf16 v[98:101], v[54:57], v[82:85], v[98:101]
    v_mfma_f32_16x16x32_bf16 v[102:105], v[58:61], v[70:73], v[102:105]
    ds_read_b128 v[26:29], v15 offset:2048
    v_mfma_f32_16x16x32_bf16 v[106:109], v[58:61], v[74:77], v[106:109]
    s_add_u32 s35, s32, s39
    s_add_u32 s35, s35, 8192
    s_mov_b32 m0, s35
    s_nop 0
    buffer_load_dwordx4 v18, s[12:15], s37 offen lds
    v_mfma_f32_16x16x32_bf16 v[110:113], v[58:61], v[78:81], v[110:113]
    ds_read_b128 v[42:45], v20 offset:8192
    v_mfma_f32_16x16x32_bf16 v[114:117], v[58:61], v[82:85], v[114:117]
    v_mfma_f32_16x16x32_bf16 v[118:121], v[62:65], v[70:73], v[118:121]
    ds_read_b128 v[30:33], v15 offset:4096
    v_mfma_f32_16x16x32_bf16 v[122:125], v[62:65], v[74:77], v[122:125]
    ds_read_b128 v[46:49], v20 offset:2048
    v_mfma_f32_16x16x32_bf16 v[126:129], v[62:65], v[78:81], v[126:129]
    s_add_u32 s37, s37, 128
    s_and_b32 s37, s37, 2047
    v_mfma_f32_16x16x32_bf16 v[130:133], v[62:65], v[82:85], v[130:133]
    v_mfma_f32_16x16x32_bf16 v[134:137], v[66:69], v[70:73], v[134:137]
    ds_read_b128 v[34:37], v15 offset:6144
    v_mfma_f32_16x16x32_bf16 v[138:141], v[66:69], v[74:77], v[138:141]
    ds_read_b128 v[50:53], v20 offset:10240
    v_mfma_f32_16x16x32_bf16 v[142:145], v[66:69], v[78:81], v[142:145]
    v_xor_b32 v16, 64, v15
    v_xor_b32 v21, 64, v20
    v_mfma_f32_16x16x32_bf16 v[146:149], v[66:69], v[82:85], v[146:149]
    s_setprio 0
    s_sub_u32 s34, s34, 1
    s_cmp_lg_u32 s34, 0
    s_cbranch_scc1 L_gl41
    s_mov_b32 s31, s32
    s_mov_b32 s32, s33
    s_add_u32 s33, s33, 49152
    s_cmp_eq_u32 s33, 147456
    s_cselect_b32 s33, 0, s33
    s_waitcnt lgkmcnt(0)
    v_mfma_f32_16x16x32_bf16 v[86:89], v[22:25], v[38:41], v[86:89]
    ds_read_b128 v[54:57], v16 offset:0
    v_mfma_f32_16x16x32_bf16 v[90:93], v[22:25], v[42:45], v[90:93]
    s_add_u32 s35, s31, s38
    s_mov_b32 m0, s35
    s_nop 0
    buffer_load_dwordx4 v10, s[4:7], s36 offen lds
    v_mfma_f32_16x16x32_bf16 v[94:97], v[22:25], v[46:49], v[94:97]
    ds_read_b128 v[70:73], v21 offset:0
    v_mfma_f32_16x16x32_bf16 v[98:101], v[22:25], v[50:53], v[98:101]
    buffer_load_dwordx4 v11, s[4:7], s36 offen offset:1024 lds
    v_mfma_f32_16x16x32_bf16 v[102:105], v[26:29], v[38:41], v[102:105]
    ds_read_b128 v[58:61], v16 offset:2048
    v_mfma_f32_16x16x32_bf16 v[106:109], v[26:29], v[42:45], v[106:109]
    ds_read_b128 v[74:77], v21 offset:8192
    v_mfma_f32_16x16x32_bf16 v[110:113], v[26:29], v[46:49], v[110:113]
    buffer_load_dwordx4 v12, s[4:7], s36 offen offset:2048 lds
    v_mfma_f32_16x16x32_bf16 v[114:117], v[26:29], v[50:53], v[114:117]
    v_mfma_f32_16x16x32_bf16 v[118:121], v[30:33], v[38:41], v[118:121]
    ds_read_b128 v[62:65], v16 offset:4096
    v_mfma_f32_16x16x32_bf16 v[122:125], v[30:33], v[42:45], v[122:125]
    ds_read_b128 v[78:81], v21 offset:2048
    v_mfma_f32_16x16x32_bf16 v[126:129], v[30:33], v[46:49], v[126:129]
    buffer_load_dwordx4 v13, s[4:7], s36 offen offset:3072 lds
    v_mfma_f32_16x16x32_bf16 v[130:133], v[30:33], v[50:53], v[130:133]
    ds_read_b128 v[66:69], v16 offset:6144
    v_mfma_f32_16x16x32_bf16 v[134:137], v[34:37], v[38:41], v[134:137]
    ds_read_b128 v[82:85], v21 offset:10240
    v_mfma_f32_16x16x32_bf16 v[138:141], v[34:37], v[42:45], v[138:141]
    s_add_u32 s36, s36, 128
    s_and_b32 s36, s36, 2047
    v_mfma_f32_16x16x32_bf16 v[142:145], v[34:37], v[46:49], v[142:145]
    v_add_u32 v15, s33, v14
    v_add_u32 v20, s33, v19
    v_mfma_f32_16x16x32_bf16 v[146:149], v[34:37], v[50:53], v[146:149]
    s_waitcnt vmcnt(6) lgkmcnt(0)
    s_barrier
    s_setprio 1
    v_mfma_f32_16x16x32_bf16 v[86:89], v[54:57], v[70:73], v[86:89]
    ds_read_b128 v[22:25], v15 offset:0
    s_add_u32 s35, s32, s39
    s_mov_b32 m0, s35
    s_nop 0
    buffer_load_dwordx4 v17, s[8:11], s37 offen lds
    v_mfma_f32_16x16x32_bf16 v[90:93], v[54:57], v[74:77], v[90:93]
    ds_read_b128 v[38:41], v20 offset:0
    ds_read_b128 v[26:29], v15 offset:2048
    v_mfma_f32_16x16x32_bf16 v[94:97], v[54:57], v[78:81], v[94:97]
    s_add_u32 s35, s32, s39
    s_add_u32 s35, s35, 8192
    s_mov_b32 m0, s35
    s_nop 0
    buffer_load_dwordx4 v18, s[12:15], s37 offen lds
    ds_read_b128 v[42:45], v20 offset:8192
    v_mfma_f32_16x16x32_bf16 v[98:101], v[54:57], v[82:85], v[98:101]
    ds_read_b128 v[30:33], v15 offset:4096
    v_mfma_f32_16x16x32_bf16 v[102:105], v[58:61], v[70:73], v[102:105]
    ds_read_b128 v[46:49], v20 offset:2048
    s_add_u32 s37, s37, 128
    s_and_b32 s37, s37, 2047
    v_mfma_f32_16x16x32_bf16 v[106:109], v[58:61], v[74:77], v[106:109]
    ds_read_b128 v[34:37], v15 offset:6144
    ds_read_b128 v[50:53], v20 offset:10240
    v_mfma_f32_16x16x32_bf16 v[110:113], v[58:61], v[78:81], v[110:113]
    v_xor_b32 v16, 64, v15
    v_xor_b32 v21, 64, v20
    v_mfma_f32_16x16x32_bf16 v[114:117], v[58:61], v[82:85], v[114:117]
    s_lshl_b32 s78, s30, 6
    s_lshl_b32 s79, s81, 5
    v_mfma_f32_16x16x32_bf16 v[118:121], v[62:65], v[70:73], v[118:121]
    s_add_u32 s79, s79, s78
    v_and_b32 v2, 15, v0
    v_mfma_f32_16x16x32_bf16 v[122:125], v[62:65], v[74:77], v[122:125]
    v_lshlrev_b32 v2, 1, v2
    v_mfma_f32_16x16x32_bf16 v[126:129], v[62:65], v[78:81], v[126:129]
    v_add_u32 v2, s79, v2
    v_lshlrev_b32 v164, 1, v2
    v_mfma_f32_16x16x32_bf16 v[130:133], v[62:65], v[82:85], v[130:133]
    v_add_u32 v172, 2, v164
    v_add_u32 v180, s78, v0
    v_mfma_f32_16x16x32_bf16 v[134:137], v[66:69], v[70:73], v[134:137]
    v_lshlrev_b32 v180, 1, v180
    v_mfma_f32_16x16x32_bf16 v[138:141], v[66:69], v[74:77], v[138:141]
    s_mov_b32 s62, 2048
    s_mov_b32 s63, 0x20000
    v_mfma_f32_16x16x32_bf16 v[142:145], v[66:69], v[78:81], v[142:145]
    s_mov_b32 s60, s42
    s_mov_b32 s61, s43
    buffer_load_ushort v165, v164, s[60:63], 0 offen
    buffer_load_ushort v173, v172, s[60:63], 0 offen
    buffer_load_ushort v181, v180, s[60:63], 0 offen
    s_mov_b32 s60, s44
    s_mov_b32 s61, s45
    buffer_load_ushort v166, v164, s[60:63], 0 offen
    buffer_load_ushort v174, v172, s[60:63], 0 offen
    buffer_load_ushort v182, v180, s[60:63], 0 offen
    v_mfma_f32_16x16x32_bf16 v[146:149], v[66:69], v[82:85], v[146:149]
    s_mov_b32 s60, s54
    s_mov_b32 s61, s55
    buffer_load_ushort v167, v164, s[60:63], 0 offen
    buffer_load_ushort v175, v172, s[60:63], 0 offen
    buffer_load_ushort v183, v180, s[60:63], 0 offen
    s_setprio 0
    s_mov_b32 s31, s32
    s_mov_b32 s32, s33
    s_add_u32 s33, s33, 49152
    s_cmp_eq_u32 s33, 147456
    s_cselect_b32 s33, 0, s33
    s_waitcnt lgkmcnt(0)
    v_mfma_f32_16x16x32_bf16 v[86:89], v[22:25], v[38:41], v[86:89]
    ds_read_b128 v[54:57], v16 offset:0
    v_mfma_f32_16x16x32_bf16 v[90:93], v[22:25], v[42:45], v[90:93]
    s_add_u32 s35, s31, s38
    s_mov_b32 m0, s35
    s_nop 0
    buffer_load_dwordx4 v10, s[4:7], s36 offen lds
    v_mfma_f32_16x16x32_bf16 v[94:97], v[22:25], v[46:49], v[94:97]
    ds_read_b128 v[70:73], v21 offset:0
    v_mfma_f32_16x16x32_bf16 v[98:101], v[22:25], v[50:53], v[98:101]
    buffer_load_dwordx4 v11, s[4:7], s36 offen offset:1024 lds
    v_mfma_f32_16x16x32_bf16 v[102:105], v[26:29], v[38:41], v[102:105]
    ds_read_b128 v[58:61], v16 offset:2048
    v_mfma_f32_16x16x32_bf16 v[106:109], v[26:29], v[42:45], v[106:109]
    ds_read_b128 v[74:77], v21 offset:8192
    v_mfma_f32_16x16x32_bf16 v[110:113], v[26:29], v[46:49], v[110:113]
    buffer_load_dwordx4 v12, s[4:7], s36 offen offset:2048 lds
    v_mfma_f32_16x16x32_bf16 v[114:117], v[26:29], v[50:53], v[114:117]
    v_mfma_f32_16x16x32_bf16 v[118:121], v[30:33], v[38:41], v[118:121]
    ds_read_b128 v[62:65], v16 offset:4096
    v_mfma_f32_16x16x32_bf16 v[122:125], v[30:33], v[42:45], v[122:125]
    ds_read_b128 v[78:81], v21 offset:2048
    v_mfma_f32_16x16x32_bf16 v[126:129], v[30:33], v[46:49], v[126:129]
    buffer_load_dwordx4 v13, s[4:7], s36 offen offset:3072 lds
    v_mfma_f32_16x16x32_bf16 v[130:133], v[30:33], v[50:53], v[130:133]
    ds_read_b128 v[66:69], v16 offset:6144
    v_mfma_f32_16x16x32_bf16 v[134:137], v[34:37], v[38:41], v[134:137]
    ds_read_b128 v[82:85], v21 offset:10240
    v_mfma_f32_16x16x32_bf16 v[138:141], v[34:37], v[42:45], v[138:141]
    s_add_u32 s36, s36, 128
    s_and_b32 s36, s36, 2047
    v_mfma_f32_16x16x32_bf16 v[142:145], v[34:37], v[46:49], v[142:145]
    v_add_u32 v15, s33, v14
    v_add_u32 v20, s33, v19
    v_mfma_f32_16x16x32_bf16 v[146:149], v[34:37], v[50:53], v[146:149]
    s_waitcnt vmcnt(15) lgkmcnt(0)
    s_barrier
    s_setprio 1
    v_mfma_f32_16x16x32_bf16 v[86:89], v[54:57], v[70:73], v[86:89]
    ds_read_b128 v[22:25], v15 offset:0
    v_mfma_f32_16x16x32_bf16 v[90:93], v[54:57], v[74:77], v[90:93]
    s_add_u32 s35, s32, s39
    s_mov_b32 m0, s35
    s_nop 0
    buffer_load_dwordx4 v17, s[8:11], s37 offen lds
    v_mfma_f32_16x16x32_bf16 v[94:97], v[54:57], v[78:81], v[94:97]
    ds_read_b128 v[38:41], v20 offset:0
    v_mfma_f32_16x16x32_bf16 v[98:101], v[54:57], v[82:85], v[98:101]
    ds_read_b128 v[26:29], v15 offset:2048
    v_mfma_f32_16x16x32_bf16 v[102:105], v[58:61], v[70:73], v[102:105]
    s_add_u32 s35, s32, s39
    s_add_u32 s35, s35, 8192
    s_mov_b32 m0, s35
    s_nop 0
    buffer_load_dwordx4 v18, s[12:15], s37 offen lds
    v_mfma_f32_16x16x32_bf16 v[106:109], v[58:61], v[74:77], v[106:109]
    v_mfma_f32_16x16x32_bf16 v[110:113], v[58:61], v[78:81], v[110:113]
    ds_read_b128 v[42:45], v20 offset:8192
    v_mfma_f32_16x16x32_bf16 v[114:117], v[58:61], v[82:85], v[114:117]
    ds_read_b128 v[30:33], v15 offset:4096
    v_mfma_f32_16x16x32_bf16 v[118:121], v[62:65], v[70:73], v[118:121]
    ds_read_b128 v[46:49], v20 offset:2048
    v_mfma_f32_16x16x32_bf16 v[122:125], v[62:65], v[74:77], v[122:125]
    s_add_u32 s37, s37, 128
    s_and_b32 s37, s37, 2047
    v_mfma_f32_16x16x32_bf16 v[126:129], v[62:65], v[78:81], v[126:129]
    v_mfma_f32_16x16x32_bf16 v[130:133], v[62:65], v[82:85], v[130:133]
    ds_read_b128 v[34:37], v15 offset:6144
    v_mfma_f32_16x16x32_bf16 v[134:137], v[66:69], v[70:73], v[134:137]
    ds_read_b128 v[50:53], v20 offset:10240
    v_mfma_f32_16x16x32_bf16 v[138:141], v[66:69], v[74:77], v[138:141]
    v_xor_b32 v16, 64, v15
    v_xor_b32 v21, 64, v20
    v_mfma_f32_16x16x32_bf16 v[142:145], v[66:69], v[78:81], v[142:145]
    s_cmp_lg_u32 s28, 0
    s_cbranch_scc1 L_mz40
    v_mov_b32 v4, -1
    v_mov_b32 v5, -1
    s_lshl_b32 s88, s30, 6
    v_add_u32 v8, s88, v0
    v_lshlrev_b32 v8, 3, v8
    s_lshl_b32 s88, s29, 13
    s_add_u32 s88, s88, 25231360
    buffer_store_dwordx2 v[4:5], v8, s[16:19], s88 offen sc1
    v_mov_b32 v6, 0
    v_lshlrev_b32 v8, 2, v0
    s_lshl_b32 s88, s2, 8
    s_add_u32 s88, s88, 25362432
    buffer_store_dword v6, v8, s[16:19], s88 offen sc1
L_mz40:
    v_mfma_f32_16x16x32_bf16 v[146:149], v[66:69], v[82:85], v[146:149]
    s_setprio 0
    s_mov_b32 s34, 2
L_gl42:
    s_mov_b32 s31, s32
    s_mov_b32 s32, s33
    s_add_u32 s33, s33, 49152
    s_cmp_eq_u32 s33, 147456
    s_cselect_b32 s33, 0, s33
    s_waitcnt lgkmcnt(0)
    v_mfma_f32_16x16x32_bf16 v[86:89], v[22:25], v[38:41], v[86:89]
    ds_read_b128 v[54:57], v16 offset:0
    v_mfma_f32_16x16x32_bf16 v[90:93], v[22:25], v[42:45], v[90:93]
    s_add_u32 s35, s31, s38
    s_mov_b32 m0, s35
    s_nop 0
    buffer_load_dwordx4 v10, s[4:7], s36 offen lds
    v_mfma_f32_16x16x32_bf16 v[94:97], v[22:25], v[46:49], v[94:97]
    ds_read_b128 v[70:73], v21 offset:0
    v_mfma_f32_16x16x32_bf16 v[98:101], v[22:25], v[50:53], v[98:101]
    buffer_load_dwordx4 v11, s[4:7], s36 offen offset:1024 lds
    v_mfma_f32_16x16x32_bf16 v[102:105], v[26:29], v[38:41], v[102:105]
    ds_read_b128 v[58:61], v16 offset:2048
    v_mfma_f32_16x16x32_bf16 v[106:109], v[26:29], v[42:45], v[106:109]
    ds_read_b128 v[74:77], v21 offset:8192
    v_mfma_f32_16x16x32_bf16 v[110:113], v[26:29], v[46:49], v[110:113]
    buffer_load_dwordx4 v12, s[4:7], s36 offen offset:2048 lds
    v_mfma_f32_16x16x32_bf16 v[114:117], v[26:29], v[50:53], v[114:117]
    v_mfma_f32_16x16x32_bf16 v[118:121], v[30:33], v[38:41], v[118:121]
    ds_read_b128 v[62:65], v16 offset:4096
    v_mfma_f32_16x16x32_bf16 v[122:125], v[30:33], v[42:45], v[122:125]
    ds_read_b128 v[78:81], v21 offset:2048
    v_mfma_f32_16x16x32_bf16 v[126:129], v[30:33], v[46:49], v[126:129]
    buffer_load_dwordx4 v13, s[4:7], s36 offen offset:3072 lds
    v_mfma_f32_16x16x32_bf16 v[130:133], v[30:33], v[50:53], v[130:133]
    ds_read_b128 v[66:69], v16 offset:6144
    v_mfma_f32_16x16x32_bf16 v[134:137], v[34:37], v[38:41], v[134:137]
    ds_read_b128 v[82:85], v21 offset:10240
    v_mfma_f32_16x16x32_bf16 v[138:141], v[34:37], v[42:45], v[138:141]
    s_add_u32 s36, s36, 128
    s_and_b32 s36, s36, 2047
    v_mfma_f32_16x16x32_bf16 v[142:145], v[34:37], v[46:49], v[142:145]
    v_add_u32 v15, s33, v14
    v_add_u32 v20, s33, v19
    v_mfma_f32_16x16x32_bf16 v[146:149], v[34:37], v[50:53], v[146:149]
    s_waitcnt vmcnt(6) lgkmcnt(0)
    s_barrier
    s_setprio 1
    v_mfma_f32_16x16x32_bf16 v[86:89], v[54:57], v[70:73], v[86:89]
    ds_read_b128 v[22:25], v15 offset:0
    v_mfma_f32_16x16x32_bf16 v[90:93], v[54:57], v[74:77], v[90:93]
    s_add_u32 s35, s32, s39
    s_mov_b32 m0, s35
    s_nop 0
    buffer_load_dwordx4 v17, s[8:11], s37 offen lds
    v_mfma_f32_16x16x32_bf16 v[94:97], v[54:57], v[78:81], v[94:97]
    ds_read_b128 v[38:41], v20 offset:0
    v_mfma_f32_16x16x32_bf16 v[98:101], v[54:57], v[82:85], v[98:101]
    v_mfma_f32_16x16x32_bf16 v[102:105], v[58:61], v[70:73], v[102:105]
    ds_read_b128 v[26:29], v15 offset:2048
    v_mfma_f32_16x16x32_bf16 v[106:109], v[58:61], v[74:77], v[106:109]
    s_add_u32 s35, s32, s39
    s_add_u32 s35, s35, 8192
    s_mov_b32 m0, s35
    s_nop 0
    buffer_load_dwordx4 v18, s[12:15], s37 offen lds
    v_mfma_f32_16x16x32_bf16 v[110:113], v[58:61], v[78:81], v[110:113]
    ds_read_b128 v[42:45], v20 offset:8192
    v_mfma_f32_16x16x32_bf16 v[114:117], v[58:61], v[82:85], v[114:117]
    v_mfma_f32_16x16x32_bf16 v[118:121], v[62:65], v[70:73], v[118:121]
    ds_read_b128 v[30:33], v15 offset:4096
    v_mfma_f32_16x16x32_bf16 v[122:125], v[62:65], v[74:77], v[122:125]
    ds_read_b128 v[46:49], v20 offset:2048
    v_mfma_f32_16x16x32_bf16 v[126:129], v[62:65], v[78:81], v[126:129]
    s_add_u32 s37, s37, 128
    s_and_b32 s37, s37, 2047
    v_mfma_f32_16x16x32_bf16 v[130:133], v[62:65], v[82:85], v[130:133]
    v_mfma_f32_16x16x32_bf16 v[134:137], v[66:69], v[70:73], v[134:137]
    ds_read_b128 v[34:37], v15 offset:6144
    v_mfma_f32_16x16x32_bf16 v[138:141], v[66:69], v[74:77], v[138:141]
    ds_read_b128 v[50:53], v20 offset:10240
    v_mfma_f32_16x16x32_bf16 v[142:145], v[66:69], v[78:81], v[142:145]
    v_xor_b32 v16, 64, v15
    v_xor_b32 v21, 64, v20
    v_mfma_f32_16x16x32_bf16 v[146:149], v[66:69], v[82:85], v[146:149]
    s_setprio 0
    s_sub_u32 s34, s34, 1
    s_cmp_lg_u32 s34, 0
    s_cbranch_scc1 L_gl42
    s_mov_b32 s31, s32
    s_mov_b32 s32, s33
    s_add_u32 s33, s33, 49152
    s_cmp_eq_u32 s33, 147456
    s_cselect_b32 s33, 0, s33
    s_waitcnt lgkmcnt(0)
    v_mfma_f32_16x16x32_bf16 v[86:89], v[22:25], v[38:41], v[86:89]
    ds_read_b128 v[54:57], v16 offset:0
    v_mfma_f32_16x16x32_bf16 v[90:93], v[22:25], v[42:45], v[90:93]
    s_add_u32 s35, s31, s38
    s_mov_b32 m0, s35
    s_nop 0
    buffer_load_dwordx4 v10, s[4:7], s36 offen lds
    v_mfma_f32_16x16x32_bf16 v[94:97], v[22:25], v[46:49], v[94:97]
    ds_read_b128 v[70:73], v21 offset:0
    v_mfma_f32_16x16x32_bf16 v[98:101], v[22:25], v[50:53], v[98:101]
    buffer_load_dwordx4 v11, s[4:7], s36 offen offset:1024 lds
    v_mfma_f32_16x16x32_bf16 v[102:105], v[26:29], v[38:41], v[102:105]
    ds_read_b128 v[58:61], v16 offset:2048
    v_mfma_f32_16x16x32_bf16 v[106:109], v[26:29], v[42:45], v[106:109]
    ds_read_b128 v[74:77], v21 offset:8192
    v_mfma_f32_16x16x32_bf16 v[110:113], v[26:29], v[46:49], v[110:113]
    buffer_load_dwordx4 v12, s[4:7], s36 offen offset:2048 lds
    v_mfma_f32_16x16x32_bf16 v[114:117], v[26:29], v[50:53], v[114:117]
    v_mfma_f32_16x16x32_bf16 v[118:121], v[30:33], v[38:41], v[118:121]
    ds_read_b128 v[62:65], v16 offset:4096
    v_mfma_f32_16x16x32_bf16 v[122:125], v[30:33], v[42:45], v[122:125]
    ds_read_b128 v[78:81], v21 offset:2048
    v_mfma_f32_16x16x32_bf16 v[126:129], v[30:33], v[46:49], v[126:129]
    buffer_load_dwordx4 v13, s[4:7], s36 offen offset:3072 lds
    v_mfma_f32_16x16x32_bf16 v[130:133], v[30:33], v[50:53], v[130:133]
    ds_read_b128 v[66:69], v16 offset:6144
    v_mfma_f32_16x16x32_bf16 v[134:137], v[34:37], v[38:41], v[134:137]
    ds_read_b128 v[82:85], v21 offset:10240
    v_mfma_f32_16x16x32_bf16 v[138:141], v[34:37], v[42:45], v[138:141]
    s_add_u32 s36, s36, 128
    s_and_b32 s36, s36, 2047
    v_mfma_f32_16x16x32_bf16 v[142:145], v[34:37], v[46:49], v[142:145]
    v_add_u32 v15, s33, v14
    v_add_u32 v20, s33, v19
    v_mfma_f32_16x16x32_bf16 v[146:149], v[34:37], v[50:53], v[146:149]
    s_cmp_lg_u32 s28, 0
    s_cbranch_scc1 L_mi43
    v_mov_b32 v6, 1
    v_mov_b32 v7, 0
    s_mov_b64 exec, 1
    buffer_atomic_add v6, v7, s[20:23], 0 offen sc1
    s_mov_b64 exec, -1
L_mi43:
    s_waitcnt vmcnt(6) lgkmcnt(0)
    s_barrier
    s_setprio 1
    v_mfma_f32_16x16x32_bf16 v[86:89], v[54:57], v[70:73], v[86:89]
    ds_read_b128 v[22:25], v15 offset:0
    s_add_u32 s35, s32, s39
    s_mov_b32 m0, s35
    s_nop 0
    buffer_load_dwordx4 v17, s[8:11], s37 offen lds
    ds_read_b128 v[38:41], v20 offset:0
    v_mfma_f32_16x16x32_bf16 v[90:93], v[54:57], v[74:77], v[90:93]
    ds_read_b128 v[26:29], v15 offset:2048
    s_add_u32 s35, s32, s39
    s_add_u32 s35, s35, 8192
    s_mov_b32 m0, s35
    s_nop 0
    buffer_load_dwordx4 v18, s[12:15], s37 offen lds
    v_mfma_f32_16x16x32_bf16 v[94:97], v[54:57], v[78:81], v[94:97]
    ds_read_b128 v[42:45], v20 offset:8192
    ds_read_b128 v[30:33], v15 offset:4096
    v_mfma_f32_16x16x32_bf16 v[98:101], v[54:57], v[82:85], v[98:101]
    ds_read_b128 v[46:49], v20 offset:2048
    s_add_u32 s37, s37, 128
    s_and_b32 s37, s37, 2047
    v_mfma_f32_16x16x32_bf16 v[102:105], v[58:61], v[70:73], v[102:105]
    ds_read_b128 v[34:37], v15 offset:6144
    ds_read_b128 v[50:53], v20 offset:10240
    v_mfma_f32_16x16x32_bf16 v[106:109], v[58:61], v[74:77], v[106:109]
    v_xor_b32 v16, 64, v15
    v_xor_b32 v21, 64, v20
    v_lshlrev_b32 v165, 16, v165
    v_lshlrev_b32 v166, 16, v166
    v_lshlrev_b32 v167, 16, v167
    v_mul_f32 v168, 0x3fb8aa3b, v167
    v_mfma_f32_16x16x32_bf16 v[110:113], v[58:61], v[78:81], v[110:113]
    v_exp_f32 v168, v168
    s_nop 0
    v_cvt_pk_bf16_f32 v168, v168, v168
    v_lshlrev_b32 v168, 16, v168
    v_mul_f32 v169, v168, v165
    v_mul_f32 v170, v168, v166
    v_mul_f32 v169, 0x3fb8aa3b, v169
    v_exp_f32 v169, v169
    v_mfma_f32_16x16x32_bf16 v[114:117], v[58:61], v[82:85], v[114:117]
    v_mul_f32 v170, 0x3e22f983, v170
    v_rndne_f32 v171, v170
    v_sub_f32 v170, v170, v171
    v_cos_f32 v171, v170
    v_sin_f32 v170, v170
    s_nop 0
    v_mul_f32 v152, v169, v171
    v_mul_f32 v153, v169, v170
    v_mfma_f32_16x16x32_bf16 v[118:121], v[62:65], v[70:73], v[118:121]
    v_subrev_f32 v168, 1.0, v152
    v_mul_f32 v169, v168, v165
    v_fmac_f32 v169, v153, v166
    v_mul_f32 v170, v153, v165
    v_fma_f32 v170, -v168, v166, v170
    v_mul_f32 v171, v165, v165
    v_fmac_f32 v171, v166, v166
    v_rcp_f32 v171, v171
    v_mfma_f32_16x16x32_bf16 v[122:125], v[62:65], v[74:77], v[122:125]
    s_nop 0
    v_add_f32 v171, v171, v171
    v_mul_f32 v154, v169, v171
    v_mul_f32 v155, v170, v171
    v_lshlrev_b32 v173, 16, v173
    v_lshlrev_b32 v174, 16, v174
    v_lshlrev_b32 v175, 16, v175
    v_mul_f32 v176, 0x3fb8aa3b, v175
    v_mfma_f32_16x16x32_bf16 v[126:129], v[62:65], v[78:81], v[126:129]
    v_exp_f32 v176, v176
    s_nop 0
    v_cvt_pk_bf16_f32 v176, v176, v176
    v_lshlrev_b32 v176, 16, v176
    v_mul_f32 v177, v176, v173
    v_mul_f32 v178, v176, v174
    v_mul_f32 v177, 0x3fb8aa3b, v177
    v_exp_f32 v177, v177
    v_mfma_f32_16x16x32_bf16 v[130:133], v[62:65], v[82:85], v[130:133]
    v_mul_f32 v178, 0x3e22f983, v178
    v_rndne_f32 v179, v178
    v_sub_f32 v178, v178, v179
    v_cos_f32 v179, v178
    v_sin_f32 v178, v178
    s_nop 0
    v_mul_f32 v156, v177, v179
    v_mul_f32 v157, v177, v178
    v_mfma_f32_16x16x32_bf16 v[134:137], v[66:69], v[70:73], v[134:137]
    v_subrev_f32 v176, 1.0, v156
    v_mul_f32 v177, v176, v173
    v_fmac_f32 v177, v157, v174
    v_mul_f32 v178, v157, v173
    v_fma_f32 v178, -v176, v174, v178
    v_mul_f32 v179, v173, v173
    v_fmac_f32 v179, v174, v174
    v_rcp_f32 v179, v179
    v_mfma_f32_16x16x32_bf16 v[138:141], v[66:69], v[74:77], v[138:141]
    s_nop 0
    v_add_f32 v179, v179, v179
    v_mul_f32 v158, v177, v179
    v_mul_f32 v159, v178, v179
    v_lshlrev_b32 v181, 16, v181
    v_lshlrev_b32 v182, 16, v182
    v_lshlrev_b32 v183, 16, v183
    v_mul_f32 v184, 0x3fb8aa3b, v183
    v_mfma_f32_16x16x32_bf16 v[142:145], v[66:69], v[78:81], v[142:145]
    v_exp_f32 v184, v184
    s_nop 0
    v_cvt_pk_bf16_f32 v184, v184, v184
    v_lshlrev_b32 v184, 16, v184
    v_mul_f32 v185, v184, v181
    v_mul_f32 v186, v184, v182
    v_mul_f32 v185, 0x3fb8aa3b, v185
    v_exp_f32 v185, v185
    v_mfma_f32_16x16x32_bf16 v[146:149], v[66:69], v[82:85], v[146:149]
    v_mul_f32 v186, 0x3e22f983, v186
    v_rndne_f32 v187, v186
    v_sub_f32 v186, v186, v187
    v_cos_f32 v187, v186
    v_sin_f32 v186, v186
    s_nop 0
    v_mul_f32 v160, v185, v187
    v_mul_f32 v161, v185, v186
    s_setprio 0
    s_mov_b32 s34, 5
L_gl44:
    s_mov_b32 s31, s32
    s_mov_b32 s32, s33
    s_add_u32 s33, s33, 49152
    s_cmp_eq_u32 s33, 147456
    s_cselect_b32 s33, 0, s33
    s_waitcnt lgkmcnt(0)
    v_mfma_f32_16x16x32_bf16 v[86:89], v[22:25], v[38:41], v[86:89]
    ds_read_b128 v[54:57], v16 offset:0
    v_mfma_f32_16x16x32_bf16 v[90:93], v[22:25], v[42:45], v[90:93]
    s_add_u32 s35, s31, s38
    s_mov_b32 m0, s35
    s_nop 0
    buffer_load_dwordx4 v10, s[4:7], s36 offen lds
    v_mfma_f32_16x16x32_bf16 v[94:97], v[22:25], v[46:49], v[94:97]
    ds_read_b128 v[70:73], v21 offset:0
    v_mfma_f32_16x16x32_bf16 v[98:101], v[22:25], v[50:53], v[98:101]
    buffer_load_dwordx4 v11, s[4:7], s36 offen offset:1024 lds
    v_mfma_f32_16x16x32_bf16 v[102:105], v[26:29], v[38:41], v[102:105]
    ds_read_b128 v[58:61], v16 offset:2048
    v_mfma_f32_16x16x32_bf16 v[106:109], v[26:29], v[42:45], v[106:109]
    ds_read_b128 v[74:77], v21 offset:8192
    v_mfma_f32_16x16x32_bf16 v[110:113], v[26:29], v[46:49], v[110:113]
    buffer_load_dwordx4 v12, s[4:7], s36 offen offset:2048 lds
    v_mfma_f32_16x16x32_bf16 v[114:117], v[26:29], v[50:53], v[114:117]
    v_mfma_f32_16x16x32_bf16 v[118:121], v[30:33], v[38:41], v[118:121]
    ds_read_b128 v[62:65], v16 offset:4096
    v_mfma_f32_16x16x32_bf16 v[122:125], v[30:33], v[42:45], v[122:125]
    ds_read_b128 v[78:81], v21 offset:2048
    v_mfma_f32_16x16x32_bf16 v[126:129], v[30:33], v[46:49], v[126:129]
    buffer_load_dwordx4 v13, s[4:7], s36 offen offset:3072 lds
    v_mfma_f32_16x16x32_bf16 v[130:133], v[30:33], v[50:53], v[130:133]
    ds_read_b128 v[66:69], v16 offset:6144
    v_mfma_f32_16x16x32_bf16 v[134:137], v[34:37], v[38:41], v[134:137]
    ds_read_b128 v[82:85], v21 offset:10240
    v_mfma_f32_16x16x32_bf16 v[138:141], v[34:37], v[42:45], v[138:141]
    s_add_u32 s36, s36, 128
    s_and_b32 s36, s36, 2047
    v_mfma_f32_16x16x32_bf16 v[142:145], v[34:37], v[46:49], v[142:145]
    v_add_u32 v15, s33, v14
    v_add_u32 v20, s33, v19
    v_mfma_f32_16x16x32_bf16 v[146:149], v[34:37], v[50:53], v[146:149]
    s_waitcnt vmcnt(6) lgkmcnt(0)
    s_barrier
    s_setprio 1
    v_mfma_f32_16x16x32_bf16 v[86:89], v[54:57], v[70:73], v[86:89]
    ds_read_b128 v[22:25], v15 offset:0
    v_mfma_f32_16x16x32_bf16 v[90:93], v[54:57], v[74:77], v[90:93]
    s_add_u32 s35, s32, s39
    s_mov_b32 m0, s35
    s_nop 0
    buffer_load_dwordx4 v17, s[8:11], s37 offen lds
    v_mfma_f32_16x16x32_bf16 v[94:97], v[54:57], v[78:81], v[94:97]
    ds_read_b128 v[38:41], v20 offset:0
    v_mfma_f32_16x16x32_bf16 v[98:101], v[54:57], v[82:85], v[98:101]
    v_mfma_f32_16x16x32_bf16 v[102:105], v[58:61], v[70:73], v[102:105]
    ds_read_b128 v[26:29], v15 offset:2048
    v_mfma_f32_16x16x32_bf16 v[106:109], v[58:61], v[74:77], v[106:109]
    s_add_u32 s35, s32, s39
    s_add_u32 s35, s35, 8192
    s_mov_b32 m0, s35
    s_nop 0
    buffer_load_dwordx4 v18, s[12:15], s37 offen lds
    v_mfma_f32_16x16x32_bf16 v[110:113], v[58:61], v[78:81], v[110:113]
    ds_read_b128 v[42:45], v20 offset:8192
    v_mfma_f32_16x16x32_bf16 v[114:117], v[58:61], v[82:85], v[114:117]
    v_mfma_f32_16x16x32_bf16 v[118:121], v[62:65], v[70:73], v[118:121]
    ds_read_b128 v[30:33], v15 offset:4096
    v_mfma_f32_16x16x32_bf16 v[122:125], v[62:65], v[74:77], v[122:125]
    ds_read_b128 v[46:49], v20 offset:2048
    v_mfma_f32_16x16x32_bf16 v[126:129], v[62:65], v[78:81], v[126:129]
    s_add_u32 s37, s37, 128
    s_and_b32 s37, s37, 2047
    v_mfma_f32_16x16x32_bf16 v[130:133], v[62:65], v[82:85], v[130:133]
    v_mfma_f32_16x16x32_bf16 v[134:137], v[66:69], v[70:73], v[134:137]
    ds_read_b128 v[34:37], v15 offset:6144
    v_mfma_f32_16x16x32_bf16 v[138:141], v[66:69], v[74:77], v[138:141]
    ds_read_b128 v[50:53], v20 offset:10240
    v_mfma_f32_16x16x32_bf16 v[142:145], v[66:69], v[78:81], v[142:145]
    v_xor_b32 v16, 64, v15
    v_xor_b32 v21, 64, v20
    v_mfma_f32_16x16x32_bf16 v[146:149], v[66:69], v[82:85], v[146:149]
    s_setprio 0
    s_sub_u32 s34, s34, 1
    s_cmp_lg_u32 s34, 0
    s_cbranch_scc1 L_gl44
    s_mov_b32 s31, s32
    s_mov_b32 s32, s33
    s_add_u32 s33, s33, 49152
    s_cmp_eq_u32 s33, 147456
    s_cselect_b32 s33, 0, s33
    s_waitcnt lgkmcnt(0)
    v_mfma_f32_16x16x32_bf16 v[86:89], v[22:25], v[38:41], v[86:89]
    ds_read_b128 v[54:57], v16 offset:0
    v_mfma_f32_16x16x32_bf16 v[90:93], v[22:25], v[42:45], v[90:93]
    s_add_u32 s35, s31, s38
    s_mov_b32 m0, s35
    s_nop 0
    buffer_load_dwordx4 v10, s[4:7], s36 offen lds
    v_mfma_f32_16x16x32_bf16 v[94:97], v[22:25], v[46:49], v[94:97]
    ds_read_b128 v[70:73], v21 offset:0
    v_mfma_f32_16x16x32_bf16 v[98:101], v[22:25], v[50:53], v[98:101]
    buffer_load_dwordx4 v11, s[4:7], s36 offen offset:1024 lds
    v_mfma_f32_16x16x32_bf16 v[102:105], v[26:29], v[38:41], v[102:105]
    ds_read_b128 v[58:61], v16 offset:2048
    v_mfma_f32_16x16x32_bf16 v[106:109], v[26:29], v[42:45], v[106:109]
    ds_read_b128 v[74:77], v21 offset:8192
    v_mfma_f32_16x16x32_bf16 v[110:113], v[26:29], v[46:49], v[110:113]
    buffer_load_dwordx4 v12, s[4:7], s36 offen offset:2048 lds
    v_mfma_f32_16x16x32_bf16 v[114:117], v[26:29], v[50:53], v[114:117]
    v_mfma_f32_16x16x32_bf16 v[118:121], v[30:33], v[38:41], v[118:121]
    ds_read_b128 v[62:65], v16 offset:4096
    v_mfma_f32_16x16x32_bf16 v[122:125], v[30:33], v[42:45], v[122:125]
    ds_read_b128 v[78:81], v21 offset:2048
    v_mfma_f32_16x16x32_bf16 v[126:129], v[30:33], v[46:49], v[126:129]
    buffer_load_dwordx4 v13, s[4:7], s36 offen offset:3072 lds
    v_mfma_f32_16x16x32_bf16 v[130:133], v[30:33], v[50:53], v[130:133]
    ds_read_b128 v[66:69], v16 offset:6144
    v_mfma_f32_16x16x32_bf16 v[134:137], v[34:37], v[38:41], v[134:137]
    ds_read_b128 v[82:85], v21 offset:10240
    v_mfma_f32_16x16x32_bf16 v[138:141], v[34:37], v[42:45], v[138:141]
    s_add_u32 s36, s36, 128
    s_and_b32 s36, s36, 2047
    v_mfma_f32_16x16x32_bf16 v[142:145], v[34:37], v[46:49], v[142:145]
    v_add_u32 v15, s33, v14
    v_add_u32 v20, s33, v19
    v_mfma_f32_16x16x32_bf16 v[146:149], v[34:37], v[50:53], v[146:149]
    s_waitcnt vmcnt(6) lgkmcnt(0)
    s_barrier
    s_setprio 1
    v_mfma_f32_16x16x32_bf16 v[86:89], v[54:57], v[70:73], v[86:89]
    ds_read_b128 v[22:25], v15 offset:0
    ds_read_b128 v[38:41], v20 offset:0
    v_mfma_f32_16x16x32_bf16 v[90:93], v[54:57], v[74:77], v[90:93]
    ds_read_b128 v[26:29], v15 offset:2048
    v_mfma_f32_16x16x32_bf16 v[94:97], v[54:57], v[78:81], v[94:97]
    ds_read_b128 v[42:45], v20 offset:8192
    v_mfma_f32_16x16x32_bf16 v[98:101], v[54:57], v[82:85], v[98:101]
    ds_read_b128 v[30:33], v15 offset:4096
    v_mfma_f32_16x16x32_bf16 v[102:105], v[58:61], v[70:73], v[102:105]
    ds_read_b128 v[46:49], v20 offset:2048
    ds_read_b128 v[34:37], v15 offset:6144
    v_mfma_f32_16x16x32_bf16 v[106:109], v[58:61], v[74:77], v[106:109]
    ds_read_b128 v[50:53], v20 offset:10240
    v_mfma_f32_16x16x32_bf16 v[110:113], v[58:61], v[78:81], v[110:113]
    v_xor_b32 v16, 64, v15
    v_xor_b32 v21, 64, v20
    v_mfma_f32_16x16x32_bf16 v[114:117], v[58:61], v[82:85], v[114:117]
    buffer_load_dwordx4 v[238:241], v236, s[24:27], s83 offen offset:0
    v_mfma_f32_16x16x32_bf16 v[118:121], v[62:65], v[70:73], v[118:121]
    buffer_load_dwordx4 v[238:241], v236, s[24:27], s83 offen offset:1024
    buffer_load_dwordx4 v[238:241], v236, s[24:27], s83 offen offset:2048
    v_mfma_f32_16x16x32_bf16 v[122:125], v[62:65], v[74:77], v[122:125]
    buffer_load_dwordx4 v[238:241], v236, s[24:27], s83 offen offset:3072
    v_mfma_f32_16x16x32_bf16 v[126:129], v[62:65], v[78:81], v[126:129]
    buffer_load_dwordx4 v[238:241], v236, s[72:75], s84 offen offset:0
    v_mfma_f32_16x16x32_bf16 v[130:133], v[62:65], v[82:85], v[130:133]
    buffer_load_dwordx4 v[238:241], v236, s[72:75], s84 offen offset:1024
    v_mfma_f32_16x16x32_bf16 v[134:137], v[66:69], v[70:73], v[134:137]
    buffer_load_dwordx4 v[238:241], v236, s[72:75], s84 offen offset:2048
    buffer_load_dwordx4 v[238:241], v236, s[72:75], s84 offen offset:3072
    s_add_u32 s84, s84, 4096
    v_mfma_f32_16x16x32_bf16 v[138:141], v[66:69], v[74:77], v[138:141]
    buffer_load_dwordx4 v[238:241], v236, s[72:75], s84 offen offset:0
    v_mfma_f32_16x16x32_bf16 v[142:145], v[66:69], v[78:81], v[142:145]
    buffer_load_dwordx4 v[238:241], v236, s[72:75], s84 offen offset:1024
    v_mfma_f32_16x16x32_bf16 v[146:149], v[66:69], v[82:85], v[146:149]
    buffer_load_dwordx4 v[238:241], v236, s[72:75], s84 offen offset:2048
    s_setprio 0
    s_mov_b32 s31, s32
    s_mov_b32 s32, s33
    s_add_u32 s33, s33, 49152
    s_cmp_eq_u32 s33, 147456
    s_cselect_b32 s33, 0, s33
    s_waitcnt lgkmcnt(0)
    v_mfma_f32_16x16x32_bf16 v[86:89], v[22:25], v[38:41], v[86:89]
    ds_read_b128 v[54:57], v16 offset:0
    v_mfma_f32_16x16x32_bf16 v[90:93], v[22:25], v[42:45], v[90:93]
    ds_read_b128 v[70:73], v21 offset:0
    v_mfma_f32_16x16x32_bf16 v[94:97], v[22:25], v[46:49], v[94:97]
    v_mfma_f32_16x16x32_bf16 v[98:101], v[22:25], v[50:53], v[98:101]
    ds_read_b128 v[58:61], v16 offset:2048
    v_mfma_f32_16x16x32_bf16 v[102:105], v[26:29], v[38:41], v[102:105]
    v_mfma_f32_16x16x32_bf16 v[106:109], v[26:29], v[42:45], v[106:109]
    ds_read_b128 v[74:77], v21 offset:8192
    v_mfma_f32_16x16x32_bf16 v[110:113], v[26:29], v[46:49], v[110:113]
    v_mfma_f32_16x16x32_bf16 v[114:117], v[26:29], v[50:53], v[114:117]
    ds_read_b128 v[62:65], v16 offset:4096
    v_mfma_f32_16x16x32_bf16 v[118:121], v[30:33], v[38:41], v[118:121]
    ds_read_b128 v[78:81], v21 offset:2048
    v_mfma_f32_16x16x32_bf16 v[122:125], v[30:33], v[42:45], v[122:125]
    v_mfma_f32_16x16x32_bf16 v[126:129], v[30:33], v[46:49], v[126:129]
    ds_read_b128 v[66:69], v16 offset:6144
    v_mfma_f32_16x16x32_bf16 v[130:133], v[30:33], v[50:53], v[130:133]
    v_mfma_f32_16x16x32_bf16 v[134:137], v[34:37], v[38:41], v[134:137]
    ds_read_b128 v[82:85], v21 offset:10240
    v_mfma_f32_16x16x32_bf16 v[138:141], v[34:37], v[42:45], v[138:141]
    v_mfma_f32_16x16x32_bf16 v[142:145], v[34:37], v[46:49], v[142:145]
    v_add_u32 v15, s33, v14
    v_add_u32 v20, s33, v19
    v_mfma_f32_16x16x32_bf16 v[146:149], v[34:37], v[50:53], v[146:149]
    s_waitcnt vmcnt(11) lgkmcnt(0)
    s_barrier
    s_setprio 1
    v_mfma_f32_16x16x32_bf16 v[86:89], v[54:57], v[70:73], v[86:89]
    ds_read_b128 v[22:25], v15 offset:0
    v_mfma_f32_16x16x32_bf16 v[90:93], v[54:57], v[74:77], v[90:93]
    ds_read_b128 v[38:41], v20 offset:0
    v_mfma_f32_16x16x32_bf16 v[94:97], v[54:57], v[78:81], v[94:97]
    v_mfma_f32_16x16x32_bf16 v[98:101], v[54:57], v[82:85], v[98:101]
    ds_read_b128 v[26:29], v15 offset:2048
    v_mfma_f32_16x16x32_bf16 v[102:105], v[58:61], v[70:73], v[102:105]
    v_mfma_f32_16x16x32_bf16 v[106:109], v[58:61], v[74:77], v[106:109]
    ds_read_b128 v[42:45], v20 offset:8192
    v_mfma_f32_16x16x32_bf16 v[110:113], v[58:61], v[78:81], v[110:113]
    v_mfma_f32_16x16x32_bf16 v[114:117], v[58:61], v[82:85], v[114:117]
    ds_read_b128 v[30:33], v15 offset:4096
    v_mfma_f32_16x16x32_bf16 v[118:121], v[62:65], v[70:73], v[118:121]
    ds_read_b128 v[46:49], v20 offset:2048
    v_mfma_f32_16x16x32_bf16 v[122:125], v[62:65], v[74:77], v[122:125]
    v_mfma_f32_16x16x32_bf16 v[126:129], v[62:65], v[78:81], v[126:129]
    ds_read_b128 v[34:37], v15 offset:6144
    v_mfma_f32_16x16x32_bf16 v[130:133], v[62:65], v[82:85], v[130:133]
    v_mfma_f32_16x16x32_bf16 v[134:137], v[66:69], v[70:73], v[134:137]
    ds_read_b128 v[50:53], v20 offset:10240
    v_mfma_f32_16x16x32_bf16 v[138:141], v[66:69], v[74:77], v[138:141]
    v_mfma_f32_16x16x32_bf16 v[142:145], v[66:69], v[78:81], v[142:145]
    v_xor_b32 v16, 64, v15
    v_xor_b32 v21, 64, v20
    v_mfma_f32_16x16x32_bf16 v[146:149], v[66:69], v[82:85], v[146:149]
    s_setprio 0
    s_mov_b32 s31, s32
    s_mov_b32 s32, s33
    s_add_u32 s33, s33, 49152
    s_cmp_eq_u32 s33, 147456
    s_cselect_b32 s33, 0, s33
    s_waitcnt lgkmcnt(0)
    v_mfma_f32_16x16x32_bf16 v[86:89], v[22:25], v[38:41], v[86:89]
    ds_read_b128 v[54:57], v16 offset:0
    v_mfma_f32_16x16x32_bf16 v[90:93], v[22:25], v[42:45], v[90:93]
    v_mfma_f32_16x16x32_bf16 v[94:97], v[22:25], v[46:49], v[94:97]
    ds_read_b128 v[70:73], v21 offset:0
    v_mfma_f32_16x16x32_bf16 v[98:101], v[22:25], v[50:53], v[98:101]
    v_mfma_f32_16x16x32_bf16 v[102:105], v[26:29], v[38:41], v[102:105]
    ds_read_b128 v[58:61], v16 offset:2048
    v_mfma_f32_16x16x32_bf16 v[106:109], v[26:29], v[42:45], v[106:109]
    v_mfma_f32_16x16x32_bf16 v[110:113], v[26:29], v[46:49], v[110:113]
    ds_read_b128 v[74:77], v21 offset:8192
    v_mfma_f32_16x16x32_bf16 v[114:117], v[26:29], v[50:53], v[114:117]
    v_mfma_f32_16x16x32_bf16 v[118:121], v[30:33], v[38:41], v[118:121]
    ds_read_b128 v[62:65], v16 offset:4096
    v_mfma_f32_16x16x32_bf16 v[122:125], v[30:33], v[42:45], v[122:125]
    v_mfma_f32_16x16x32_bf16 v[126:129], v[30:33], v[46:49], v[126:129]
    ds_read_b128 v[78:81], v21 offset:2048
    v_mfma_f32_16x16x32_bf16 v[130:133], v[30:33], v[50:53], v[130:133]
    v_mfma_f32_16x16x32_bf16 v[134:137], v[34:37], v[38:41], v[134:137]
    ds_read_b128 v[66:69], v16 offset:6144
    v_mfma_f32_16x16x32_bf16 v[138:141], v[34:37], v[42:45], v[138:141]
    v_mfma_f32_16x16x32_bf16 v[142:145], v[34:37], v[46:49], v[142:145]
    ds_read_b128 v[82:85], v21 offset:10240
    v_mfma_f32_16x16x32_bf16 v[146:149], v[34:37], v[50:53], v[146:149]
    s_waitcnt lgkmcnt(0)
    v_mfma_f32_16x16x32_bf16 v[86:89], v[54:57], v[70:73], v[86:89]
    v_mfma_f32_16x16x32_bf16 v[90:93], v[54:57], v[74:77], v[90:93]
    v_mfma_f32_16x16x32_bf16 v[94:97], v[54:57], v[78:81], v[94:97]
    v_mfma_f32_16x16x32_bf16 v[98:101], v[54:57], v[82:85], v[98:101]
    v_mfma_f32_16x16x32_bf16 v[102:105], v[58:61], v[70:73], v[102:105]
    v_mfma_f32_16x16x32_bf16 v[106:109], v[58:61], v[74:77], v[106:109]
    v_mfma_f32_16x16x32_bf16 v[110:113], v[58:61], v[78:81], v[110:113]
    v_mfma_f32_16x16x32_bf16 v[114:117], v[58:61], v[82:85], v[114:117]
    v_mfma_f32_16x16x32_bf16 v[118:121], v[62:65], v[70:73], v[118:121]
    v_mfma_f32_16x16x32_bf16 v[122:125], v[62:65], v[74:77], v[122:125]
    v_mfma_f32_16x16x32_bf16 v[126:129], v[62:65], v[78:81], v[126:129]
    v_mfma_f32_16x16x32_bf16 v[130:133], v[62:65], v[82:85], v[130:133]
    v_mfma_f32_16x16x32_bf16 v[134:137], v[66:69], v[70:73], v[134:137]
    v_mfma_f32_16x16x32_bf16 v[138:141], v[66:69], v[74:77], v[138:141]
    v_mfma_f32_16x16x32_bf16 v[142:145], v[66:69], v[78:81], v[142:145]
    v_mfma_f32_16x16x32_bf16 v[146:149], v[66:69], v[82:85], v[146:149]
    s_cmp_lg_u32 s28, 0
    s_cbranch_scc1 L_il45
    v_mov_b32 v1, 0
    buffer_load_dword v1, v1, s[20:23], 0 offen sc1
L_il45:
    s_nop 7
    v_mov_b32 v164, v86
    v_mov_b32 v165, v90
    v_mov_b32 v166, v94
    v_mov_b32 v167, v98
    v_fma_f32 v168, v152, v164, v87
    v_fma_f32 v169, v152, v165, v91
    v_fma_f32 v170, v156, v166, v95
    v_fma_f32 v171, v156, v167, v99
    v_fma_f32 v168, -v153, v165, v168
    v_fma_f32 v169, v153, v164, v169
    v_fma_f32 v170, -v157, v167, v170
    v_fma_f32 v171, v157, v166, v171
    v_fma_f32 v164, v152, v168, v88
    v_fma_f32 v165, v152, v169, v92
    v_fma_f32 v166, v156, v170, v96
    v_fma_f32 v167, v156, v171, v100
    v_fma_f32 v164, -v153, v169, v164
    v_fma_f32 v165, v153, v168, v165
    v_fma_f32 v166, -v157, v171, v166
    v_fma_f32 v167, v157, v170, v167
    v_fma_f32 v168, v152, v164, v89
    v_fma_f32 v169, v152, v165, v93
    v_fma_f32 v170, v156, v166, v97
    v_fma_f32 v171, v156, v167, v101
    v_fma_f32 v168, -v153, v165, v168
    v_fma_f32 v169, v153, v164, v169
    v_fma_f32 v170, -v157, v167, v170
    v_fma_f32 v171, v157, v166, v171
    v_fma_f32 v164, v152, v168, v102
    v_fma_f32 v165, v152, v169, v106
    v_fma_f32 v166, v156, v170, v110
    v_fma_f32 v167, v156, v171, v114
    v_fma_f32 v164, -v153, v169, v164
    v_fma_f32 v165, v153, v168, v165
    v_fma_f32 v166, -v157, v171, v166
    v_fma_f32 v167, v157, v170, v167
    v_fma_f32 v168, v152, v164, v103
    v_fma_f32 v169, v152, v165, v107
    v_fma_f32 v170, v156, v166, v111
    v_fma_f32 v171, v156, v167, v115
    v_fma_f32 v168, -v153, v165, v168
    v_fma_f32 v169, v153, v164, v169
    v_fma_f32 v170, -v157, v167, v170
    v_fma_f32 v171, v157, v166, v171
    v_fma_f32 v164, v152, v168, v104
    v_fma_f32 v165, v152, v169, v108
    v_fma_f32 v166, v156, v170, v112
    v_fma_f32 v167, v156, v171, v116
    v_fma_f32 v164, -v153, v169, v164
    v_fma_f32 v165, v153, v168, v165
    v_fma_f32 v166, -v157, v171, v166
    v_fma_f32 v167, v157, v170, v167
    v_fma_f32 v168, v152, v164, v105
    v_fma_f32 v169, v152, v165, v109
    v_fma_f32 v170, v156, v166, v113
    v_fma_f32 v171, v156, v167, v117
    v_fma_f32 v168, -v153, v165, v168
    v_fma_f32 v169, v153, v164, v169
    v_fma_f32 v170, -v157, v167, v170
    v_fma_f32 v171, v157, v166, v171
    v_fma_f32 v164, v152, v168, v118
    v_fma_f32 v165, v152, v169, v122
    v_fma_f32 v166, v156, v170, v126
    v_fma_f32 v167, v156, v171, v130
    v_fma_f32 v164, -v153, v169, v164
    v_fma_f32 v165, v153, v168, v165
    v_fma_f32 v166, -v157, v171, v166
    v_fma_f32 v167, v157, v170, v167
    v_fma_f32 v168, v152, v164, v119
    v_fma_f32 v169, v152, v165, v123
    v_fma_f32 v170, v156, v166, v127
    v_fma_f32 v171, v156, v167, v131
    v_fma_f32 v168, -v153, v165, v168
    v_fma_f32 v169, v153, v164, v169
    v_fma_f32 v170, -v157, v167, v170
    v_fma_f32 v171, v157, v166, v171
    v_fma_f32 v164, v152, v168, v120
    v_fma_f32 v165, v152, v169, v124
    v_fma_f32 v166, v156, v170, v128
    v_fma_f32 v167, v156, v171, v132
    v_fma_f32 v164, -v153, v169, v164
    v_fma_f32 v165, v153, v168, v165
    v_fma_f32 v166, -v157, v171, v166
    v_fma_f32 v167, v157, v170, v167
    v_fma_f32 v168, v152, v164, v121
    v_fma_f32 v169, v152, v165, v125
    v_fma_f32 v170, v156, v166, v129
    v_fma_f32 v171, v156, v167, v133
    v_fma_f32 v168, -v153, v165, v168
    v_fma_f32 v169, v153, v164, v169
    v_fma_f32 v170, -v157, v167, v170
    v_fma_f32 v171, v157, v166, v171
    v_fma_f32 v164, v152, v168, v134
    v_fma_f32 v165, v152, v169, v138
    v_fma_f32 v166, v156, v170, v142
    v_fma_f32 v167, v156, v171, v146
    v_fma_f32 v164, -v153, v169, v164
    v_fma_f32 v165, v153, v168, v165
    v_fma_f32 v166, -v157, v171, v166
    v_fma_f32 v167, v157, v170, v167
    v_fma_f32 v168, v152, v164, v135
    v_fma_f32 v169, v152, v165, v139
    v_fma_f32 v170, v156, v166, v143
    v_fma_f32 v171, v156, v167, v147
    v_fma_f32 v168, -v153, v165, v168
    v_fma_f32 v169, v153, v164, v169
    v_fma_f32 v170, -v157, v167, v170
    v_fma_f32 v171, v157, v166, v171
    v_fma_f32 v164, v152, v168, v136
    v_fma_f32 v165, v152, v169, v140
    v_fma_f32 v166, v156, v170, v144
    v_fma_f32 v167, v156, v171, v148
    v_fma_f32 v164, -v153, v169, v164
    v_fma_f32 v165, v153, v168, v165
    v_fma_f32 v166, -v157, v171, v166
    v_fma_f32 v167, v157, v170, v167
    v_fma_f32 v168, v152, v164, v137
    v_fma_f32 v169, v152, v165, v141
    v_fma_f32 v170, v156, v166, v145
    v_fma_f32 v171, v156, v167, v149
    v_fma_f32 v168, -v153, v165, v168
    v_fma_f32 v169, v153, v164, v169
    v_fma_f32 v170, -v157, v167, v170
    v_fma_f32 v171, v157, v166, v171
    v_lshrrev_b32 v172, 4, v0
    s_lshl_b32 s76, s80, 2
    v_add_u32 v172, s76, v172
    v_lshlrev_b32 v172, 9, v172
    v_and_b32 v173, 15, v0
    v_lshlrev_b32 v173, 4, v173
    s_lshl_b32 s76, s81, 8
    s_add_u32 s76, s76, 147456
    v_add3_u32 v172, v172, v173, s76
    ds_write_b128 v172, v[168:171]
    s_waitcnt lgkmcnt(0)
    s_barrier
    s_cmp_lg_u32 s28, 0
    s_cbranch_scc1 L_s_gate
    v_lshlrev_b32 v173, 3, v0
    v_add_u32 v173, 147456, v173
    ds_read_b64 v[180:181], v173 offset:0
    ds_read_b64 v[182:183], v173 offset:512
    ds_read_b64 v[184:185], v173 offset:1024
    ds_read_b64 v[186:187], v173 offset:1536
    ds_read_b64 v[188:189], v173 offset:2048
    ds_read_b64 v[190:191], v173 offset:2560
    ds_read_b64 v[192:193], v173 offset:3072
    ds_read_b64 v[194:195], v173 offset:3584
    ds_read_b64 v[196:197], v173 offset:4096
    ds_read_b64 v[198:199], v173 offset:4608
    ds_read_b64 v[200:201], v173 offset:5120
    ds_read_b64 v[202:203], v173 offset:5632
    ds_read_b64 v[204:205], v173 offset:6144
    ds_read_b64 v[206:207], v173 offset:6656
    ds_read_b64 v[208:209], v173 offset:7168
    ds_read_b64 v[210:211], v173 offset:7680
    v_mul_f32 v168, v160, v161
    v_mul_f32 v174, v160, v160
    v_fma_f32 v174, -v161, v161, v174
    v_add_f32 v175, v168, v168
    v_mul_f32 v168, v174, v175
    v_mul_f32 v174, v174, v174
    v_fma_f32 v174, -v175, v175, v174
    v_add_f32 v175, v168, v168
    v_mul_f32 v168, v174, v175
    v_mul_f32 v174, v174, v174
    v_fma_f32 v174, -v175, v175, v174
    v_add_f32 v175, v168, v168
    v_mul_f32 v168, v174, v175
    v_mul_f32 v174, v174, v174
    v_fma_f32 v174, -v175, v175, v174
    v_add_f32 v175, v168, v168
    v_mul_f32 v168, v174, v175
    v_mul_f32 v176, v174, v174
    v_fma_f32 v176, -v175, v175, v176
    v_add_f32 v177, v168, v168
    v_mul_f32 v168, v176, v177
    v_mul_f32 v176, v176, v176
    v_fma_f32 v176, -v177, v177, v176
    v_add_f32 v177, v168, v168
    v_mul_f32 v168, v176, v177
    v_mul_f32 v176, v176, v176
    v_fma_f32 v176, -v177, v177, v176
    v_add_f32 v177, v168, v168
    v_mul_f32 v168, v176, v177
    v_mul_f32 v176, v176, v176
    v_fma_f32 v176, -v177, v177, v176
    v_add_f32 v177, v168, v168
    s_waitcnt lgkmcnt(0)
    v_fma_f32 v182, v174, v180, v182
    v_fma_f32 v183, v174, v181, v183
    v_fma_f32 v182, -v175, v181, v182
    v_fma_f32 v183, v175, v180, v183
    v_fma_f32 v184, v174, v182, v184
    v_fma_f32 v185, v174, v183, v185
    v_fma_f32 v184, -v175, v183, v184
    v_fma_f32 v185, v175, v182, v185
    v_fma_f32 v186, v174, v184, v186
    v_fma_f32 v187, v174, v185, v187
    v_fma_f32 v186, -v175, v185, v186
    v_fma_f32 v187, v175, v184, v187
    v_fma_f32 v188, v174, v186, v188
    v_fma_f32 v189, v174, v187, v189
    v_fma_f32 v188, -v175, v187, v188
    v_fma_f32 v189, v175, v186, v189
    v_fma_f32 v190, v174, v188, v190
    v_fma_f32 v191, v174, v189, v191
    v_fma_f32 v190, -v175, v189, v190
    v_fma_f32 v191, v175, v188, v191
    v_fma_f32 v192, v174, v190, v192
    v_fma_f32 v193, v174, v191, v193
    v_fma_f32 v192, -v175, v191, v192
    v_fma_f32 v193, v175, v190, v193
    v_fma_f32 v194, v174, v192, v194
    v_fma_f32 v195, v174, v193, v195
    v_fma_f32 v194, -v175, v193, v194
    v_fma_f32 v195, v175, v192, v195
    v_fma_f32 v196, v174, v194, v196
    v_fma_f32 v197, v174, v195, v197
    v_fma_f32 v196, -v175, v195, v196
    v_fma_f32 v197, v175, v194, v197
    v_fma_f32 v198, v174, v196, v198
    v_fma_f32 v199, v174, v197, v199
    v_fma_f32 v198, -v175, v197, v198
    v_fma_f32 v199, v175, v196, v199
    v_fma_f32 v200, v174, v198, v200
    v_fma_f32 v201, v174, v199, v201
    v_fma_f32 v200, -v175, v199, v200
    v_fma_f32 v201, v175, v198, v201
    v_fma_f32 v202, v174, v200, v202
    v_fma_f32 v203, v174, v201, v203
    v_fma_f32 v202, -v175, v201, v202
    v_fma_f32 v203, v175, v200, v203
    v_fma_f32 v204, v174, v202, v204
    v_fma_f32 v205, v174, v203, v205
    v_fma_f32 v204, -v175, v203, v204
    v_fma_f32 v205, v175, v202, v205
    v_fma_f32 v206, v174, v204, v206
    v_fma_f32 v207, v174, v205, v207
    v_fma_f32 v206, -v175, v205, v206
    v_fma_f32 v207, v175, v204, v207
    v_fma_f32 v208, v174, v206, v208
    v_fma_f32 v209, v174, v207, v209
    v_fma_f32 v208, -v175, v207, v208
    v_fma_f32 v209, v175, v206, v209
    v_fma_f32 v210, v174, v208, v210
    v_fma_f32 v211, v174, v209, v211
    v_fma_f32 v210, -v175, v209, v210
    v_fma_f32 v211, v175, v208, v211
    s_lshl_b32 s76, s30, 6
    v_add_u32 v172, s76, v0
    v_lshlrev_b32 v172, 3, v172
    s_lshl_b32 s77, s29, 13
    s_add_u32 s77, s77, 25231360
    s_waitcnt vmcnt(0)
    v_readfirstlane_b32 s88, v1
    s_nop 3
    s_cmp_ge_u32 s88, 256
    s_cbranch_scc1 L_ic46
    s_mov_b32 s79, 0
    v_mov_b32 v220, s79
    s_mov_b32 s90, 300000
L_poll47:
    s_sub_u32 s90, s90, 1
    s_cmp_eq_u32 s90, 0
    s_cbranch_scc1 L_pok48
    buffer_load_dword v216, v220, s[20:23], 0 offen sc1
    s_waitcnt vmcnt(0)
    v_readfirstlane_b32 s88, v216
    s_nop 3
    s_cmp_ge_u32 s88, 256
    s_cbranch_scc1 L_pok48
    s_sleep 32
    s_branch L_poll47
L_pok48:
L_ic46:
    s_lshl_b32 s77, s29, 13
    s_add_u32 s77, s77, 25231360
    buffer_store_dwordx2 v[210:211], v172, s[16:19], s77 offen sc1
    v_mov_b32 v212, 0
    v_mov_b32 v213, 0
    s_cmp_eq_u32 s29, 0
    s_cbranch_scc1 L_s_nolb
    s_mov_b32 s90, 300000
L_s_lb:
    s_mov_b32 s77, 25231360
    buffer_load_dwordx2 v[214:215], v172, s[16:19], s77 offen sc1
    s_cmp_le_u32 s29, 1
    s_cbranch_scc1 L_s_lbw
    s_mov_b32 s77, 25239552
    buffer_load_dwordx2 v[216:217], v172, s[16:19], s77 offen sc1
    s_cmp_le_u32 s29, 2
    s_cbranch_scc1 L_s_lbw
    s_mov_b32 s77, 25247744
    buffer_load_dwordx2 v[218:219], v172, s[16:19], s77 offen sc1
    s_cmp_le_u32 s29, 3
    s_cbranch_scc1 L_s_lbw
    s_mov_b32 s77, 25255936
    buffer_load_dwordx2 v[220:221], v172, s[16:19], s77 offen sc1
    s_cmp_le_u32 s29, 4
    s_cbranch_scc1 L_s_lbw
    s_mov_b32 s77, 25264128
    buffer_load_dwordx2 v[222:223], v172, s[16:19], s77 offen sc1
    s_cmp_le_u32 s29, 5
    s_cbranch_scc1 L_s_lbw
    s_mov_b32 s77, 25272320
    buffer_load_dwordx2 v[224:225], v172, s[16:19], s77 offen sc1
    s_cmp_le_u32 s29, 6
    s_cbranch_scc1 L_s_lbw
    s_mov_b32 s77, 25280512
    buffer_load_dwordx2 v[226:227], v172, s[16:19], s77 offen sc1
L_s_lbw:
    s_waitcnt vmcnt(0)
    s_mov_b64 s[88:89], 0
    v_cmp_eq_u32 vcc, -1, v214
    s_nop 0
    s_or_b64 s[88:89], s[88:89], vcc
    v_cmp_eq_u32 vcc, -1, v215
    s_nop 0
    s_or_b64 s[88:89], s[88:89], vcc
    s_cmp_le_u32 s29, 1
    s_cbranch_scc1 L_s_lbc
    v_cmp_eq_u32 vcc, -1, v216
    s_nop 0
    s_or_b64 s[88:89], s[88:89], vcc
    v_cmp_eq_u32 vcc, -1, v217
    s_nop 0
    s_or_b64 s[88:89], s[88:89], vcc
    s_cmp_le_u32 s29, 2
    s_cbranch_scc1 L_s_lbc
    v_cmp_eq_u32 vcc, -1, v218
    s_nop 0
    s_or_b64 s[88:89], s[88:89], vcc
    v_cmp_eq_u32 vcc, -1, v219
    s_nop 0
    s_or_b64 s[88:89], s[88:89], vcc
    s_cmp_le_u32 s29, 3
    s_cbranch_scc1 L_s_lbc
    v_cmp_eq_u32 vcc, -1, v220
    s_nop 0
    s_or_b64 s[88:89], s[88:89], vcc
    v_cmp_eq_u32 vcc, -1, v221
    s_nop 0
    s_or_b64 s[88:89], s[88:89], vcc
    s_cmp_le_u32 s29, 4
    s_cbranch_scc1 L_s_lbc
    v_cmp_eq_u32 vcc, -1, v222
    s_nop 0
    s_or_b64 s[88:89], s[88:89], vcc
    v_cmp_eq_u32 vcc, -1, v223
    s_nop 0
    s_or_b64 s[88:89], s[88:89], vcc
    s_cmp_le_u32 s29, 5
    s_cbranch_scc1 L_s_lbc
    v_cmp_eq_u32 vcc, -1, v224
    s_nop 0
    s_or_b64 s[88:89], s[88:89], vcc
    v_cmp_eq_u32 vcc, -1, v225
    s_nop 0
    s_or_b64 s[88:89], s[88:89], vcc
    s_cmp_le_u32 s29, 6
    s_cbranch_scc1 L_s_lbc
    v_cmp_eq_u32 vcc, -1, v226
    s_nop 0
    s_or_b64 s[88:89], s[88:89], vcc
    v_cmp_eq_u32 vcc, -1, v227
    s_nop 0
    s_or_b64 s[88:89], s[88:89], vcc
L_s_lbc:
    s_cmp_eq_u64 s[88:89], 0
    s_cbranch_scc1 L_s_lbok
    s_sub_u32 s90, s90, 1
    s_cmp_eq_u32 s90, 0
    s_cbranch_scc1 L_s_lbok
    s_sleep 2
    s_branch L_s_lb
L_s_lbok:
    s_cmp_le_u32 s29, 0
    s_cbranch_scc1 L_s_nolb
    v_fma_f32 v170, v176, v212, v214
    v_fma_f32 v171, v176, v213, v215
    v_fma_f32 v170, -v177, v213, v170
    v_fma_f32 v213, v177, v212, v171
    v_mov_b32 v212, v170
    s_cmp_le_u32 s29, 1
    s_cbranch_scc1 L_s_nolb
    v_fma_f32 v170, v176, v212, v216
    v_fma_f32 v171, v176, v213, v217
    v_fma_f32 v170, -v177, v213, v170
    v_fma_f32 v213, v177, v212, v171
    v_mov_b32 v212, v170
    s_cmp_le_u32 s29, 2
    s_cbranch_scc1 L_s_nolb
    v_fma_f32 v170, v176, v212, v218
    v_fma_f32 v171, v176, v213, v219
    v_fma_f32 v170, -v177, v213, v170
    v_fma_f32 v213, v177, v212, v171
    v_mov_b32 v212, v170
    s_cmp_le_u32 s29, 3
    s_cbranch_scc1 L_s_nolb
    v_fma_f32 v170, v176, v212, v220
    v_fma_f32 v171, v176, v213, v221
    v_fma_f32 v170, -v177, v213, v170
    v_fma_f32 v213, v177, v212, v171
    v_mov_b32 v212, v170
    s_cmp_le_u32 s29, 4
    s_cbranch_scc1 L_s_nolb
    v_fma_f32 v170, v176, v212, v222
    v_fma_f32 v171, v176, v213, v223
    v_fma_f32 v170, -v177, v213, v170
    v_fma_f32 v213, v177, v212, v171
    v_mov_b32 v212, v170
    s_cmp_le_u32 s29, 5
    s_cbranch_scc1 L_s_nolb
    v_fma_f32 v170, v176, v212, v224
    v_fma_f32 v171, v176, v213, v225
    v_fma_f32 v170, -v177, v213, v170
    v_fma_f32 v213, v177, v212, v171
    v_mov_b32 v212, v170
    s_cmp_le_u32 s29, 6
    s_cbranch_scc1 L_s_nolb
    v_fma_f32 v170, v176, v212, v226
    v_fma_f32 v171, v176, v213, v227
    v_fma_f32 v170, -v177, v213, v170
    v_fma_f32 v213, v177, v212, v171
    v_mov_b32 v212, v170
L_s_nolb:
    ds_write_b64 v173, v[212:213]
    v_mul_f32 v170, v174, v212
    v_mul_f32 v171, v174, v213
    v_fma_f32 v170, -v175, v213, v170
    v_fma_f32 v213, v175, v212, v171
    v_mov_b32 v212, v170
    v_add_f32 v180, v180, v212
    v_add_f32 v181, v181, v213
    ds_write_b64 v173, v[180:181] offset:512
    v_mul_f32 v170, v174, v212
    v_mul_f32 v171, v174, v213
    v_fma_f32 v170, -v175, v213, v170
    v_fma_f32 v213, v175, v212, v171
    v_mov_b32 v212, v170
    v_add_f32 v182, v182, v212
    v_add_f32 v183, v183, v213
    ds_write_b64 v173, v[182:183] offset:1024
    v_mul_f32 v170, v174, v212
    v_mul_f32 v171, v174, v213
    v_fma_f32 v170, -v175, v213, v170
    v_fma_f32 v213, v175, v212, v171
    v_mov_b32 v212, v170
    v_add_f32 v184, v184, v212
    v_add_f32 v185, v185, v213
    ds_write_b64 v173, v[184:185] offset:1536
    v_mul_f32 v170, v174, v212
    v_mul_f32 v171, v174, v213
    v_fma_f32 v170, -v175, v213, v170
    v_fma_f32 v213, v175, v212, v171
    v_mov_b32 v212, v170
    v_add_f32 v186, v186, v212
    v_add_f32 v187, v187, v213
    ds_write_b64 v173, v[186:187] offset:2048
    v_mul_f32 v170, v174, v212
    v_mul_f32 v171, v174, v213
    v_fma_f32 v170, -v175, v213, v170
    v_fma_f32 v213, v175, v212, v171
    v_mov_b32 v212, v170
    v_add_f32 v188, v188, v212
    v_add_f32 v189, v189, v213
    ds_write_b64 v173, v[188:189] offset:2560
    v_mul_f32 v170, v174, v212
    v_mul_f32 v171, v174, v213
    v_fma_f32 v170, -v175, v213, v170
    v_fma_f32 v213, v175, v212, v171
    v_mov_b32 v212, v170
    v_add_f32 v190, v190, v212
    v_add_f32 v191, v191, v213
    ds_write_b64 v173, v[190:191] offset:3072
    v_mul_f32 v170, v174, v212
    v_mul_f32 v171, v174, v213
    v_fma_f32 v170, -v175, v213, v170
    v_fma_f32 v213, v175, v212, v171
    v_mov_b32 v212, v170
    v_add_f32 v192, v192, v212
    v_add_f32 v193, v193, v213
    ds_write_b64 v173, v[192:193] offset:3584
    v_mul_f32 v170, v174, v212
    v_mul_f32 v171, v174, v213
    v_fma_f32 v170, -v175, v213, v170
    v_fma_f32 v213, v175, v212, v171
    v_mov_b32 v212, v170
    v_add_f32 v194, v194, v212
    v_add_f32 v195, v195, v213
    ds_write_b64 v173, v[194:195] offset:4096
    v_mul_f32 v170, v174, v212
    v_mul_f32 v171, v174, v213
    v_fma_f32 v170, -v175, v213, v170
    v_fma_f32 v213, v175, v212, v171
    v_mov_b32 v212, v170
    v_add_f32 v196, v196, v212
    v_add_f32 v197, v197, v213
    ds_write_b64 v173, v[196:197] offset:4608
    v_mul_f32 v170, v174, v212
    v_mul_f32 v171, v174, v213
    v_fma_f32 v170, -v175, v213, v170
    v_fma_f32 v213, v175, v212, v171
    v_mov_b32 v212, v170
    v_add_f32 v198, v198, v212
    v_add_f32 v199, v199, v213
    ds_write_b64 v173, v[198:199] offset:5120
    v_mul_f32 v170, v174, v212
    v_mul_f32 v171, v174, v213
    v_fma_f32 v170, -v175, v213, v170
    v_fma_f32 v213, v175, v212, v171
    v_mov_b32 v212, v170
    v_add_f32 v200, v200, v212
    v_add_f32 v201, v201, v213
    ds_write_b64 v173, v[200:201] offset:5632
    v_mul_f32 v170, v174, v212
    v_mul_f32 v171, v174, v213
    v_fma_f32 v170, -v175, v213, v170
    v_fma_f32 v213, v175, v212, v171
    v_mov_b32 v212, v170
    v_add_f32 v202, v202, v212
    v_add_f32 v203, v203, v213
    ds_write_b64 v173, v[202:203] offset:6144
    v_mul_f32 v170, v174, v212
    v_mul_f32 v171, v174, v213
    v_fma_f32 v170, -v175, v213, v170
    v_fma_f32 v213, v175, v212, v171
    v_mov_b32 v212, v170
    v_add_f32 v204, v204, v212
    v_add_f32 v205, v205, v213
    ds_write_b64 v173, v[204:205] offset:6656
    v_mul_f32 v170, v174, v212
    v_mul_f32 v171, v174, v213
    v_fma_f32 v170, -v175, v213, v170
    v_fma_f32 v213, v175, v212, v171
    v_mov_b32 v212, v170
    v_add_f32 v206, v206, v212
    v_add_f32 v207, v207, v213
    ds_write_b64 v173, v[206:207] offset:7168
    v_mul_f32 v170, v174, v212
    v_mul_f32 v171, v174, v213
    v_fma_f32 v170, -v175, v213, v170
    v_fma_f32 v213, v175, v212, v171
    v_mov_b32 v212, v170
    v_add_f32 v208, v208, v212
    v_add_f32 v209, v209, v213
    ds_write_b64 v173, v[208:209] offset:7680
    s_waitcnt lgkmcnt(0)
    s_branch L_s_wait
L_s_gate:
    s_lshl_b32 s76, s29, 8
    s_lshl_b32 s77, s30, 4
    s_add_u32 s76, s76, s77
    s_add_u32 s76, s76, s28
    s_sub_u32 s76, s76, 1
    s_add_u32 s77, s76, 7
    s_add_u32 s78, s76, 14
    v_lshlrev_b32 v212, 5, v0
    s_mov_b32 s24, s68
    s_mov_b32 s25, s69
    s_mov_b32 s26, 2048
    s_mov_b32 s27, 0x20000
    buffer_load_dwordx4 v[204:207], v212, s[24:27], 0 offen
    buffer_load_dwordx4 v[208:211], v212, s[24:27], 0 offen offset:16
    s_lshl_b32 s89, s76, 11
    buffer_load_dwordx4 v[180:183], v212, s[4:7], s89 offen
    buffer_load_dwordx4 v[184:187], v212, s[4:7], s89 offen offset:16
    s_lshl_b32 s89, s77, 11
    buffer_load_dwordx4 v[188:191], v212, s[4:7], s89 offen
    buffer_load_dwordx4 v[192:195], v212, s[4:7], s89 offen offset:16
    s_cmp_gt_u32 s28, 2
    s_cbranch_scc1 L_s_g2
    s_lshl_b32 s89, s78, 11
    buffer_load_dwordx4 v[196:199], v212, s[4:7], s89 offen
    buffer_load_dwordx4 v[200:203], v212, s[4:7], s89 offen offset:16
    s_waitcnt vmcnt(0)
    v_mov_b32 v213, 0
    v_lshlrev_b32 v214, 16, v196
    v_and_b32 v215, 0xffff0000, v196
    v_lshlrev_b32 v216, 16, v204
    v_and_b32 v217, 0xffff0000, v204
    v_mul_f32 v214, v214, v216
    v_mul_f32 v215, v215, v217
    v_cvt_pk_bf16_f32 v214, v214, v215
    v_and_b32 v215, 0xffff0000, v214
    v_lshlrev_b32 v214, 16, v214
    v_add_f32 v213, v213, v214
    v_add_f32 v213, v213, v215
    v_lshlrev_b32 v214, 16, v197
    v_and_b32 v215, 0xffff0000, v197
    v_lshlrev_b32 v216, 16, v205
    v_and_b32 v217, 0xffff0000, v205
    v_mul_f32 v214, v214, v216
    v_mul_f32 v215, v215, v217
    v_cvt_pk_bf16_f32 v214, v214, v215
    v_and_b32 v215, 0xffff0000, v214
    v_lshlrev_b32 v214, 16, v214
    v_add_f32 v213, v213, v214
    v_add_f32 v213, v213, v215
    v_lshlrev_b32 v214, 16, v198
    v_and_b32 v215, 0xffff0000, v198
    v_lshlrev_b32 v216, 16, v206
    v_and_b32 v217, 0xffff0000, v206
    v_mul_f32 v214, v214, v216
    v_mul_f32 v215, v215, v217
    v_cvt_pk_bf16_f32 v214, v214, v215
    v_and_b32 v215, 0xffff0000, v214
    v_lshlrev_b32 v214, 16, v214
    v_add_f32 v213, v213, v214
    v_add_f32 v213, v213, v215
    v_lshlrev_b32 v214, 16, v199
    v_and_b32 v215, 0xffff0000, v199
    v_lshlrev_b32 v216, 16, v207
    v_and_b32 v217, 0xffff0000, v207
    v_mul_f32 v214, v214, v216
    v_mul_f32 v215, v215, v217
    v_cvt_pk_bf16_f32 v214, v214, v215
    v_and_b32 v215, 0xffff0000, v214
    v_lshlrev_b32 v214, 16, v214
    v_add_f32 v213, v213, v214
    v_add_f32 v213, v213, v215
    v_lshlrev_b32 v214, 16, v200
    v_and_b32 v215, 0xffff0000, v200
    v_lshlrev_b32 v216, 16, v208
    v_and_b32 v217, 0xffff0000, v208
    v_mul_f32 v214, v214, v216
    v_mul_f32 v215, v215, v217
    v_cvt_pk_bf16_f32 v214, v214, v215
    v_and_b32 v215, 0xffff0000, v214
    v_lshlrev_b32 v214, 16, v214
    v_add_f32 v213, v213, v214
    v_add_f32 v213, v213, v215
    v_lshlrev_b32 v214, 16, v201
    v_and_b32 v215, 0xffff0000, v201
    v_lshlrev_b32 v216, 16, v209
    v_and_b32 v217, 0xffff0000, v209
    v_mul_f32 v214, v214, v216
    v_mul_f32 v215, v215, v217
    v_cvt_pk_bf16_f32 v214, v214, v215
    v_and_b32 v215, 0xffff0000, v214
    v_lshlrev_b32 v214, 16, v214
    v_add_f32 v213, v213, v214
    v_add_f32 v213, v213, v215
    v_lshlrev_b32 v214, 16, v202
    v_and_b32 v215, 0xffff0000, v202
    v_lshlrev_b32 v216, 16, v210
    v_and_b32 v217, 0xffff0000, v210
    v_mul_f32 v214, v214, v216
    v_mul_f32 v215, v215, v217
    v_cvt_pk_bf16_f32 v214, v214, v215
    v_and_b32 v215, 0xffff0000, v214
    v_lshlrev_b32 v214, 16, v214
    v_add_f32 v213, v213, v214
    v_add_f32 v213, v213, v215
    v_lshlrev_b32 v214, 16, v203
    v_and_b32 v215, 0xffff0000, v203
    v_lshlrev_b32 v216, 16, v211
    v_and_b32 v217, 0xffff0000, v211
    v_mul_f32 v214, v214, v216
    v_mul_f32 v215, v215, v217
    v_cvt_pk_bf16_f32 v214, v214, v215
    v_and_b32 v215, 0xffff0000, v214
    v_lshlrev_b32 v214, 16, v214
    v_add_f32 v213, v213, v214
    v_add_f32 v213, v213, v215
    s_nop 1
    v_add_f32_dpp v213, v213, v213 row_shr:1 row_mask:0xf bank_mask:0xf bound_ctrl:0
    s_nop 1
    v_add_f32_dpp v213, v213, v213 row_shr:2 row_mask:0xf bank_mask:0xf bound_ctrl:0
    s_nop 1
    v_add_f32_dpp v213, v213, v213 row_shr:4 row_mask:0xf bank_mask:0xf bound_ctrl:0
    s_nop 1
    v_add_f32_dpp v213, v213, v213 row_shr:8 row_mask:0xf bank_mask:0xf bound_ctrl:0
    s_nop 1
    v_add_f32_dpp v213, v213, v213 row_bcast:15 row_mask:0xa bank_mask:0xf
    s_nop 1
    v_add_f32_dpp v213, v213, v213 row_bcast:31 row_mask:0xc bank_mask:0xf
    s_nop 1
    v_readlane_b32 s88, v213, 63
    s_nop 1
    v_mov_b32 v213, s88
    v_cvt_pk_bf16_f32 v213, v213, v213
    v_lshlrev_b32 v213, 16, v213
    v_mul_f32 v214, 0xbfb8aa3b, v213
    v_exp_f32 v214, v214
    s_nop 0
    v_add_f32 v214, 1.0, v214
    v_rcp_f32 v214, v214
    s_nop 0
    v_cvt_pk_bf16_f32 v214, v214, v214
    v_lshlrev_b32 v214, 16, v214
    v_sub_f32 v215, 1.0, v214
    v_cvt_pk_bf16_f32 v215, v215, v215
    v_lshlrev_b32 v215, 16, v215
    s_lshl_b32 s88, s78, 3
    s_add_u32 s88, s88, 25165824
    v_cmp_eq_u32 vcc, 0, v0
    s_nop 1
    v_cndmask_b32 v214, v215, v214, vcc
    v_lshlrev_b32 v216, 2, v0
    s_mov_b64 exec, 3
    buffer_store_dword v214, v216, s[16:19], s88 offen sc1
    s_mov_b64 exec, -1
L_s_g2:
    s_waitcnt vmcnt(0)
    v_mov_b32 v213, 0
    v_lshlrev_b32 v214, 16, v180
    v_and_b32 v215, 0xffff0000, v180
    v_lshlrev_b32 v216, 16, v204
    v_and_b32 v217, 0xffff0000, v204
    v_mul_f32 v214, v214, v216
    v_mul_f32 v215, v215, v217
    v_cvt_pk_bf16_f32 v214, v214, v215
    v_and_b32 v215, 0xffff0000, v214
    v_lshlrev_b32 v214, 16, v214
    v_add_f32 v213, v213, v214
    v_add_f32 v213, v213, v215
    v_lshlrev_b32 v214, 16, v181
    v_and_b32 v215, 0xffff0000, v181
    v_lshlrev_b32 v216, 16, v205
    v_and_b32 v217, 0xffff0000, v205
    v_mul_f32 v214, v214, v216
    v_mul_f32 v215, v215, v217
    v_cvt_pk_bf16_f32 v214, v214, v215
    v_and_b32 v215, 0xffff0000, v214
    v_lshlrev_b32 v214, 16, v214
    v_add_f32 v213, v213, v214
    v_add_f32 v213, v213, v215
    v_lshlrev_b32 v214, 16, v182
    v_and_b32 v215, 0xffff0000, v182
    v_lshlrev_b32 v216, 16, v206
    v_and_b32 v217, 0xffff0000, v206
    v_mul_f32 v214, v214, v216
    v_mul_f32 v215, v215, v217
    v_cvt_pk_bf16_f32 v214, v214, v215
    v_and_b32 v215, 0xffff0000, v214
    v_lshlrev_b32 v214, 16, v214
    v_add_f32 v213, v213, v214
    v_add_f32 v213, v213, v215
    v_lshlrev_b32 v214, 16, v183
    v_and_b32 v215, 0xffff0000, v183
    v_lshlrev_b32 v216, 16, v207
    v_and_b32 v217, 0xffff0000, v207
    v_mul_f32 v214, v214, v216
    v_mul_f32 v215, v215, v217
    v_cvt_pk_bf16_f32 v214, v214, v215
    v_and_b32 v215, 0xffff0000, v214
    v_lshlrev_b32 v214, 16, v214
    v_add_f32 v213, v213, v214
    v_add_f32 v213, v213, v215
    v_lshlrev_b32 v214, 16, v184
    v_and_b32 v215, 0xffff0000, v184
    v_lshlrev_b32 v216, 16, v208
    v_and_b32 v217, 0xffff0000, v208
    v_mul_f32 v214, v214, v216
    v_mul_f32 v215, v215, v217
    v_cvt_pk_bf16_f32 v214, v214, v215
    v_and_b32 v215, 0xffff0000, v214
    v_lshlrev_b32 v214, 16, v214
    v_add_f32 v213, v213, v214
    v_add_f32 v213, v213, v215
    v_lshlrev_b32 v214, 16, v185
    v_and_b32 v215, 0xffff0000, v185
    v_lshlrev_b32 v216, 16, v209
    v_and_b32 v217, 0xffff0000, v209
    v_mul_f32 v214, v214, v216
    v_mul_f32 v215, v215, v217
    v_cvt_pk_bf16_f32 v214, v214, v215
    v_and_b32 v215, 0xffff0000, v214
    v_lshlrev_b32 v214, 16, v214
    v_add_f32 v213, v213, v214
    v_add_f32 v213, v213, v215
    v_lshlrev_b32 v214, 16, v186
    v_and_b32 v215, 0xffff0000, v186
    v_lshlrev_b32 v216, 16, v210
    v_and_b32 v217, 0xffff0000, v210
    v_mul_f32 v214, v214, v216
    v_mul_f32 v215, v215, v217
    v_cvt_pk_bf16_f32 v214, v214, v215
    v_and_b32 v215, 0xffff0000, v214
    v_lshlrev_b32 v214, 16, v214
    v_add_f32 v213, v213, v214
    v_add_f32 v213, v213, v215
    v_lshlrev_b32 v214, 16, v187
    v_and_b32 v215, 0xffff0000, v187
    v_lshlrev_b32 v216, 16, v211
    v_and_b32 v217, 0xffff0000, v211
    v_mul_f32 v214, v214, v216
    v_mul_f32 v215, v215, v217
    v_cvt_pk_bf16_f32 v214, v214, v215
    v_and_b32 v215, 0xffff0000, v214
    v_lshlrev_b32 v214, 16, v214
    v_add_f32 v213, v213, v214
    v_add_f32 v213, v213, v215
    s_nop 1
    v_add_f32_dpp v213, v213, v213 row_shr:1 row_mask:0xf bank_mask:0xf bound_ctrl:0
    s_nop 1
    v_add_f32_dpp v213, v213, v213 row_shr:2 row_mask:0xf bank_mask:0xf bound_ctrl:0
    s_nop 1
    v_add_f32_dpp v213, v213, v213 row_shr:4 row_mask:0xf bank_mask:0xf bound_ctrl:0
    s_nop 1
    v_add_f32_dpp v213, v213, v213 row_shr:8 row_mask:0xf bank_mask:0xf bound_ctrl:0
    s_nop 1
    v_add_f32_dpp v213, v213, v213 row_bcast:15 row_mask:0xa bank_mask:0xf
    s_nop 1
    v_add_f32_dpp v213, v213, v213 row_bcast:31 row_mask:0xc bank_mask:0xf
    s_nop 1
    v_readlane_b32 s88, v213, 63
    s_nop 1
    v_mov_b32 v213, s88
    v_cvt_pk_bf16_f32 v213, v213, v213
    v_lshlrev_b32 v213, 16, v213
    v_mul_f32 v214, 0xbfb8aa3b, v213
    v_exp_f32 v214, v214
    s_nop 0
    v_add_f32 v214, 1.0, v214
    v_rcp_f32 v214, v214
    s_nop 0
    v_cvt_pk_bf16_f32 v214, v214, v214
    v_lshlrev_b32 v214, 16, v214
    v_sub_f32 v215, 1.0, v214
    v_cvt_pk_bf16_f32 v215, v215, v215
    v_lshlrev_b32 v215, 16, v215
    s_lshl_b32 s88, s76, 3
    s_add_u32 s88, s88, 25165824
    v_cmp_eq_u32 vcc, 0, v0
    s_nop 1
    v_cndmask_b32 v214, v215, v214, vcc
    v_lshlrev_b32 v216, 2, v0
    s_mov_b64 exec, 3
    buffer_store_dword v214, v216, s[16:19], s88 offen sc1
    s_mov_b64 exec, -1
    v_mov_b32 v213, 0
    v_lshlrev_b32 v214, 16, v188
    v_and_b32 v215, 0xffff0000, v188
    v_lshlrev_b32 v216, 16, v204
    v_and_b32 v217, 0xffff0000, v204
    v_mul_f32 v214, v214, v216
    v_mul_f32 v215, v215, v217
    v_cvt_pk_bf16_f32 v214, v214, v215
    v_and_b32 v215, 0xffff0000, v214
    v_lshlrev_b32 v214, 16, v214
    v_add_f32 v213, v213, v214
    v_add_f32 v213, v213, v215
    v_lshlrev_b32 v214, 16, v189
    v_and_b32 v215, 0xffff0000, v189
    v_lshlrev_b32 v216, 16, v205
    v_and_b32 v217, 0xffff0000, v205
    v_mul_f32 v214, v214, v216
    v_mul_f32 v215, v215, v217
    v_cvt_pk_bf16_f32 v214, v214, v215
    v_and_b32 v215, 0xffff0000, v214
    v_lshlrev_b32 v214, 16, v214
    v_add_f32 v213, v213, v214
    v_add_f32 v213, v213, v215
    v_lshlrev_b32 v214, 16, v190
    v_and_b32 v215, 0xffff0000, v190
    v_lshlrev_b32 v216, 16, v206
    v_and_b32 v217, 0xffff0000, v206
    v_mul_f32 v214, v214, v216
    v_mul_f32 v215, v215, v217
    v_cvt_pk_bf16_f32 v214, v214, v215
    v_and_b32 v215, 0xffff0000, v214
    v_lshlrev_b32 v214, 16, v214
    v_add_f32 v213, v213, v214
    v_add_f32 v213, v213, v215
    v_lshlrev_b32 v214, 16, v191
    v_and_b32 v215, 0xffff0000, v191
    v_lshlrev_b32 v216, 16, v207
    v_and_b32 v217, 0xffff0000, v207
    v_mul_f32 v214, v214, v216
    v_mul_f32 v215, v215, v217
    v_cvt_pk_bf16_f32 v214, v214, v215
    v_and_b32 v215, 0xffff0000, v214
    v_lshlrev_b32 v214, 16, v214
    v_add_f32 v213, v213, v214
    v_add_f32 v213, v213, v215
    v_lshlrev_b32 v214, 16, v192
    v_and_b32 v215, 0xffff0000, v192
    v_lshlrev_b32 v216, 16, v208
    v_and_b32 v217, 0xffff0000, v208
    v_mul_f32 v214, v214, v216
    v_mul_f32 v215, v215, v217
    v_cvt_pk_bf16_f32 v214, v214, v215
    v_and_b32 v215, 0xffff0000, v214
    v_lshlrev_b32 v214, 16, v214
    v_add_f32 v213, v213, v214
    v_add_f32 v213, v213, v215
    v_lshlrev_b32 v214, 16, v193
    v_and_b32 v215, 0xffff0000, v193
    v_lshlrev_b32 v216, 16, v209
    v_and_b32 v217, 0xffff0000, v209
    v_mul_f32 v214, v214, v216
    v_mul_f32 v215, v215, v217
    v_cvt_pk_bf16_f32 v214, v214, v215
    v_and_b32 v215, 0xffff0000, v214
    v_lshlrev_b32 v214, 16, v214
    v_add_f32 v213, v213, v214
    v_add_f32 v213, v213, v215
    v_lshlrev_b32 v214, 16, v194
    v_and_b32 v215, 0xffff0000, v194
    v_lshlrev_b32 v216, 16, v210
    v_and_b32 v217, 0xffff0000, v210
    v_mul_f32 v214, v214, v216
    v_mul_f32 v215, v215, v217
    v_cvt_pk_bf16_f32 v214, v214, v215
    v_and_b32 v215, 0xffff0000, v214
    v_lshlrev_b32 v214, 16, v214
    v_add_f32 v213, v213, v214
    v_add_f32 v213, v213, v215
    v_lshlrev_b32 v214, 16, v195
    v_and_b32 v215, 0xffff0000, v195
    v_lshlrev_b32 v216, 16, v211
    v_and_b32 v217, 0xffff0000, v211
    v_mul_f32 v214, v214, v216
    v_mul_f32 v215, v215, v217
    v_cvt_pk_bf16_f32 v214, v214, v215
    v_and_b32 v215, 0xffff0000, v214
    v_lshlrev_b32 v214, 16, v214
    v_add_f32 v213, v213, v214
    v_add_f32 v213, v213, v215
    s_nop 1
    v_add_f32_dpp v213, v213, v213 row_shr:1 row_mask:0xf bank_mask:0xf bound_ctrl:0
    s_nop 1
    v_add_f32_dpp v213, v213, v213 row_shr:2 row_mask:0xf bank_mask:0xf bound_ctrl:0
    s_nop 1
    v_add_f32_dpp v213, v213, v213 row_shr:4 row_mask:0xf bank_mask:0xf bound_ctrl:0
    s_nop 1
    v_add_f32_dpp v213, v213, v213 row_shr:8 row_mask:0xf bank_mask:0xf bound_ctrl:0
    s_nop 1
    v_add_f32_dpp v213, v213, v213 row_bcast:15 row_mask:0xa bank_mask:0xf
    s_nop 1
    v_add_f32_dpp v213, v213, v213 row_bcast:31 row_mask:0xc bank_mask:0xf
    s_nop 1
    v_readlane_b32 s88, v213, 63
    s_nop 1
    v_mov_b32 v213, s88
    v_cvt_pk_bf16_f32 v213, v213, v213
    v_lshlrev_b32 v213, 16, v213
    v_mul_f32 v214, 0xbfb8aa3b, v213
    v_exp_f32 v214, v214
    s_nop 0
    v_add_f32 v214, 1.0, v214
    v_rcp_f32 v214, v214
    s_nop 0
    v_cvt_pk_bf16_f32 v214, v214, v214
    v_lshlrev_b32 v214, 16, v214
    v_sub_f32 v215, 1.0, v214
    v_cvt_pk_bf16_f32 v215, v215, v215
    v_lshlrev_b32 v215, 16, v215
    s_lshl_b32 s88, s77, 3
    s_add_u32 s88, s88, 25165824
    v_cmp_eq_u32 vcc, 0, v0
    s_nop 1
    v_cndmask_b32 v214, v215, v214, vcc
    v_lshlrev_b32 v216, 2, v0
    s_mov_b64 exec, 3
    buffer_store_dword v214, v216, s[16:19], s88 offen sc1
    s_mov_b64 exec, -1
L_s_wait:
    s_barrier
    v_lshrrev_b32 v172, 4, v0
    s_lshl_b32 s76, s80, 2
    v_add_u32 v172, s76, v172
    v_lshlrev_b32 v172, 9, v172
    v_and_b32 v173, 15, v0
    v_lshlrev_b32 v173, 4, v173
    s_lshl_b32 s76, s81, 8
    s_add_u32 s76, s76, 147456
    v_add3_u32 v172, v172, v173, s76
    ds_read_b128 v[164:167], v172
    v_lshrrev_b32 v173, 4, v0
    v_lshlrev_b32 v173, 4, v173
    s_lshl_b32 s76, s80, 6
    v_add_u32 v173, s76, v173
    v_mul_u32_u24 v173, 272, v173
    v_and_b32 v174, 15, v0
    v_lshl_add_u32 v173, v174, 2, v173
    s_lshl_b32 s76, s81, 6
    v_add_u32 v173, s76, v173
    v_lshrrev_b32 v174, 4, v0
    s_lshl_b32 s76, s28, 5
    v_add_u32 v174, s76, v174
    s_lshl_b32 s77, s29, 8
    v_add_u32 v175, s77, v174
    v_mul_u32_u24 v175, 11264, v175
    v_mul_u32_u24 v174, 272, v174
    v_and_b32 v188, 15, v0
    v_lshl_add_u32 v174, v188, 4, v174
    v_and_b32 v188, 7, v0
    v_lshl_add_u32 v175, v188, 4, v175
    v_bfe_u32 v188, v0, 3, 1
    v_lshl_add_u32 v175, v188, 11, v175
    s_lshl_b32 s76, s30, 7
    s_add_u32 s76, s76, 0
    s_waitcnt lgkmcnt(0)
    v_fma_f32 v168, v152, v164, v86
    v_fma_f32 v169, v152, v165, v90
    v_fma_f32 v170, v156, v166, v94
    v_fma_f32 v171, v156, v167, v98
    v_fma_f32 v168, -v153, v165, v168
    v_fma_f32 v169, v153, v164, v169
    v_fma_f32 v170, -v157, v167, v170
    v_fma_f32 v171, v157, v166, v171
    v_mul_f32 v176, v154, v168
    v_mul_f32 v178, -v154, v169
    v_mul_f32 v177, v158, v170
    v_mul_f32 v179, -v158, v171
    v_fma_f32 v176, -v155, v169, v176
    v_fma_f32 v178, -v155, v168, v178
    v_fma_f32 v177, -v159, v171, v177
    v_fma_f32 v179, -v159, v170, v179
    v_cvt_pk_bf16_f32 v180, v176, v177
    v_cvt_pk_bf16_f32 v181, v178, v179
    ds_write_b32 v173, v180 offset:0
    ds_write_b32 v173, v181 offset:128
    v_fma_f32 v164, v152, v168, v87
    v_fma_f32 v165, v152, v169, v91
    v_fma_f32 v166, v156, v170, v95
    v_fma_f32 v167, v156, v171, v99
    v_fma_f32 v164, -v153, v169, v164
    v_fma_f32 v165, v153, v168, v165
    v_fma_f32 v166, -v157, v171, v166
    v_fma_f32 v167, v157, v170, v167
    v_mul_f32 v176, v154, v164
    v_mul_f32 v178, -v154, v165
    v_mul_f32 v177, v158, v166
    v_mul_f32 v179, -v158, v167
    v_fma_f32 v176, -v155, v165, v176
    v_fma_f32 v178, -v155, v164, v178
    v_fma_f32 v177, -v159, v167, v177
    v_fma_f32 v179, -v159, v166, v179
    v_cvt_pk_bf16_f32 v182, v176, v177
    v_cvt_pk_bf16_f32 v183, v178, v179
    ds_write_b32 v173, v182 offset:272
    ds_write_b32 v173, v183 offset:400
    v_fma_f32 v168, v152, v164, v88
    v_fma_f32 v169, v152, v165, v92
    v_fma_f32 v170, v156, v166, v96
    v_fma_f32 v171, v156, v167, v100
    v_fma_f32 v168, -v153, v165, v168
    v_fma_f32 v169, v153, v164, v169
    v_fma_f32 v170, -v157, v167, v170
    v_fma_f32 v171, v157, v166, v171
    v_mul_f32 v176, v154, v168
    v_mul_f32 v178, -v154, v169
    v_mul_f32 v177, v158, v170
    v_mul_f32 v179, -v158, v171
    v_fma_f32 v176, -v155, v169, v176
    v_fma_f32 v178, -v155, v168, v178
    v_fma_f32 v177, -v159, v171, v177
    v_fma_f32 v179, -v159, v170, v179
    v_cvt_pk_bf16_f32 v184, v176, v177
    v_cvt_pk_bf16_f32 v185, v178, v179
    ds_write_b32 v173, v184 offset:544
    ds_write_b32 v173, v185 offset:672
    v_fma_f32 v164, v152, v168, v89
    v_fma_f32 v165, v152, v169, v93
    v_fma_f32 v166, v156, v170, v97
    v_fma_f32 v167, v156, v171, v101
    v_fma_f32 v164, -v153, v169, v164
    v_fma_f32 v165, v153, v168, v165
    v_fma_f32 v166, -v157, v171, v166
    v_fma_f32 v167, v157, v170, v167
    v_mul_f32 v176, v154, v164
    v_mul_f32 v178, -v154, v165
    v_mul_f32 v177, v158, v166
    v_mul_f32 v179, -v158, v167
    v_fma_f32 v176, -v155, v165, v176
    v_fma_f32 v178, -v155, v164, v178
    v_fma_f32 v177, -v159, v167, v177
    v_fma_f32 v179, -v159, v166, v179
    v_cvt_pk_bf16_f32 v186, v176, v177
    v_cvt_pk_bf16_f32 v187, v178, v179
    ds_write_b32 v173, v186 offset:816
    ds_write_b32 v173, v187 offset:944
    v_fma_f32 v168, v152, v164, v102
    v_fma_f32 v169, v152, v165, v106
    v_fma_f32 v170, v156, v166, v110
    v_fma_f32 v171, v156, v167, v114
    v_fma_f32 v168, -v153, v165, v168
    v_fma_f32 v169, v153, v164, v169
    v_fma_f32 v170, -v157, v167, v170
    v_fma_f32 v171, v157, v166, v171
    v_mul_f32 v176, v154, v168
    v_mul_f32 v178, -v154, v169
    v_mul_f32 v177, v158, v170
    v_mul_f32 v179, -v158, v171
    v_fma_f32 v176, -v155, v169, v176
    v_fma_f32 v178, -v155, v168, v178
    v_fma_f32 v177, -v159, v171, v177
    v_fma_f32 v179, -v159, v170, v179
    v_cvt_pk_bf16_f32 v180, v176, v177
    v_cvt_pk_bf16_f32 v181, v178, v179
    ds_write_b32 v173, v180 offset:1088
    ds_write_b32 v173, v181 offset:1216
    v_fma_f32 v164, v152, v168, v103
    v_fma_f32 v165, v152, v169, v107
    v_fma_f32 v166, v156, v170, v111
    v_fma_f32 v167, v156, v171, v115
    v_fma_f32 v164, -v153, v169, v164
    v_fma_f32 v165, v153, v168, v165
    v_fma_f32 v166, -v157, v171, v166
    v_fma_f32 v167, v157, v170, v167
    v_mul_f32 v176, v154, v164
    v_mul_f32 v178, -v154, v165
    v_mul_f32 v177, v158, v166
    v_mul_f32 v179, -v158, v167
    v_fma_f32 v176, -v155, v165, v176
    v_fma_f32 v178, -v155, v164, v178
    v_fma_f32 v177, -v159, v167, v177
    v_fma_f32 v179, -v159, v166, v179
    v_cvt_pk_bf16_f32 v182, v176, v177
    v_cvt_pk_bf16_f32 v183, v178, v179
    ds_write_b32 v173, v182 offset:1360
    ds_write_b32 v173, v183 offset:1488
    v_fma_f32 v168, v152, v164, v104
    v_fma_f32 v169, v152, v165, v108
    v_fma_f32 v170, v156, v166, v112
    v_fma_f32 v171, v156, v167, v116
    v_fma_f32 v168, -v153, v165, v168
    v_fma_f32 v169, v153, v164, v169
    v_fma_f32 v170, -v157, v167, v170
    v_fma_f32 v171, v157, v166, v171
    v_mul_f32 v176, v154, v168
    v_mul_f32 v178, -v154, v169
    v_mul_f32 v177, v158, v170
    v_mul_f32 v179, -v158, v171
    v_fma_f32 v176, -v155, v169, v176
    v_fma_f32 v178, -v155, v168, v178
    v_fma_f32 v177, -v159, v171, v177
    v_fma_f32 v179, -v159, v170, v179
    v_cvt_pk_bf16_f32 v184, v176, v177
    v_cvt_pk_bf16_f32 v185, v178, v179
    ds_write_b32 v173, v184 offset:1632
    ds_write_b32 v173, v185 offset:1760
    v_fma_f32 v164, v152, v168, v105
    v_fma_f32 v165, v152, v169, v109
    v_fma_f32 v166, v156, v170, v113
    v_fma_f32 v167, v156, v171, v117
    v_fma_f32 v164, -v153, v169, v164
    v_fma_f32 v165, v153, v168, v165
    v_fma_f32 v166, -v157, v171, v166
    v_fma_f32 v167, v157, v170, v167
    v_mul_f32 v176, v154, v164
    v_mul_f32 v178, -v154, v165
    v_mul_f32 v177, v158, v166
    v_mul_f32 v179, -v158, v167
    v_fma_f32 v176, -v155, v165, v176
    v_fma_f32 v178, -v155, v164, v178
    v_fma_f32 v177, -v159, v167, v177
    v_fma_f32 v179, -v159, v166, v179
    v_cvt_pk_bf16_f32 v186, v176, v177
    v_cvt_pk_bf16_f32 v187, v178, v179
    ds_write_b32 v173, v186 offset:1904
    ds_write_b32 v173, v187 offset:2032
    s_waitcnt lgkmcnt(0)
    s_barrier
    ds_read_b128 v[192:195], v174 offset:0
    ds_read_b128 v[196:199], v174 offset:1088
    ds_read_b128 v[200:203], v174 offset:4352
    ds_read_b128 v[204:207], v174 offset:5440
    s_waitcnt lgkmcnt(3)
    s_add_u32 s77, s76, 0
    buffer_store_dwordx4 v[192:195], v175, s[16:19], s77 offen sc1
    s_waitcnt lgkmcnt(2)
    s_add_u32 s77, s76, 45056
    buffer_store_dwordx4 v[196:199], v175, s[16:19], s77 offen sc1
    s_waitcnt lgkmcnt(1)
    s_add_u32 s77, s76, 180224
    buffer_store_dwordx4 v[200:203], v175, s[16:19], s77 offen sc1
    s_waitcnt lgkmcnt(0)
    s_add_u32 s77, s76, 225280
    buffer_store_dwordx4 v[204:207], v175, s[16:19], s77 offen sc1
    v_fma_f32 v168, v152, v164, v118
    v_fma_f32 v169, v152, v165, v122
    v_fma_f32 v170, v156, v166, v126
    v_fma_f32 v171, v156, v167, v130
    v_fma_f32 v168, -v153, v165, v168
    v_fma_f32 v169, v153, v164, v169
    v_fma_f32 v170, -v157, v167, v170
    v_fma_f32 v171, v157, v166, v171
    v_mul_f32 v176, v154, v168
    v_mul_f32 v178, -v154, v169
    v_mul_f32 v177, v158, v170
    v_mul_f32 v179, -v158, v171
    v_fma_f32 v176, -v155, v169, v176
    v_fma_f32 v178, -v155, v168, v178
    v_fma_f32 v177, -v159, v171, v177
    v_fma_f32 v179, -v159, v170, v179
    v_cvt_pk_bf16_f32 v180, v176, v177
    v_cvt_pk_bf16_f32 v181, v178, v179
    ds_write_b32 v173, v180 offset:2176
    ds_write_b32 v173, v181 offset:2304
    v_fma_f32 v164, v152, v168, v119
    v_fma_f32 v165, v152, v169, v123
    v_fma_f32 v166, v156, v170, v127
    v_fma_f32 v167, v156, v171, v131
    v_fma_f32 v164, -v153, v169, v164
    v_fma_f32 v165, v153, v168, v165
    v_fma_f32 v166, -v157, v171, v166
    v_fma_f32 v167, v157, v170, v167
    v_mul_f32 v176, v154, v164
    v_mul_f32 v178, -v154, v165
    v_mul_f32 v177, v158, v166
    v_mul_f32 v179, -v158, v167
    v_fma_f32 v176, -v155, v165, v176
    v_fma_f32 v178, -v155, v164, v178
    v_fma_f32 v177, -v159, v167, v177
    v_fma_f32 v179, -v159, v166, v179
    v_cvt_pk_bf16_f32 v182, v176, v177
    v_cvt_pk_bf16_f32 v183, v178, v179
    ds_write_b32 v173, v182 offset:2448
    ds_write_b32 v173, v183 offset:2576
    v_fma_f32 v168, v152, v164, v120
    v_fma_f32 v169, v152, v165, v124
    v_fma_f32 v170, v156, v166, v128
    v_fma_f32 v171, v156, v167, v132
    v_fma_f32 v168, -v153, v165, v168
    v_fma_f32 v169, v153, v164, v169
    v_fma_f32 v170, -v157, v167, v170
    v_fma_f32 v171, v157, v166, v171
    v_mul_f32 v176, v154, v168
    v_mul_f32 v178, -v154, v169
    v_mul_f32 v177, v158, v170
    v_mul_f32 v179, -v158, v171
    v_fma_f32 v176, -v155, v169, v176
    v_fma_f32 v178, -v155, v168, v178
    v_fma_f32 v177, -v159, v171, v177
    v_fma_f32 v179, -v159, v170, v179
    v_cvt_pk_bf16_f32 v184, v176, v177
    v_cvt_pk_bf16_f32 v185, v178, v179
    ds_write_b32 v173, v184 offset:2720
    ds_write_b32 v173, v185 offset:2848
    v_fma_f32 v164, v152, v168, v121
    v_fma_f32 v165, v152, v169, v125
    v_fma_f32 v166, v156, v170, v129
    v_fma_f32 v167, v156, v171, v133
    v_fma_f32 v164, -v153, v169, v164
    v_fma_f32 v165, v153, v168, v165
    v_fma_f32 v166, -v157, v171, v166
    v_fma_f32 v167, v157, v170, v167
    v_mul_f32 v176, v154, v164
    v_mul_f32 v178, -v154, v165
    v_mul_f32 v177, v158, v166
    v_mul_f32 v179, -v158, v167
    v_fma_f32 v176, -v155, v165, v176
    v_fma_f32 v178, -v155, v164, v178
    v_fma_f32 v177, -v159, v167, v177
    v_fma_f32 v179, -v159, v166, v179
    v_cvt_pk_bf16_f32 v186, v176, v177
    v_cvt_pk_bf16_f32 v187, v178, v179
    ds_write_b32 v173, v186 offset:2992
    ds_write_b32 v173, v187 offset:3120
    v_fma_f32 v168, v152, v164, v134
    v_fma_f32 v169, v152, v165, v138
    v_fma_f32 v170, v156, v166, v142
    v_fma_f32 v171, v156, v167, v146
    v_fma_f32 v168, -v153, v165, v168
    v_fma_f32 v169, v153, v164, v169
    v_fma_f32 v170, -v157, v167, v170
    v_fma_f32 v171, v157, v166, v171
    v_mul_f32 v176, v154, v168
    v_mul_f32 v178, -v154, v169
    v_mul_f32 v177, v158, v170
    v_mul_f32 v179, -v158, v171
    v_fma_f32 v176, -v155, v169, v176
    v_fma_f32 v178, -v155, v168, v178
    v_fma_f32 v177, -v159, v171, v177
    v_fma_f32 v179, -v159, v170, v179
    v_cvt_pk_bf16_f32 v180, v176, v177
    v_cvt_pk_bf16_f32 v181, v178, v179
    ds_write_b32 v173, v180 offset:3264
    ds_write_b32 v173, v181 offset:3392
    v_fma_f32 v164, v152, v168, v135
    v_fma_f32 v165, v152, v169, v139
    v_fma_f32 v166, v156, v170, v143
    v_fma_f32 v167, v156, v171, v147
    v_fma_f32 v164, -v153, v169, v164
    v_fma_f32 v165, v153, v168, v165
    v_fma_f32 v166, -v157, v171, v166
    v_fma_f32 v167, v157, v170, v167
    v_mul_f32 v176, v154, v164
    v_mul_f32 v178, -v154, v165
    v_mul_f32 v177, v158, v166
    v_mul_f32 v179, -v158, v167
    v_fma_f32 v176, -v155, v165, v176
    v_fma_f32 v178, -v155, v164, v178
    v_fma_f32 v177, -v159, v167, v177
    v_fma_f32 v179, -v159, v166, v179
    v_cvt_pk_bf16_f32 v182, v176, v177
    v_cvt_pk_bf16_f32 v183, v178, v179
    ds_write_b32 v173, v182 offset:3536
    ds_write_b32 v173, v183 offset:3664
    v_fma_f32 v168, v152, v164, v136
    v_fma_f32 v169, v152, v165, v140
    v_fma_f32 v170, v156, v166, v144
    v_fma_f32 v171, v156, v167, v148
    v_fma_f32 v168, -v153, v165, v168
    v_fma_f32 v169, v153, v164, v169
    v_fma_f32 v170, -v157, v167, v170
    v_fma_f32 v171, v157, v166, v171
    v_mul_f32 v176, v154, v168
    v_mul_f32 v178, -v154, v169
    v_mul_f32 v177, v158, v170
    v_mul_f32 v179, -v158, v171
    v_fma_f32 v176, -v155, v169, v176
    v_fma_f32 v178, -v155, v168, v178
    v_fma_f32 v177, -v159, v171, v177
    v_fma_f32 v179, -v159, v170, v179
    v_cvt_pk_bf16_f32 v184, v176, v177
    v_cvt_pk_bf16_f32 v185, v178, v179
    ds_write_b32 v173, v184 offset:3808
    ds_write_b32 v173, v185 offset:3936
    v_fma_f32 v164, v152, v168, v137
    v_fma_f32 v165, v152, v169, v141
    v_fma_f32 v166, v156, v170, v145
    v_fma_f32 v167, v156, v171, v149
    v_fma_f32 v164, -v153, v169, v164
    v_fma_f32 v165, v153, v168, v165
    v_fma_f32 v166, -v157, v171, v166
    v_fma_f32 v167, v157, v170, v167
    v_mul_f32 v176, v154, v164
    v_mul_f32 v178, -v154, v165
    v_mul_f32 v177, v158, v166
    v_mul_f32 v179, -v158, v167
    v_fma_f32 v176, -v155, v165, v176
    v_fma_f32 v178, -v155, v164, v178
    v_fma_f32 v177, -v159, v167, v177
    v_fma_f32 v179, -v159, v166, v179
    v_cvt_pk_bf16_f32 v186, v176, v177
    v_cvt_pk_bf16_f32 v187, v178, v179
    ds_write_b32 v173, v186 offset:4080
    ds_write_b32 v173, v187 offset:4208
    s_waitcnt lgkmcnt(0)
    s_barrier
    ds_read_b128 v[192:195], v174 offset:2176
    ds_read_b128 v[196:199], v174 offset:3264
    ds_read_b128 v[200:203], v174 offset:6528
    ds_read_b128 v[204:207], v174 offset:7616
    s_waitcnt lgkmcnt(3)
    s_add_u32 s77, s76, 90112
    buffer_store_dwordx4 v[192:195], v175, s[16:19], s77 offen sc1
    s_waitcnt lgkmcnt(2)
    s_add_u32 s77, s76, 135168
    buffer_store_dwordx4 v[196:199], v175, s[16:19], s77 offen sc1
    s_waitcnt lgkmcnt(1)
    s_add_u32 s77, s76, 270336
    buffer_store_dwordx4 v[200:203], v175, s[16:19], s77 offen sc1
    s_waitcnt lgkmcnt(0)
    s_add_u32 s77, s76, 315392
    buffer_store_dwordx4 v[204:207], v175, s[16:19], s77 offen sc1
    s_and_b32 s76, s2, 7
    s_lshr_b32 s77, s2, 3
    s_lshr_b32 s0, s76, 1
    s_and_b32 s78, s76, 1
    s_lshl_b32 s86, s78, 2
    s_bfe_u32 s78, s77, 0x20002
    s_add_u32 s86, s86, s78
    s_and_b32 s78, s0, 1
    s_lshl_b32 s87, s78, 2
    s_and_b32 s78, s77, 3
    s_add_u32 s87, s87, s78
    s_lshl_b32 s85, s86, 3
    s_add_u32 s85, s85, s87
    s_lshr_b32 s80, s28, 2
    s_and_b32 s81, s28, 3
    s_mov_b32 s24, s64
    s_mov_b32 s25, s65
    s_mov_b32 s26, 7340032
    s_mov_b32 s27, 0x20000
    s_lshr_b32 s76, s0, 1
    s_cmp_eq_u32 s76, 0
    s_cselect_b32 s8, s50, s52
    s_cselect_b32 s9, s51, s53
    s_mov_b32 s10, 2097152
    s_mov_b32 s11, 0x20000
    v_and_b32 v2, 7, v0
    v_lshrrev_b32 v3, 4, v0
    v_xor_b32 v2, v2, v3
    v_lshlrev_b32 v2, 4, v2
    v_lshrrev_b32 v3, 3, v0
    v_lshl_add_u32 v5, v3, 11, v2
    s_lshl_b32 s76, s87, 7
    s_lshl_b32 s77, s28, 4
    s_add_u32 s76, s76, s77
    s_lshl_b32 s76, s76, 11
    v_add_u32 v10, s76, v5
    s_lshl_b32 s76, s87, 7
    s_lshl_b32 s77, s28, 4
    s_add_u32 s76, s76, s77
    s_add_u32 s76, s76, 8
    s_lshl_b32 s76, s76, 11
    s_sub_u32 s76, s76, 1024
    v_xor_b32 v11, 64, v5
    v_add_u32 v11, s76, v11
    s_lshl_b32 s38, s28, 11
    s_lshl_b32 s76, s87, 8
    s_mul_i32 s88, s28, 2
    s_add_u32 s89, s88, 0
    s_lshl_b32 s89, s89, 6
    v_add_u32 v6, s89, v0
    v_lshrrev_b32 v7, 4, v6
    v_and_b32 v6, 15, v6
    v_and_b32 v8, 3, v7
    v_bfe_u32 v9, v7, 3, 1
    v_lshl_or_b32 v8, v9, 2, v8
    v_lshlrev_b32 v8, 1, v8
    v_xor_b32 v6, v6, v8
    v_mul_u32_u24 v7, 2048, v7
    v_lshl_add_u32 v6, v6, 4, v7
    v_add_u32 v15, s76, v6
    s_add_u32 s89, s88, 1
    s_lshl_b32 s89, s89, 6
    v_add_u32 v6, s89, v0
    v_lshrrev_b32 v7, 4, v6
    v_and_b32 v6, 15, v6
    v_and_b32 v8, 3, v7
    v_bfe_u32 v9, v7, 3, 1
    v_lshl_or_b32 v8, v9, 2, v8
    v_lshlrev_b32 v8, 1, v8
    v_xor_b32 v6, v6, v8
    v_mul_u32_u24 v7, 2048, v7
    v_lshl_add_u32 v6, v6, 4, v7
    s_sub_u32 s89, s76, 1024
    v_add_u32 v16, s89, v6
    s_mul_i32 s83, s28, 2
    s_lshl_b32 s83, s83, 10
    v_lshrrev_b32 v3, 3, v0
    v_mul_u32_u24 v3, 11264, v3
    v_add_u32 v5, v3, v2
    s_mul_i32 s76, s28, 32
    s_lshr_b32 s77, s76, 4
    s_add_u32 s77, s77, s0
    s_and_b32 s77, s77, 3
    s_lshl_b32 s77, s77, 4
    s_andn2_b32 s76, s76, 48
    s_or_b32 s76, s76, s77
    s_mul_i32 s77, s86, 256
    s_add_u32 s76, s76, s77
    s_mul_i32 s76, s76, 11264
    v_add_u32 v25, s76, v5
    s_mul_i32 s76, s28, 32
    s_add_u32 s76, s76, 8
    s_lshr_b32 s77, s76, 4
    s_add_u32 s77, s77, s0
    s_and_b32 s77, s77, 3
    s_lshl_b32 s77, s77, 4
    s_andn2_b32 s76, s76, 48
    s_or_b32 s76, s76, s77
    s_mul_i32 s77, s86, 256
    s_add_u32 s76, s76, s77
    s_mul_i32 s76, s76, 11264
    s_sub_u32 s76, s76, 1024
    v_xor_b32 v26, 64, v5
    v_add_u32 v26, s76, v26
    s_mul_i32 s76, s28, 32
    s_add_u32 s76, s76, 16
    s_lshr_b32 s77, s76, 4
    s_add_u32 s77, s77, s0
    s_and_b32 s77, s77, 3
    s_lshl_b32 s77, s77, 4
    s_andn2_b32 s76, s76, 48
    s_or_b32 s76, s76, s77
    s_mul_i32 s77, s86, 256
    s_add_u32 s76, s76, s77
    s_mul_i32 s76, s76, 11264
    s_sub_u32 s76, s76, 2048
    v_add_u32 v27, s76, v5
    s_mul_i32 s76, s28, 32
    s_add_u32 s76, s76, 24
    s_lshr_b32 s77, s76, 4
    s_add_u32 s77, s77, s0
    s_and_b32 s77, s77, 3
    s_lshl_b32 s77, s77, 4
    s_andn2_b32 s76, s76, 48
    s_or_b32 s76, s76, s77
    s_mul_i32 s77, s86, 256
    s_add_u32 s76, s76, s77
    s_mul_i32 s76, s76, 11264
    s_sub_u32 s76, s76, 3072
    v_xor_b32 v28, 64, v5
    v_add_u32 v28, s76, v28
    s_mul_i32 s39, s28, 4096
    s_add_u32 s39, s39, 16384
    s_mul_i32 s37, s0, 1024
    s_and_b32 s36, s37, 2047
    s_lshr_b32 s76, s0, 1
    s_mul_i32 s76, s76, 28
    s_and_b32 s77, s0, 1
    s_mul_i32 s77, s77, 12
    s_add_u32 s76, s76, s77
    s_mul_i32 s84, s76, 131072
    s_lshl_b32 s3, s76, 7
    s_add_u32 s3, s3, 4096
    s_mul_i32 s76, s80, 4
    v_and_b32 v2, 15, v0
    v_lshrrev_b32 v3, 4, v0
    v_lshrrev_b32 v4, 1, v2
    v_xor_b32 v3, v3, v4
    v_lshlrev_b32 v3, 4, v3
    v_lshl_add_u32 v2, v2, 7, v3
    s_lshl_b32 s88, s76, 11
    v_add_u32 v12, s88, v2
    v_lshrrev_b32 v2, 4, v0
    v_lshlrev_b32 v2, 3, v2
    v_bfe_u32 v3, v0, 2, 2
    v_add_u32 v2, v2, v3
    v_and_b32 v3, 3, v2
    v_bfe_u32 v4, v2, 3, 1
    v_lshl_or_b32 v3, v4, 2, v3
    v_mul_u32_u24 v2, 256, v2
    v_and_b32 v4, 3, v0
    v_lshl_add_u32 v2, v4, 3, v2
    s_add_u32 s88, s76, 0
    v_xor_b32 v4, s88, v3
    v_lshl_add_u32 v17, v4, 5, v2
    s_add_u32 s88, s76, 1
    v_xor_b32 v4, s88, v3
    v_subrev_u32 v4, 1, v4
    v_lshl_add_u32 v18, v4, 5, v2
    s_add_u32 s88, s76, 2
    v_xor_b32 v4, s88, v3
    v_subrev_u32 v4, 2, v4
    v_lshl_add_u32 v19, v4, 5, v2
    s_add_u32 s88, s76, 3
    v_xor_b32 v4, s88, v3
    v_subrev_u32 v4, 3, v4
    v_lshl_add_u32 v20, v4, 5, v2
    s_mul_i32 s76, s81, 4
    v_and_b32 v2, 15, v0
    v_lshrrev_b32 v3, 4, v0
    v_lshrrev_b32 v4, 1, v2
    v_xor_b32 v3, v3, v4
    v_lshlrev_b32 v3, 4, v3
    v_lshl_add_u32 v2, v2, 7, v3
    s_lshl_b32 s88, s76, 11
    s_add_u32 s88, s88, 16384
    v_add_u32 v29, s88, v2
    s_barrier
    s_mov_b32 s32, 0
    s_add_u32 s35, s32, s38
    s_mov_b32 m0, s35
    s_nop 0
    buffer_load_dwordx4 v10, s[8:11], s36 offen lds
    buffer_load_dwordx4 v11, s[8:11], s36 offen offset:1024 lds
    s_add_u32 s36, s36, 128
    s_add_u32 s32, s32, 49152
    s_add_u32 s35, s32, s38
    s_mov_b32 m0, s35
    s_nop 0
    buffer_load_dwordx4 v10, s[8:11], s36 offen lds
    buffer_load_dwordx4 v11, s[8:11], s36 offen offset:1024 lds
    s_add_u32 s36, s36, 128
    s_add_u32 s32, s32, 49152
    s_add_u32 s35, s32, s38
    s_mov_b32 m0, s35
    s_nop 0
    buffer_load_dwordx4 v10, s[8:11], s36 offen lds
    buffer_load_dwordx4 v11, s[8:11], s36 offen offset:1024 lds
    s_add_u32 s36, s36, 128
    s_add_u32 s32, s32, 49152
    s_waitcnt vmcnt(6)
    s_barrier
    s_cmp_eq_u32 s28, 1
    s_cbranch_scc1 L_p2A_pl
    s_cmp_lg_u32 s28, 0
    s_cbranch_scc1 L_p2A_dep
    v_mov_b32 v3, s29
    v_bfe_u32 v5, v0, 3, 2
    v_lshrrev_b32 v4, 2, v3
    v_mad_u32_u24 v4, v5, 2, v4
    v_and_b32 v3, 3, v3
    v_lshlrev_b32 v3, 2, v3
    v_and_b32 v2, 3, v0
    v_or_b32 v3, v3, v2
    v_bfe_u32 v2, v0, 2, 1
    v_and_b32 v5, 1, v5
    v_xor_b32 v2, v2, v5
    v_xor_b32 v2, 1, v2
    v_lshl_or_b32 v3, v2, 4, v3
    v_lshl_or_b32 v3, v3, 3, v4
    v_lshlrev_b32 v3, 8, v3
    s_and_b32 s76, s30, 7
    s_lshl_b32 s76, 1, s76
    v_mov_b32 v2, s76
    s_lshr_b32 s76, s30, 3
    s_lshl_b32 s76, s76, 2
    s_add_u32 s76, s76, 25362432
    s_mov_b32 exec_hi, 0
    buffer_atomic_add v2, v3, s[16:19], s76 offen sc1
    s_mov_b64 exec, -1
    s_branch L_p2A_dep
L_p2A_pl:
    s_lshl_b32 s79, s2, 8
    s_add_u32 s79, s79, 25362432
    v_mov_b32 v6, s79
    s_mov_b32 s90, 300000
L_poll49:
    s_sub_u32 s90, s90, 1
    s_cmp_eq_u32 s90, 0
    s_cbranch_scc1 L_pok50
    buffer_load_dwordx4 v[2:5], v6, s[16:19], 0 offen sc1
    s_waitcnt vmcnt(0)
    v_readfirstlane_b32 s88, v2
    v_readfirstlane_b32 s89, v3
    v_readfirstlane_b32 s91, v4
    s_nop 3
    s_bitcmp1_b32 s0, 0
    s_cselect_b32 s49, s89, s88
    s_and_b32 s88, s49, 7
    s_cmp_eq_u32 s88, 7
    s_cbranch_scc1 L_pok50
    s_sleep 2
    s_branch L_poll49
L_pok50:
L_p2A_dep:
    s_barrier
    s_mov_b32 s32, 0
    s_add_u32 s35, s32, s39
    s_mov_b32 m0, s35
    s_nop 0
    buffer_load_dwordx4 v25, s[16:19], s37 offen sc1 lds
    buffer_load_dwordx4 v26, s[16:19], s37 offen offset:1024 sc1 lds
    buffer_load_dwordx4 v27, s[16:19], s37 offen offset:2048 sc1 lds
    buffer_load_dwordx4 v28, s[16:19], s37 offen offset:3072 sc1 lds
    s_add_u32 s37, s37, 128
    s_add_u32 s32, s32, 49152
    s_add_u32 s35, s32, s39
    s_mov_b32 m0, s35
    s_nop 0
    buffer_load_dwordx4 v25, s[16:19], s37 offen sc1 lds
    buffer_load_dwordx4 v26, s[16:19], s37 offen offset:1024 sc1 lds
    buffer_load_dwordx4 v27, s[16:19], s37 offen offset:2048 sc1 lds
    buffer_load_dwordx4 v28, s[16:19], s37 offen offset:3072 sc1 lds
    s_add_u32 s37, s37, 128
    s_add_u32 s32, s32, 49152
    s_add_u32 s32, s32, 49152
    s_waitcnt vmcnt(4)
    s_barrier
    v_mov_b32 v13, v12
    v_xor_b32 v14, 64, v12
    v_mov_b32 v30, v29
    v_xor_b32 v31, 64, v29
    v_mov_b32 v21, v17
    v_mov_b32 v22, v18
    v_mov_b32 v23, v19
    v_mov_b32 v24, v20
    s_mov_b32 s33, 0
    s_mov_b32 s32, 98304
    ds_read_b128 v[32:35], v13 offset:0
    ds_read_b128 v[48:51], v30 offset:0
    ds_read_b128 v[36:39], v13 offset:2048
    ds_read_b128 v[52:55], v30 offset:2048
    ds_read_b128 v[40:43], v13 offset:4096
    ds_read_b128 v[56:59], v30 offset:4096
    ds_read_b128 v[44:47], v13 offset:6144
    ds_read_b128 v[60:63], v30 offset:6144
    s_mov_b32 s31, s32
    s_mov_b32 s32, s33
    s_add_u32 s33, s33, 49152
    s_cmp_eq_u32 s33, 147456
    s_cselect_b32 s33, 0, s33
    s_waitcnt lgkmcnt(0)
    v_mfma_f32_16x16x32_bf16 v[160:163], v[32:35], v[48:51], 0
    ds_read_b128 v[64:67], v14 offset:0
    v_mfma_f32_16x16x32_bf16 v[164:167], v[32:35], v[52:55], 0
    s_add_u32 s35, s31, s39
    s_mov_b32 m0, s35
    s_nop 0
    buffer_load_dwordx4 v25, s[16:19], s37 offen sc1 lds
    v_mfma_f32_16x16x32_bf16 v[168:171], v[32:35], v[56:59], 0
    ds_read_b128 v[80:83], v31 offset:0
    v_mfma_f32_16x16x32_bf16 v[172:175], v[32:35], v[60:63], 0
    buffer_load_dwordx4 v26, s[16:19], s37 offen offset:1024 sc1 lds
    v_mfma_f32_16x16x32_bf16 v[176:179], v[36:39], v[48:51], 0
    ds_read_b128 v[68:71], v14 offset:2048
    v_mfma_f32_16x16x32_bf16 v[180:183], v[36:39], v[52:55], 0
    ds_read_b128 v[84:87], v31 offset:2048
    v_mfma_f32_16x16x32_bf16 v[184:187], v[36:39], v[56:59], 0
    buffer_load_dwordx4 v27, s[16:19], s37 offen offset:2048 sc1 lds
    v_mfma_f32_16x16x32_bf16 v[188:191], v[36:39], v[60:63], 0
    v_mfma_f32_16x16x32_bf16 v[192:195], v[40:43], v[48:51], 0
    ds_read_b128 v[72:75], v14 offset:4096
    v_mfma_f32_16x16x32_bf16 v[196:199], v[40:43], v[52:55], 0
    ds_read_b128 v[88:91], v31 offset:4096
    v_mfma_f32_16x16x32_bf16 v[200:203], v[40:43], v[56:59], 0
    buffer_load_dwordx4 v28, s[16:19], s37 offen offset:3072 sc1 lds
    v_mfma_f32_16x16x32_bf16 v[204:207], v[40:43], v[60:63], 0
    ds_read_b128 v[76:79], v14 offset:6144
    v_mfma_f32_16x16x32_bf16 v[208:211], v[44:47], v[48:51], 0
    ds_read_b128 v[92:95], v31 offset:6144
    v_mfma_f32_16x16x32_bf16 v[212:215], v[44:47], v[52:55], 0
    s_add_u32 s37, s37, 128
    v_mfma_f32_16x16x32_bf16 v[216:219], v[44:47], v[56:59], 0
    v_add_u32 v13, s33, v12
    v_add_u32 v30, s33, v29
    v_mfma_f32_16x16x32_bf16 v[220:223], v[44:47], v[60:63], 0
    s_cmp_lg_u32 s28, 1
    s_cbranch_scc1 L_hs51
    s_bitcmp1_b32 s49, 3
    s_cbranch_scc1 L_hs51
    s_lshl_b32 s79, s2, 8
    s_add_u32 s79, s79, 25362432
    v_mov_b32 v6, s79
    s_mov_b32 s90, 300000
L_poll52:
    s_sub_u32 s90, s90, 1
    s_cmp_eq_u32 s90, 0
    s_cbranch_scc1 L_pok53
    buffer_load_dwordx4 v[2:5], v6, s[16:19], 0 offen sc1
    s_waitcnt vmcnt(0)
    v_readfirstlane_b32 s88, v2
    v_readfirstlane_b32 s89, v3
    v_readfirstlane_b32 s91, v4
    s_nop 3
    s_bitcmp1_b32 s0, 0
    s_cselect_b32 s49, s89, s88
    s_and_b32 s88, s49, 8
    s_cmp_eq_u32 s88, 8
    s_cbranch_scc1 L_pok53
    s_sleep 2
    s_branch L_poll52
L_pok53:
L_hs51:
    s_waitcnt vmcnt(4) lgkmcnt(0)
    s_barrier
    s_setprio 1
    v_mfma_f32_16x16x32_bf16 v[160:163], v[64:67], v[80:83], v[160:163]
    ds_read_b128 v[32:35], v13 offset:0
    v_mfma_f32_16x16x32_bf16 v[164:167], v[64:67], v[84:87], v[164:167]
    s_add_u32 s35, s32, s38
    s_mov_b32 m0, s35
    s_nop 0
    buffer_load_dwordx4 v10, s[8:11], s36 offen lds
    v_mfma_f32_16x16x32_bf16 v[168:171], v[64:67], v[88:91], v[168:171]
    ds_read_b128 v[48:51], v30 offset:0
    v_mfma_f32_16x16x32_bf16 v[172:175], v[64:67], v[92:95], v[172:175]
    v_mfma_f32_16x16x32_bf16 v[176:179], v[68:71], v[80:83], v[176:179]
    ds_read_b128 v[36:39], v13 offset:2048
    v_mfma_f32_16x16x32_bf16 v[180:183], v[68:71], v[84:87], v[180:183]
    buffer_load_dwordx4 v11, s[8:11], s36 offen offset:1024 lds
    v_mfma_f32_16x16x32_bf16 v[184:187], v[68:71], v[88:91], v[184:187]
    ds_read_b128 v[52:55], v30 offset:2048
    v_mfma_f32_16x16x32_bf16 v[188:191], v[68:71], v[92:95], v[188:191]
    v_mfma_f32_16x16x32_bf16 v[192:195], v[72:75], v[80:83], v[192:195]
    ds_read_b128 v[40:43], v13 offset:4096
    v_mfma_f32_16x16x32_bf16 v[196:199], v[72:75], v[84:87], v[196:199]
    ds_read_b128 v[56:59], v30 offset:4096
    v_mfma_f32_16x16x32_bf16 v[200:203], v[72:75], v[88:91], v[200:203]
    s_add_u32 s36, s36, 128
    v_mfma_f32_16x16x32_bf16 v[204:207], v[72:75], v[92:95], v[204:207]
    v_mfma_f32_16x16x32_bf16 v[208:211], v[76:79], v[80:83], v[208:211]
    ds_read_b128 v[44:47], v13 offset:6144
    v_mfma_f32_16x16x32_bf16 v[212:215], v[76:79], v[84:87], v[212:215]
    ds_read_b128 v[60:63], v30 offset:6144
    v_mfma_f32_16x16x32_bf16 v[216:219], v[76:79], v[88:91], v[216:219]
    v_xor_b32 v14, 64, v13
    v_xor_b32 v31, 64, v30
    v_mfma_f32_16x16x32_bf16 v[220:223], v[76:79], v[92:95], v[220:223]
    s_setprio 0
    s_mov_b32 s31, s32
    s_mov_b32 s32, s33
    s_add_u32 s33, s33, 49152
    s_cmp_eq_u32 s33, 147456
    s_cselect_b32 s33, 0, s33
    s_waitcnt lgkmcnt(0)
    v_mfma_f32_16x16x32_bf16 v[160:163], v[32:35], v[48:51], v[160:163]
    ds_read_b128 v[64:67], v14 offset:0
    v_mfma_f32_16x16x32_bf16 v[164:167], v[32:35], v[52:55], v[164:167]
    s_add_u32 s35, s31, s39
    s_mov_b32 m0, s35
    s_nop 0
    buffer_load_dwordx4 v25, s[16:19], s37 offen sc1 lds
    v_mfma_f32_16x16x32_bf16 v[168:171], v[32:35], v[56:59], v[168:171]
    ds_read_b128 v[80:83], v31 offset:0
    v_mfma_f32_16x16x32_bf16 v[172:175], v[32:35], v[60:63], v[172:175]
    buffer_load_dwordx4 v26, s[16:19], s37 offen offset:1024 sc1 lds
    v_mfma_f32_16x16x32_bf16 v[176:179], v[36:39], v[48:51], v[176:179]
    ds_read_b128 v[68:71], v14 offset:2048
    v_mfma_f32_16x16x32_bf16 v[180:183], v[36:39], v[52:55], v[180:183]
    ds_read_b128 v[84:87], v31 offset:2048
    v_mfma_f32_16x16x32_bf16 v[184:187], v[36:39], v[56:59], v[184:187]
    buffer_load_dwordx4 v27, s[16:19], s37 offen offset:2048 sc1 lds
    v_mfma_f32_16x16x32_bf16 v[188:191], v[36:39], v[60:63], v[188:191]
    v_mfma_f32_16x16x32_bf16 v[192:195], v[40:43], v[48:51], v[192:195]
    ds_read_b128 v[72:75], v14 offset:4096
    v_mfma_f32_16x16x32_bf16 v[196:199], v[40:43], v[52:55], v[196:199]
    ds_read_b128 v[88:91], v31 offset:4096
    v_mfma_f32_16x16x32_bf16 v[200:203], v[40:43], v[56:59], v[200:203]
    buffer_load_dwordx4 v28, s[16:19], s37 offen offset:3072 sc1 lds
    v_mfma_f32_16x16x32_bf16 v[204:207], v[40:43], v[60:63], v[204:207]
    ds_read_b128 v[76:79], v14 offset:6144
    v_mfma_f32_16x16x32_bf16 v[208:211], v[44:47], v[48:51], v[208:211]
    ds_read_b128 v[92:95], v31 offset:6144
    v_mfma_f32_16x16x32_bf16 v[212:215], v[44:47], v[52:55], v[212:215]
    s_add_u32 s37, s37, 128
    v_mfma_f32_16x16x32_bf16 v[216:219], v[44:47], v[56:59], v[216:219]
    v_add_u32 v13, s33, v12
    v_add_u32 v30, s33, v29
    v_mfma_f32_16x16x32_bf16 v[220:223], v[44:47], v[60:63], v[220:223]
    s_cmp_lg_u32 s28, 1
    s_cbranch_scc1 L_hs54
    s_bitcmp1_b32 s49, 4
    s_cbranch_scc1 L_hs54
    s_lshl_b32 s79, s2, 8
    s_add_u32 s79, s79, 25362432
    v_mov_b32 v6, s79
    s_mov_b32 s90, 300000
L_poll55:
    s_sub_u32 s90, s90, 1
    s_cmp_eq_u32 s90, 0
    s_cbranch_scc1 L_pok56
    buffer_load_dwordx4 v[2:5], v6, s[16:19], 0 offen sc1
    s_waitcnt vmcnt(0)
    v_readfirstlane_b32 s88, v2
    v_readfirstlane_b32 s89, v3
    v_readfirstlane_b32 s91, v4
    s_nop 3
    s_bitcmp1_b32 s0, 0
    s_cselect_b32 s49, s89, s88
    s_and_b32 s88, s49, 16
    s_cmp_eq_u32 s88, 16
    s_cbranch_scc1 L_pok56
    s_sleep 2
    s_branch L_poll55
L_pok56:
L_hs54:
    s_waitcnt vmcnt(6) lgkmcnt(0)
    s_barrier
    s_setprio 1
    v_mfma_f32_16x16x32_bf16 v[160:163], v[64:67], v[80:83], v[160:163]
    ds_read_b128 v[32:35], v13 offset:0
    v_mfma_f32_16x16x32_bf16 v[164:167], v[64:67], v[84:87], v[164:167]
    s_add_u32 s35, s32, s38
    s_mov_b32 m0, s35
    s_nop 0
    buffer_load_dwordx4 v10, s[8:11], s36 offen lds
    v_mfma_f32_16x16x32_bf16 v[168:171], v[64:67], v[88:91], v[168:171]
    ds_read_b128 v[48:51], v30 offset:0
    v_mfma_f32_16x16x32_bf16 v[172:175], v[64:67], v[92:95], v[172:175]
    v_mfma_f32_16x16x32_bf16 v[176:179], v[68:71], v[80:83], v[176:179]
    ds_read_b128 v[36:39], v13 offset:2048
    v_mfma_f32_16x16x32_bf16 v[180:183], v[68:71], v[84:87], v[180:183]
    buffer_load_dwordx4 v11, s[8:11], s36 offen offset:1024 lds
    v_mfma_f32_16x16x32_bf16 v[184:187], v[68:71], v[88:91], v[184:187]
    ds_read_b128 v[52:55], v30 offset:2048
    v_mfma_f32_16x16x32_bf16 v[188:191], v[68:71], v[92:95], v[188:191]
    v_mfma_f32_16x16x32_bf16 v[192:195], v[72:75], v[80:83], v[192:195]
    ds_read_b128 v[40:43], v13 offset:4096
    v_mfma_f32_16x16x32_bf16 v[196:199], v[72:75], v[84:87], v[196:199]
    ds_read_b128 v[56:59], v30 offset:4096
    v_mfma_f32_16x16x32_bf16 v[200:203], v[72:75], v[88:91], v[200:203]
    s_add_u32 s36, s36, 128
    v_mfma_f32_16x16x32_bf16 v[204:207], v[72:75], v[92:95], v[204:207]
    v_mfma_f32_16x16x32_bf16 v[208:211], v[76:79], v[80:83], v[208:211]
    ds_read_b128 v[44:47], v13 offset:6144
    v_mfma_f32_16x16x32_bf16 v[212:215], v[76:79], v[84:87], v[212:215]
    ds_read_b128 v[60:63], v30 offset:6144
    v_mfma_f32_16x16x32_bf16 v[216:219], v[76:79], v[88:91], v[216:219]
    v_xor_b32 v14, 64, v13
    v_xor_b32 v31, 64, v30
    v_mfma_f32_16x16x32_bf16 v[220:223], v[76:79], v[92:95], v[220:223]
    s_setprio 0
    s_mov_b32 s31, s32
    s_mov_b32 s32, s33
    s_add_u32 s33, s33, 49152
    s_cmp_eq_u32 s33, 147456
    s_cselect_b32 s33, 0, s33
    s_waitcnt lgkmcnt(0)
    v_mfma_f32_16x16x32_bf16 v[160:163], v[32:35], v[48:51], v[160:163]
    ds_read_b128 v[64:67], v14 offset:0
    v_mfma_f32_16x16x32_bf16 v[164:167], v[32:35], v[52:55], v[164:167]
    s_add_u32 s35, s31, s39
    s_mov_b32 m0, s35
    s_nop 0
    buffer_load_dwordx4 v25, s[16:19], s37 offen sc1 lds
    v_mfma_f32_16x16x32_bf16 v[168:171], v[32:35], v[56:59], v[168:171]
    ds_read_b128 v[80:83], v31 offset:0
    v_mfma_f32_16x16x32_bf16 v[172:175], v[32:35], v[60:63], v[172:175]
    buffer_load_dwordx4 v26, s[16:19], s37 offen offset:1024 sc1 lds
    v_mfma_f32_16x16x32_bf16 v[176:179], v[36:39], v[48:51], v[176:179]
    ds_read_b128 v[68:71], v14 offset:2048
    v_mfma_f32_16x16x32_bf16 v[180:183], v[36:39], v[52:55], v[180:183]
    ds_read_b128 v[84:87], v31 offset:2048
    v_mfma_f32_16x16x32_bf16 v[184:187], v[36:39], v[56:59], v[184:187]
    buffer_load_dwordx4 v27, s[16:19], s37 offen offset:2048 sc1 lds
    v_mfma_f32_16x16x32_bf16 v[188:191], v[36:39], v[60:63], v[188:191]
    v_mfma_f32_16x16x32_bf16 v[192:195], v[40:43], v[48:51], v[192:195]
    ds_read_b128 v[72:75], v14 offset:4096
    v_mfma_f32_16x16x32_bf16 v[196:199], v[40:43], v[52:55], v[196:199]
    ds_read_b128 v[88:91], v31 offset:4096
    v_mfma_f32_16x16x32_bf16 v[200:203], v[40:43], v[56:59], v[200:203]
    buffer_load_dwordx4 v28, s[16:19], s37 offen offset:3072 sc1 lds
    v_mfma_f32_16x16x32_bf16 v[204:207], v[40:43], v[60:63], v[204:207]
    ds_read_b128 v[76:79], v14 offset:6144
    v_mfma_f32_16x16x32_bf16 v[208:211], v[44:47], v[48:51], v[208:211]
    ds_read_b128 v[92:95], v31 offset:6144
    v_mfma_f32_16x16x32_bf16 v[212:215], v[44:47], v[52:55], v[212:215]
    s_add_u32 s37, s37, 128
    v_mfma_f32_16x16x32_bf16 v[216:219], v[44:47], v[56:59], v[216:219]
    v_add_u32 v13, s33, v12
    v_add_u32 v30, s33, v29
    v_mfma_f32_16x16x32_bf16 v[220:223], v[44:47], v[60:63], v[220:223]
    s_cmp_lg_u32 s28, 1
    s_cbranch_scc1 L_hs57
    s_bitcmp1_b32 s49, 5
    s_cbranch_scc1 L_hs57
    s_lshl_b32 s79, s2, 8
    s_add_u32 s79, s79, 25362432
    v_mov_b32 v6, s79
    s_mov_b32 s90, 300000
L_poll58:
    s_sub_u32 s90, s90, 1
    s_cmp_eq_u32 s90, 0
    s_cbranch_scc1 L_pok59
    buffer_load_dwordx4 v[2:5], v6, s[16:19], 0 offen sc1
    s_waitcnt vmcnt(0)
    v_readfirstlane_b32 s88, v2
    v_readfirstlane_b32 s89, v3
    v_readfirstlane_b32 s91, v4
    s_nop 3
    s_bitcmp1_b32 s0, 0
    s_cselect_b32 s49, s89, s88
    s_and_b32 s88, s49, 32
    s_cmp_eq_u32 s88, 32
    s_cbranch_scc1 L_pok59
    s_sleep 2
    s_branch L_poll58
L_pok59:
L_hs57:
    s_waitcnt vmcnt(6) lgkmcnt(0)
    s_barrier
    s_setprio 1
    v_mfma_f32_16x16x32_bf16 v[160:163], v[64:67], v[80:83], v[160:163]
    ds_read_b128 v[32:35], v13 offset:0
    v_mfma_f32_16x16x32_bf16 v[164:167], v[64:67], v[84:87], v[164:167]
    s_add_u32 s35, s32, s38
    s_mov_b32 m0, s35
    s_nop 0
    buffer_load_dwordx4 v10, s[8:11], s36 offen lds
    v_mfma_f32_16x16x32_bf16 v[168:171], v[64:67], v[88:91], v[168:171]
    ds_read_b128 v[48:51], v30 offset:0
    v_mfma_f32_16x16x32_bf16 v[172:175], v[64:67], v[92:95], v[172:175]
    v_mfma_f32_16x16x32_bf16 v[176:179], v[68:71], v[80:83], v[176:179]
    ds_read_b128 v[36:39], v13 offset:2048
    v_mfma_f32_16x16x32_bf16 v[180:183], v[68:71], v[84:87], v[180:183]
    buffer_load_dwordx4 v11, s[8:11], s36 offen offset:1024 lds
    v_mfma_f32_16x16x32_bf16 v[184:187], v[68:71], v[88:91], v[184:187]
    ds_read_b128 v[52:55], v30 offset:2048
    v_mfma_f32_16x16x32_bf16 v[188:191], v[68:71], v[92:95], v[188:191]
    v_mfma_f32_16x16x32_bf16 v[192:195], v[72:75], v[80:83], v[192:195]
    ds_read_b128 v[40:43], v13 offset:4096
    v_mfma_f32_16x16x32_bf16 v[196:199], v[72:75], v[84:87], v[196:199]
    ds_read_b128 v[56:59], v30 offset:4096
    v_mfma_f32_16x16x32_bf16 v[200:203], v[72:75], v[88:91], v[200:203]
    s_add_u32 s36, s36, 128
    v_mfma_f32_16x16x32_bf16 v[204:207], v[72:75], v[92:95], v[204:207]
    v_mfma_f32_16x16x32_bf16 v[208:211], v[76:79], v[80:83], v[208:211]
    ds_read_b128 v[44:47], v13 offset:6144
    v_mfma_f32_16x16x32_bf16 v[212:215], v[76:79], v[84:87], v[212:215]
    ds_read_b128 v[60:63], v30 offset:6144
    v_mfma_f32_16x16x32_bf16 v[216:219], v[76:79], v[88:91], v[216:219]
    v_xor_b32 v14, 64, v13
    v_xor_b32 v31, 64, v30
    v_mfma_f32_16x16x32_bf16 v[220:223], v[76:79], v[92:95], v[220:223]
    s_setprio 0
    s_mov_b32 s31, s32
    s_mov_b32 s32, s33
    s_add_u32 s33, s33, 49152
    s_cmp_eq_u32 s33, 147456
    s_cselect_b32 s33, 0, s33
    s_waitcnt lgkmcnt(0)
    v_mfma_f32_16x16x32_bf16 v[160:163], v[32:35], v[48:51], v[160:163]
    ds_read_b128 v[64:67], v14 offset:0
    v_mfma_f32_16x16x32_bf16 v[164:167], v[32:35], v[52:55], v[164:167]
    s_add_u32 s35, s31, s39
    s_mov_b32 m0, s35
    s_nop 0
    buffer_load_dwordx4 v25, s[16:19], s37 offen sc1 lds
    v_mfma_f32_16x16x32_bf16 v[168:171], v[32:35], v[56:59], v[168:171]
    ds_read_b128 v[80:83], v31 offset:0
    v_mfma_f32_16x16x32_bf16 v[172:175], v[32:35], v[60:63], v[172:175]
    buffer_load_dwordx4 v26, s[16:19], s37 offen offset:1024 sc1 lds
    v_mfma_f32_16x16x32_bf16 v[176:179], v[36:39], v[48:51], v[176:179]
    ds_read_b128 v[68:71], v14 offset:2048
    v_mfma_f32_16x16x32_bf16 v[180:183], v[36:39], v[52:55], v[180:183]
    ds_read_b128 v[84:87], v31 offset:2048
    v_mfma_f32_16x16x32_bf16 v[184:187], v[36:39], v[56:59], v[184:187]
    buffer_load_dwordx4 v27, s[16:19], s37 offen offset:2048 sc1 lds
    v_mfma_f32_16x16x32_bf16 v[188:191], v[36:39], v[60:63], v[188:191]
    v_mfma_f32_16x16x32_bf16 v[192:195], v[40:43], v[48:51], v[192:195]
    ds_read_b128 v[72:75], v14 offset:4096
    v_mfma_f32_16x16x32_bf16 v[196:199], v[40:43], v[52:55], v[196:199]
    ds_read_b128 v[88:91], v31 offset:4096
    v_mfma_f32_16x16x32_bf16 v[200:203], v[40:43], v[56:59], v[200:203]
    buffer_load_dwordx4 v28, s[16:19], s37 offen offset:3072 sc1 lds
    v_mfma_f32_16x16x32_bf16 v[204:207], v[40:43], v[60:63], v[204:207]
    ds_read_b128 v[76:79], v14 offset:6144
    v_mfma_f32_16x16x32_bf16 v[208:211], v[44:47], v[48:51], v[208:211]
    ds_read_b128 v[92:95], v31 offset:6144
    v_mfma_f32_16x16x32_bf16 v[212:215], v[44:47], v[52:55], v[212:215]
    s_add_u32 s37, s37, 128
    v_mfma_f32_16x16x32_bf16 v[216:219], v[44:47], v[56:59], v[216:219]
    v_add_u32 v13, s33, v12
    v_add_u32 v30, s33, v29
    v_mfma_f32_16x16x32_bf16 v[220:223], v[44:47], v[60:63], v[220:223]
    s_cmp_lg_u32 s28, 1
    s_cbranch_scc1 L_hs60
    s_bitcmp1_b32 s49, 6
    s_cbranch_scc1 L_hs60
    s_lshl_b32 s79, s2, 8
    s_add_u32 s79, s79, 25362432
    v_mov_b32 v6, s79
    s_mov_b32 s90, 300000
L_poll61:
    s_sub_u32 s90, s90, 1
    s_cmp_eq_u32 s90, 0
    s_cbranch_scc1 L_pok62
    buffer_load_dwordx4 v[2:5], v6, s[16:19], 0 offen sc1
    s_waitcnt vmcnt(0)
    v_readfirstlane_b32 s88, v2
    v_readfirstlane_b32 s89, v3
    v_readfirstlane_b32 s91, v4
    s_nop 3
    s_bitcmp1_b32 s0, 0
    s_cselect_b32 s49, s89, s88
    s_and_b32 s88, s49, 64
    s_cmp_eq_u32 s88, 64
    s_cbranch_scc1 L_pok62
    s_sleep 2
    s_branch L_poll61
L_pok62:
L_hs60:
    s_waitcnt vmcnt(6) lgkmcnt(0)
    s_barrier
    s_setprio 1
    v_mfma_f32_16x16x32_bf16 v[160:163], v[64:67], v[80:83], v[160:163]
    ds_read_b128 v[32:35], v13 offset:0
    v_mfma_f32_16x16x32_bf16 v[164:167], v[64:67], v[84:87], v[164:167]
    s_add_u32 s35, s32, s38
    s_mov_b32 m0, s35
    s_nop 0
    buffer_load_dwordx4 v10, s[8:11], s36 offen lds
    v_mfma_f32_16x16x32_bf16 v[168:171], v[64:67], v[88:91], v[168:171]
    ds_read_b128 v[48:51], v30 offset:0
    v_mfma_f32_16x16x32_bf16 v[172:175], v[64:67], v[92:95], v[172:175]
    v_mfma_f32_16x16x32_bf16 v[176:179], v[68:71], v[80:83], v[176:179]
    ds_read_b128 v[36:39], v13 offset:2048
    v_mfma_f32_16x16x32_bf16 v[180:183], v[68:71], v[84:87], v[180:183]
    buffer_load_dwordx4 v11, s[8:11], s36 offen offset:1024 lds
    v_mfma_f32_16x16x32_bf16 v[184:187], v[68:71], v[88:91], v[184:187]
    ds_read_b128 v[52:55], v30 offset:2048
    v_mfma_f32_16x16x32_bf16 v[188:191], v[68:71], v[92:95], v[188:191]
    v_mfma_f32_16x16x32_bf16 v[192:195], v[72:75], v[80:83], v[192:195]
    ds_read_b128 v[40:43], v13 offset:4096
    v_mfma_f32_16x16x32_bf16 v[196:199], v[72:75], v[84:87], v[196:199]
    ds_read_b128 v[56:59], v30 offset:4096
    v_mfma_f32_16x16x32_bf16 v[200:203], v[72:75], v[88:91], v[200:203]
    s_add_u32 s36, s36, 128
    v_mfma_f32_16x16x32_bf16 v[204:207], v[72:75], v[92:95], v[204:207]
    v_mfma_f32_16x16x32_bf16 v[208:211], v[76:79], v[80:83], v[208:211]
    ds_read_b128 v[44:47], v13 offset:6144
    v_mfma_f32_16x16x32_bf16 v[212:215], v[76:79], v[84:87], v[212:215]
    ds_read_b128 v[60:63], v30 offset:6144
    v_mfma_f32_16x16x32_bf16 v[216:219], v[76:79], v[88:91], v[216:219]
    v_xor_b32 v14, 64, v13
    v_xor_b32 v31, 64, v30
    v_mfma_f32_16x16x32_bf16 v[220:223], v[76:79], v[92:95], v[220:223]
    s_setprio 0
    s_mov_b32 s31, s32
    s_mov_b32 s32, s33
    s_add_u32 s33, s33, 49152
    s_cmp_eq_u32 s33, 147456
    s_cselect_b32 s33, 0, s33
    s_waitcnt lgkmcnt(0)
    v_mfma_f32_16x16x32_bf16 v[160:163], v[32:35], v[48:51], v[160:163]
    ds_read_b128 v[64:67], v14 offset:0
    v_mfma_f32_16x16x32_bf16 v[164:167], v[32:35], v[52:55], v[164:167]
    s_add_u32 s35, s31, s39
    s_mov_b32 m0, s35
    s_nop 0
    buffer_load_dwordx4 v25, s[16:19], s37 offen sc1 lds
    v_mfma_f32_16x16x32_bf16 v[168:171], v[32:35], v[56:59], v[168:171]
    ds_read_b128 v[80:83], v31 offset:0
    v_mfma_f32_16x16x32_bf16 v[172:175], v[32:35], v[60:63], v[172:175]
    buffer_load_dwordx4 v26, s[16:19], s37 offen offset:1024 sc1 lds
    v_mfma_f32_16x16x32_bf16 v[176:179], v[36:39], v[48:51], v[176:179]
    ds_read_b128 v[68:71], v14 offset:2048
    v_mfma_f32_16x16x32_bf16 v[180:183], v[36:39], v[52:55], v[180:183]
    ds_read_b128 v[84:87], v31 offset:2048
    v_mfma_f32_16x16x32_bf16 v[184:187], v[36:39], v[56:59], v[184:187]
    buffer_load_dwordx4 v27, s[16:19], s37 offen offset:2048 sc1 lds
    v_mfma_f32_16x16x32_bf16 v[188:191], v[36:39], v[60:63], v[188:191]
    v_mfma_f32_16x16x32_bf16 v[192:195], v[40:43], v[48:51], v[192:195]
    ds_read_b128 v[72:75], v14 offset:4096
    v_mfma_f32_16x16x32_bf16 v[196:199], v[40:43], v[52:55], v[196:199]
    ds_read_b128 v[88:91], v31 offset:4096
    v_mfma_f32_16x16x32_bf16 v[200:203], v[40:43], v[56:59], v[200:203]
    buffer_load_dwordx4 v28, s[16:19], s37 offen offset:3072 sc1 lds
    v_mfma_f32_16x16x32_bf16 v[204:207], v[40:43], v[60:63], v[204:207]
    ds_read_b128 v[76:79], v14 offset:6144
    v_mfma_f32_16x16x32_bf16 v[208:211], v[44:47], v[48:51], v[208:211]
    ds_read_b128 v[92:95], v31 offset:6144
    v_mfma_f32_16x16x32_bf16 v[212:215], v[44:47], v[52:55], v[212:215]
    s_add_u32 s37, s37, 128
    v_mfma_f32_16x16x32_bf16 v[216:219], v[44:47], v[56:59], v[216:219]
    v_add_u32 v13, s33, v12
    v_add_u32 v30, s33, v29
    v_mfma_f32_16x16x32_bf16 v[220:223], v[44:47], v[60:63], v[220:223]
    s_cmp_lg_u32 s28, 1
    s_cbranch_scc1 L_hs63
    s_bitcmp1_b32 s49, 7
    s_cbranch_scc1 L_hs63
    s_lshl_b32 s79, s2, 8
    s_add_u32 s79, s79, 25362432
    v_mov_b32 v6, s79
    s_mov_b32 s90, 300000
L_poll64:
    s_sub_u32 s90, s90, 1
    s_cmp_eq_u32 s90, 0
    s_cbranch_scc1 L_pok65
    buffer_load_dwordx4 v[2:5], v6, s[16:19], 0 offen sc1
    s_waitcnt vmcnt(0)
    v_readfirstlane_b32 s88, v2
    v_readfirstlane_b32 s89, v3
    v_readfirstlane_b32 s91, v4
    s_nop 3
    s_bitcmp1_b32 s0, 0
    s_cselect_b32 s49, s89, s88
    s_and_b32 s88, s49, 128
    s_cmp_eq_u32 s88, 128
    s_cbranch_scc1 L_pok65
    s_sleep 2
    s_branch L_poll64
L_pok65:
L_hs63:
    s_waitcnt vmcnt(6) lgkmcnt(0)
    s_barrier
    s_setprio 1
    v_mfma_f32_16x16x32_bf16 v[160:163], v[64:67], v[80:83], v[160:163]
    ds_read_b128 v[32:35], v13 offset:0
    v_mfma_f32_16x16x32_bf16 v[164:167], v[64:67], v[84:87], v[164:167]
    s_add_u32 s35, s32, s38
    s_mov_b32 m0, s35
    s_nop 0
    buffer_load_dwordx4 v10, s[8:11], s36 offen lds
    v_mfma_f32_16x16x32_bf16 v[168:171], v[64:67], v[88:91], v[168:171]
    ds_read_b128 v[48:51], v30 offset:0
    v_mfma_f32_16x16x32_bf16 v[172:175], v[64:67], v[92:95], v[172:175]
    v_mfma_f32_16x16x32_bf16 v[176:179], v[68:71], v[80:83], v[176:179]
    ds_read_b128 v[36:39], v13 offset:2048
    v_mfma_f32_16x16x32_bf16 v[180:183], v[68:71], v[84:87], v[180:183]
    buffer_load_dwordx4 v11, s[8:11], s36 offen offset:1024 lds
    v_mfma_f32_16x16x32_bf16 v[184:187], v[68:71], v[88:91], v[184:187]
    ds_read_b128 v[52:55], v30 offset:2048
    v_mfma_f32_16x16x32_bf16 v[188:191], v[68:71], v[92:95], v[188:191]
    v_mfma_f32_16x16x32_bf16 v[192:195], v[72:75], v[80:83], v[192:195]
    ds_read_b128 v[40:43], v13 offset:4096
    v_mfma_f32_16x16x32_bf16 v[196:199], v[72:75], v[84:87], v[196:199]
    ds_read_b128 v[56:59], v30 offset:4096
    v_mfma_f32_16x16x32_bf16 v[200:203], v[72:75], v[88:91], v[200:203]
    s_add_u32 s36, s36, 128
    v_mfma_f32_16x16x32_bf16 v[204:207], v[72:75], v[92:95], v[204:207]
    v_mfma_f32_16x16x32_bf16 v[208:211], v[76:79], v[80:83], v[208:211]
    ds_read_b128 v[44:47], v13 offset:6144
    v_mfma_f32_16x16x32_bf16 v[212:215], v[76:79], v[84:87], v[212:215]
    ds_read_b128 v[60:63], v30 offset:6144
    v_mfma_f32_16x16x32_bf16 v[216:219], v[76:79], v[88:91], v[216:219]
    v_xor_b32 v14, 64, v13
    v_xor_b32 v31, 64, v30
    v_mfma_f32_16x16x32_bf16 v[220:223], v[76:79], v[92:95], v[220:223]
    s_setprio 0
    s_mov_b32 s31, s32
    s_mov_b32 s32, s33
    s_add_u32 s33, s33, 49152
    s_cmp_eq_u32 s33, 147456
    s_cselect_b32 s33, 0, s33
    s_waitcnt lgkmcnt(0)
    v_mfma_f32_16x16x32_bf16 v[160:163], v[32:35], v[48:51], v[160:163]
    ds_read_b128 v[64:67], v14 offset:0
    v_mfma_f32_16x16x32_bf16 v[164:167], v[32:35], v[52:55], v[164:167]
    s_add_u32 s35, s31, s39
    s_mov_b32 m0, s35
    s_nop 0
    buffer_load_dwordx4 v25, s[16:19], s37 offen sc1 lds
    v_mfma_f32_16x16x32_bf16 v[168:171], v[32:35], v[56:59], v[168:171]
    ds_read_b128 v[80:83], v31 offset:0
    v_mfma_f32_16x16x32_bf16 v[172:175], v[32:35], v[60:63], v[172:175]
    buffer_load_dwordx4 v26, s[16:19], s37 offen offset:1024 sc1 lds
    v_mfma_f32_16x16x32_bf16 v[176:179], v[36:39], v[48:51], v[176:179]
    ds_read_b128 v[68:71], v14 offset:2048
    v_mfma_f32_16x16x32_bf16 v[180:183], v[36:39], v[52:55], v[180:183]
    ds_read_b128 v[84:87], v31 offset:2048
    v_mfma_f32_16x16x32_bf16 v[184:187], v[36:39], v[56:59], v[184:187]
    buffer_load_dwordx4 v27, s[16:19], s37 offen offset:2048 sc1 lds
    v_mfma_f32_16x16x32_bf16 v[188:191], v[36:39], v[60:63], v[188:191]
    v_mfma_f32_16x16x32_bf16 v[192:195], v[40:43], v[48:51], v[192:195]
    ds_read_b128 v[72:75], v14 offset:4096
    v_mfma_f32_16x16x32_bf16 v[196:199], v[40:43], v[52:55], v[196:199]
    ds_read_b128 v[88:91], v31 offset:4096
    v_mfma_f32_16x16x32_bf16 v[200:203], v[40:43], v[56:59], v[200:203]
    buffer_load_dwordx4 v28, s[16:19], s37 offen offset:3072 sc1 lds
    v_mfma_f32_16x16x32_bf16 v[204:207], v[40:43], v[60:63], v[204:207]
    ds_read_b128 v[76:79], v14 offset:6144
    v_mfma_f32_16x16x32_bf16 v[208:211], v[44:47], v[48:51], v[208:211]
    ds_read_b128 v[92:95], v31 offset:6144
    v_mfma_f32_16x16x32_bf16 v[212:215], v[44:47], v[52:55], v[212:215]
    s_add_u32 s37, s37, 128
    v_mfma_f32_16x16x32_bf16 v[216:219], v[44:47], v[56:59], v[216:219]
    v_add_u32 v13, s33, v12
    v_add_u32 v30, s33, v29
    v_mfma_f32_16x16x32_bf16 v[220:223], v[44:47], v[60:63], v[220:223]
    s_cmp_lg_u32 s28, 1
    s_cbranch_scc1 L_hk66
    s_lshl_b32 s79, s2, 8
    s_add_u32 s79, s79, 25362432
    v_mov_b32 v6, s79
    s_mov_b32 s90, 300000
L_poll67:
    s_sub_u32 s90, s90, 1
    s_cmp_eq_u32 s90, 0
    s_cbranch_scc1 L_pok68
    buffer_load_dwordx4 v[2:5], v6, s[16:19], 0 offen sc1
    s_waitcnt vmcnt(0)
    v_readfirstlane_b32 s88, v2
    v_readfirstlane_b32 s89, v3
    v_readfirstlane_b32 s91, v4
    s_nop 3
    s_add_u32 s88, s88, s89
    s_add_u32 s88, s88, s91
    s_cmp_eq_u32 s88, 526
    s_cbranch_scc1 L_pok68
    s_sleep 2
    s_branch L_poll67
L_pok68:
L_hk66:
    s_waitcnt vmcnt(6) lgkmcnt(0)
    s_barrier
    s_setprio 1
    v_mfma_f32_16x16x32_bf16 v[160:163], v[64:67], v[80:83], v[160:163]
    ds_read_b128 v[32:35], v13 offset:0
    v_mfma_f32_16x16x32_bf16 v[164:167], v[64:67], v[84:87], v[164:167]
    s_add_u32 s35, s32, s83
    s_mov_b32 m0, s35
    s_nop 0
    buffer_load_dwordx4 v15, s[24:27], s84 offen lds
    v_mfma_f32_16x16x32_bf16 v[168:171], v[64:67], v[88:91], v[168:171]
    ds_read_b128 v[48:51], v30 offset:0
    v_mfma_f32_16x16x32_bf16 v[172:175], v[64:67], v[92:95], v[172:175]
    v_mfma_f32_16x16x32_bf16 v[176:179], v[68:71], v[80:83], v[176:179]
    ds_read_b128 v[36:39], v13 offset:2048
    v_mfma_f32_16x16x32_bf16 v[180:183], v[68:71], v[84:87], v[180:183]
    buffer_load_dwordx4 v16, s[24:27], s84 offen offset:1024 lds
    v_mfma_f32_16x16x32_bf16 v[184:187], v[68:71], v[88:91], v[184:187]
    ds_read_b128 v[52:55], v30 offset:2048
    v_mfma_f32_16x16x32_bf16 v[188:191], v[68:71], v[92:95], v[188:191]
    v_mfma_f32_16x16x32_bf16 v[192:195], v[72:75], v[80:83], v[192:195]
    ds_read_b128 v[40:43], v13 offset:4096
    v_mfma_f32_16x16x32_bf16 v[196:199], v[72:75], v[84:87], v[196:199]
    ds_read_b128 v[56:59], v30 offset:4096
    v_mfma_f32_16x16x32_bf16 v[200:203], v[72:75], v[88:91], v[200:203]
    s_add_u32 s84, s84, 131072
    v_mfma_f32_16x16x32_bf16 v[204:207], v[72:75], v[92:95], v[204:207]
    v_mfma_f32_16x16x32_bf16 v[208:211], v[76:79], v[80:83], v[208:211]
    ds_read_b128 v[44:47], v13 offset:6144
    v_mfma_f32_16x16x32_bf16 v[212:215], v[76:79], v[84:87], v[212:215]
    ds_read_b128 v[60:63], v30 offset:6144
    v_mfma_f32_16x16x32_bf16 v[216:219], v[76:79], v[88:91], v[216:219]
    v_xor_b32 v14, 64, v13
    v_xor_b32 v31, 64, v30
    v_mfma_f32_16x16x32_bf16 v[220:223], v[76:79], v[92:95], v[220:223]
    s_setprio 0
    s_mov_b32 s31, s32
    s_mov_b32 s32, s33
    s_add_u32 s33, s33, 49152
    s_cmp_eq_u32 s33, 147456
    s_cselect_b32 s33, 0, s33
    s_waitcnt lgkmcnt(0)
    v_mfma_f32_16x16x32_bf16 v[160:163], v[32:35], v[48:51], v[160:163]
    ds_read_b128 v[64:67], v14 offset:0
    v_mfma_f32_16x16x32_bf16 v[164:167], v[32:35], v[52:55], v[164:167]
    s_add_u32 s35, s31, s39
    s_mov_b32 m0, s35
    s_nop 0
    buffer_load_dwordx4 v25, s[16:19], s3 offen sc1 lds
    v_mfma_f32_16x16x32_bf16 v[168:171], v[32:35], v[56:59], v[168:171]
    ds_read_b128 v[80:83], v31 offset:0
    v_mfma_f32_16x16x32_bf16 v[172:175], v[32:35], v[60:63], v[172:175]
    buffer_load_dwordx4 v26, s[16:19], s3 offen offset:1024 sc1 lds
    v_mfma_f32_16x16x32_bf16 v[176:179], v[36:39], v[48:51], v[176:179]
    ds_read_b128 v[68:71], v14 offset:2048
    v_mfma_f32_16x16x32_bf16 v[180:183], v[36:39], v[52:55], v[180:183]
    ds_read_b128 v[84:87], v31 offset:2048
    v_mfma_f32_16x16x32_bf16 v[184:187], v[36:39], v[56:59], v[184:187]
    buffer_load_dwordx4 v27, s[16:19], s3 offen offset:2048 sc1 lds
    v_mfma_f32_16x16x32_bf16 v[188:191], v[36:39], v[60:63], v[188:191]
    v_mfma_f32_16x16x32_bf16 v[192:195], v[40:43], v[48:51], v[192:195]
    ds_read_b128 v[72:75], v14 offset:4096
    v_mfma_f32_16x16x32_bf16 v[196:199], v[40:43], v[52:55], v[196:199]
    ds_read_b128 v[88:91], v31 offset:4096
    v_mfma_f32_16x16x32_bf16 v[200:203], v[40:43], v[56:59], v[200:203]
    buffer_load_dwordx4 v28, s[16:19], s3 offen offset:3072 sc1 lds
    v_mfma_f32_16x16x32_bf16 v[204:207], v[40:43], v[60:63], v[204:207]
    ds_read_b128 v[76:79], v14 offset:6144
    v_mfma_f32_16x16x32_bf16 v[208:211], v[44:47], v[48:51], v[208:211]
    ds_read_b128 v[92:95], v31 offset:6144
    v_mfma_f32_16x16x32_bf16 v[212:215], v[44:47], v[52:55], v[212:215]
    s_add_u32 s3, s3, 128
    v_mfma_f32_16x16x32_bf16 v[216:219], v[44:47], v[56:59], v[216:219]
    v_add_u32 v13, s33, v12
    v_add_u32 v30, s33, v29
    v_mfma_f32_16x16x32_bf16 v[220:223], v[44:47], v[60:63], v[220:223]
    s_waitcnt vmcnt(6) lgkmcnt(0)
    s_barrier
    s_setprio 1
    v_mfma_f32_16x16x32_bf16 v[160:163], v[64:67], v[80:83], v[160:163]
    ds_read_b128 v[32:35], v13 offset:0
    v_mfma_f32_16x16x32_bf16 v[164:167], v[64:67], v[84:87], v[164:167]
    s_add_u32 s35, s32, s83
    s_mov_b32 m0, s35
    s_nop 0
    buffer_load_dwordx4 v15, s[24:27], s84 offen lds
    v_mfma_f32_16x16x32_bf16 v[168:171], v[64:67], v[88:91], v[168:171]
    ds_read_b128 v[48:51], v30 offset:0
    v_mfma_f32_16x16x32_bf16 v[172:175], v[64:67], v[92:95], v[172:175]
    v_mfma_f32_16x16x32_bf16 v[176:179], v[68:71], v[80:83], v[176:179]
    ds_read_b128 v[36:39], v13 offset:2048
    v_mfma_f32_16x16x32_bf16 v[180:183], v[68:71], v[84:87], v[180:183]
    buffer_load_dwordx4 v16, s[24:27], s84 offen offset:1024 lds
    v_mfma_f32_16x16x32_bf16 v[184:187], v[68:71], v[88:91], v[184:187]
    ds_read_b128 v[52:55], v30 offset:2048
    v_mfma_f32_16x16x32_bf16 v[188:191], v[68:71], v[92:95], v[188:191]
    v_mfma_f32_16x16x32_bf16 v[192:195], v[72:75], v[80:83], v[192:195]
    ds_read_b128 v[40:43], v13 offset:4096
    v_mfma_f32_16x16x32_bf16 v[196:199], v[72:75], v[84:87], v[196:199]
    ds_read_b128 v[56:59], v30 offset:4096
    v_mfma_f32_16x16x32_bf16 v[200:203], v[72:75], v[88:91], v[200:203]
    s_add_u32 s84, s84, 131072
    v_mfma_f32_16x16x32_bf16 v[204:207], v[72:75], v[92:95], v[204:207]
    v_mfma_f32_16x16x32_bf16 v[208:211], v[76:79], v[80:83], v[208:211]
    ds_read_b128 v[44:47], v13 offset:6144
    v_mfma_f32_16x16x32_bf16 v[212:215], v[76:79], v[84:87], v[212:215]
    ds_read_b128 v[60:63], v30 offset:6144
    v_mfma_f32_16x16x32_bf16 v[216:219], v[76:79], v[88:91], v[216:219]
    v_xor_b32 v14, 64, v13
    v_xor_b32 v31, 64, v30
    v_mfma_f32_16x16x32_bf16 v[220:223], v[76:79], v[92:95], v[220:223]
    s_setprio 0
    s_mov_b32 s31, s32
    s_mov_b32 s32, s33
    s_add_u32 s33, s33, 49152
    s_cmp_eq_u32 s33, 147456
    s_cselect_b32 s33, 0, s33
    s_waitcnt lgkmcnt(0)
    v_mfma_f32_16x16x32_bf16 v[160:163], v[32:35], v[48:51], v[160:163]
    ds_read_b128 v[64:67], v14 offset:0
    v_mfma_f32_16x16x32_bf16 v[164:167], v[32:35], v[52:55], v[164:167]
    s_add_u32 s35, s31, s39
    s_mov_b32 m0, s35
    s_nop 0
    buffer_load_dwordx4 v25, s[16:19], s3 offen sc1 lds
    v_mfma_f32_16x16x32_bf16 v[168:171], v[32:35], v[56:59], v[168:171]
    ds_read_b128 v[80:83], v31 offset:0
    v_mfma_f32_16x16x32_bf16 v[172:175], v[32:35], v[60:63], v[172:175]
    buffer_load_dwordx4 v26, s[16:19], s3 offen offset:1024 sc1 lds
    v_mfma_f32_16x16x32_bf16 v[176:179], v[36:39], v[48:51], v[176:179]
    ds_read_b128 v[68:71], v14 offset:2048
    v_mfma_f32_16x16x32_bf16 v[180:183], v[36:39], v[52:55], v[180:183]
    ds_read_b128 v[84:87], v31 offset:2048
    v_mfma_f32_16x16x32_bf16 v[184:187], v[36:39], v[56:59], v[184:187]
    buffer_load_dwordx4 v27, s[16:19], s3 offen offset:2048 sc1 lds
    v_mfma_f32_16x16x32_bf16 v[188:191], v[36:39], v[60:63], v[188:191]
    v_mfma_f32_16x16x32_bf16 v[192:195], v[40:43], v[48:51], v[192:195]
    ds_read_b128 v[72:75], v14 offset:4096
    v_mfma_f32_16x16x32_bf16 v[196:199], v[40:43], v[52:55], v[196:199]
    ds_read_b128 v[88:91], v31 offset:4096
    v_mfma_f32_16x16x32_bf16 v[200:203], v[40:43], v[56:59], v[200:203]
    buffer_load_dwordx4 v28, s[16:19], s3 offen offset:3072 sc1 lds
    v_mfma_f32_16x16x32_bf16 v[204:207], v[40:43], v[60:63], v[204:207]
    ds_read_b128 v[76:79], v14 offset:6144
    v_mfma_f32_16x16x32_bf16 v[208:211], v[44:47], v[48:51], v[208:211]
    ds_read_b128 v[92:95], v31 offset:6144
    v_mfma_f32_16x16x32_bf16 v[212:215], v[44:47], v[52:55], v[212:215]
    s_add_u32 s3, s3, 128
    v_mfma_f32_16x16x32_bf16 v[216:219], v[44:47], v[56:59], v[216:219]
    v_add_u32 v21, s33, v17
    v_add_u32 v22, s33, v18
    v_add_u32 v23, s33, v19
    v_add_u32 v24, s33, v20
    v_add_u32 v30, s33, v29
    v_mfma_f32_16x16x32_bf16 v[220:223], v[44:47], v[60:63], v[220:223]
    s_waitcnt vmcnt(6) lgkmcnt(0)
    s_barrier
    s_setprio 1
    v_mfma_f32_16x16x32_bf16 v[160:163], v[64:67], v[80:83], v[160:163]
    ds_read_b64_tr_b16 v[32:33], v21 offset:0
    v_mfma_f32_16x16x32_bf16 v[164:167], v[64:67], v[84:87], v[164:167]
    s_add_u32 s35, s32, s83
    s_mov_b32 m0, s35
    s_nop 0
    buffer_load_dwordx4 v15, s[24:27], s84 offen lds
    v_mfma_f32_16x16x32_bf16 v[168:171], v[64:67], v[88:91], v[168:171]
    ds_read_b128 v[48:51], v30 offset:0
    v_mfma_f32_16x16x32_bf16 v[172:175], v[64:67], v[92:95], v[172:175]
    ds_read_b64_tr_b16 v[34:35], v21 offset:1024
    v_mfma_f32_16x16x32_bf16 v[176:179], v[68:71], v[80:83], v[176:179]
    ds_read_b64_tr_b16 v[36:37], v22 offset:32
    v_mfma_f32_16x16x32_bf16 v[180:183], v[68:71], v[84:87], v[180:183]
    ds_read_b128 v[52:55], v30 offset:2048
    v_mfma_f32_16x16x32_bf16 v[184:187], v[68:71], v[88:91], v[184:187]
    buffer_load_dwordx4 v16, s[24:27], s84 offen offset:1024 lds
    v_mfma_f32_16x16x32_bf16 v[188:191], v[68:71], v[92:95], v[188:191]
    ds_read_b64_tr_b16 v[38:39], v22 offset:1056
    v_mfma_f32_16x16x32_bf16 v[192:195], v[72:75], v[80:83], v[192:195]
    ds_read_b64_tr_b16 v[40:41], v23 offset:64
    v_mfma_f32_16x16x32_bf16 v[196:199], v[72:75], v[84:87], v[196:199]
    ds_read_b128 v[56:59], v30 offset:4096
    v_mfma_f32_16x16x32_bf16 v[200:203], v[72:75], v[88:91], v[200:203]
    ds_read_b64_tr_b16 v[42:43], v23 offset:1088
    v_mfma_f32_16x16x32_bf16 v[204:207], v[72:75], v[92:95], v[204:207]
    s_add_u32 s84, s84, 131072
    v_mfma_f32_16x16x32_bf16 v[208:211], v[76:79], v[80:83], v[208:211]
    ds_read_b64_tr_b16 v[44:45], v24 offset:96
    v_mfma_f32_16x16x32_bf16 v[212:215], v[76:79], v[84:87], v[212:215]
    ds_read_b128 v[60:63], v30 offset:6144
    v_mfma_f32_16x16x32_bf16 v[216:219], v[76:79], v[88:91], v[216:219]
    ds_read_b64_tr_b16 v[46:47], v24 offset:1120
    v_mfma_f32_16x16x32_bf16 v[220:223], v[76:79], v[92:95], v[220:223]
    v_xor_b32 v31, 64, v30
    s_setprio 0
    s_mov_b32 s31, s32
    s_mov_b32 s32, s33
    s_add_u32 s33, s33, 49152
    s_cmp_eq_u32 s33, 147456
    s_cselect_b32 s33, 0, s33
    s_waitcnt lgkmcnt(0)
    v_mfma_f32_16x16x32_bf16 v[96:99], v[32:35], v[48:51], 0
    ds_read_b64_tr_b16 v[64:65], v21 offset:8192
    s_add_u32 s35, s31, s39
    s_mov_b32 m0, s35
    s_nop 0
    buffer_load_dwordx4 v25, s[16:19], s3 offen sc1 lds
    v_mfma_f32_16x16x32_bf16 v[100:103], v[32:35], v[52:55], 0
    ds_read_b128 v[80:83], v31 offset:0
    v_mfma_f32_16x16x32_bf16 v[104:107], v[32:35], v[56:59], 0
    ds_read_b64_tr_b16 v[66:67], v21 offset:9216
    v_mfma_f32_16x16x32_bf16 v[108:111], v[32:35], v[60:63], 0
    buffer_load_dwordx4 v26, s[16:19], s3 offen offset:1024 sc1 lds
    v_mfma_f32_16x16x32_bf16 v[112:115], v[36:39], v[48:51], 0
    ds_read_b64_tr_b16 v[68:69], v22 offset:8224
    v_mfma_f32_16x16x32_bf16 v[116:119], v[36:39], v[52:55], 0
    ds_read_b128 v[84:87], v31 offset:2048
    v_mfma_f32_16x16x32_bf16 v[120:123], v[36:39], v[56:59], 0
    ds_read_b64_tr_b16 v[70:71], v22 offset:9248
    v_mfma_f32_16x16x32_bf16 v[124:127], v[36:39], v[60:63], 0
    buffer_load_dwordx4 v27, s[16:19], s3 offen offset:2048 sc1 lds
    v_mfma_f32_16x16x32_bf16 v[128:131], v[40:43], v[48:51], 0
    ds_read_b64_tr_b16 v[72:73], v23 offset:8256
    ds_read_b128 v[88:91], v31 offset:4096
    v_mfma_f32_16x16x32_bf16 v[132:135], v[40:43], v[52:55], 0
    buffer_load_dwordx4 v28, s[16:19], s3 offen offset:3072 sc1 lds
    v_mfma_f32_16x16x32_bf16 v[136:139], v[40:43], v[56:59], 0
    ds_read_b64_tr_b16 v[74:75], v23 offset:9280
    v_mfma_f32_16x16x32_bf16 v[140:143], v[40:43], v[60:63], 0
    ds_read_b64_tr_b16 v[76:77], v24 offset:8288
    v_mfma_f32_16x16x32_bf16 v[144:147], v[44:47], v[48:51], 0
    ds_read_b128 v[92:95], v31 offset:6144
    v_mfma_f32_16x16x32_bf16 v[148:151], v[44:47], v[52:55], 0
    s_add_u32 s3, s3, 128
    v_mfma_f32_16x16x32_bf16 v[152:155], v[44:47], v[56:59], 0
    ds_read_b64_tr_b16 v[78:79], v24 offset:9312
    v_mfma_f32_16x16x32_bf16 v[156:159], v[44:47], v[60:63], 0
    v_add_u32 v21, s33, v17
    v_add_u32 v22, s33, v18
    v_add_u32 v23, s33, v19
    v_add_u32 v24, s33, v20
    v_add_u32 v30, s33, v29
    s_waitcnt vmcnt(6) lgkmcnt(0)
    s_barrier
    s_setprio 1
    v_mfma_f32_16x16x32_bf16 v[96:99], v[64:67], v[80:83], v[96:99]
    ds_read_b64_tr_b16 v[32:33], v21 offset:0
    v_mfma_f32_16x16x32_bf16 v[100:103], v[64:67], v[84:87], v[100:103]
    s_add_u32 s35, s32, s83
    s_mov_b32 m0, s35
    s_nop 0
    buffer_load_dwordx4 v15, s[24:27], s84 offen lds
    v_mfma_f32_16x16x32_bf16 v[104:107], v[64:67], v[88:91], v[104:107]
    ds_read_b128 v[48:51], v30 offset:0
    v_mfma_f32_16x16x32_bf16 v[108:111], v[64:67], v[92:95], v[108:111]
    ds_read_b64_tr_b16 v[34:35], v21 offset:1024
    v_mfma_f32_16x16x32_bf16 v[112:115], v[68:71], v[80:83], v[112:115]
    ds_read_b64_tr_b16 v[36:37], v22 offset:32
    v_mfma_f32_16x16x32_bf16 v[116:119], v[68:71], v[84:87], v[116:119]
    ds_read_b128 v[52:55], v30 offset:2048
    v_mfma_f32_16x16x32_bf16 v[120:123], v[68:71], v[88:91], v[120:123]
    buffer_load_dwordx4 v16, s[24:27], s84 offen offset:1024 lds
    v_mfma_f32_16x16x32_bf16 v[124:127], v[68:71], v[92:95], v[124:127]
    ds_read_b64_tr_b16 v[38:39], v22 offset:1056
    v_mfma_f32_16x16x32_bf16 v[128:131], v[72:75], v[80:83], v[128:131]
    ds_read_b64_tr_b16 v[40:41], v23 offset:64
    v_mfma_f32_16x16x32_bf16 v[132:135], v[72:75], v[84:87], v[132:135]
    ds_read_b128 v[56:59], v30 offset:4096
    v_mfma_f32_16x16x32_bf16 v[136:139], v[72:75], v[88:91], v[136:139]
    ds_read_b64_tr_b16 v[42:43], v23 offset:1088
    v_mfma_f32_16x16x32_bf16 v[140:143], v[72:75], v[92:95], v[140:143]
    s_add_u32 s84, s84, 131072
    v_mfma_f32_16x16x32_bf16 v[144:147], v[76:79], v[80:83], v[144:147]
    ds_read_b64_tr_b16 v[44:45], v24 offset:96
    v_mfma_f32_16x16x32_bf16 v[148:151], v[76:79], v[84:87], v[148:151]
    ds_read_b128 v[60:63], v30 offset:6144
    v_mfma_f32_16x16x32_bf16 v[152:155], v[76:79], v[88:91], v[152:155]
    ds_read_b64_tr_b16 v[46:47], v24 offset:1120
    v_mfma_f32_16x16x32_bf16 v[156:159], v[76:79], v[92:95], v[156:159]
    v_xor_b32 v31, 64, v30
    s_setprio 0
    s_mov_b32 s34, 12
L_gl69:
    s_mov_b32 s31, s32
    s_mov_b32 s32, s33
    s_add_u32 s33, s33, 49152
    s_cmp_eq_u32 s33, 147456
    s_cselect_b32 s33, 0, s33
    s_waitcnt lgkmcnt(0)
    v_mfma_f32_16x16x32_bf16 v[96:99], v[32:35], v[48:51], v[96:99]
    ds_read_b64_tr_b16 v[64:65], v21 offset:8192
    s_add_u32 s35, s31, s39
    s_mov_b32 m0, s35
    s_nop 0
    buffer_load_dwordx4 v25, s[16:19], s3 offen sc1 lds
    v_mfma_f32_16x16x32_bf16 v[100:103], v[32:35], v[52:55], v[100:103]
    ds_read_b128 v[80:83], v31 offset:0
    v_mfma_f32_16x16x32_bf16 v[104:107], v[32:35], v[56:59], v[104:107]
    ds_read_b64_tr_b16 v[66:67], v21 offset:9216
    v_mfma_f32_16x16x32_bf16 v[108:111], v[32:35], v[60:63], v[108:111]
    buffer_load_dwordx4 v26, s[16:19], s3 offen offset:1024 sc1 lds
    v_mfma_f32_16x16x32_bf16 v[112:115], v[36:39], v[48:51], v[112:115]
    ds_read_b64_tr_b16 v[68:69], v22 offset:8224
    v_mfma_f32_16x16x32_bf16 v[116:119], v[36:39], v[52:55], v[116:119]
    ds_read_b128 v[84:87], v31 offset:2048
    v_mfma_f32_16x16x32_bf16 v[120:123], v[36:39], v[56:59], v[120:123]
    ds_read_b64_tr_b16 v[70:71], v22 offset:9248
    v_mfma_f32_16x16x32_bf16 v[124:127], v[36:39], v[60:63], v[124:127]
    buffer_load_dwordx4 v27, s[16:19], s3 offen offset:2048 sc1 lds
    v_mfma_f32_16x16x32_bf16 v[128:131], v[40:43], v[48:51], v[128:131]
    ds_read_b64_tr_b16 v[72:73], v23 offset:8256
    ds_read_b128 v[88:91], v31 offset:4096
    v_mfma_f32_16x16x32_bf16 v[132:135], v[40:43], v[52:55], v[132:135]
    buffer_load_dwordx4 v28, s[16:19], s3 offen offset:3072 sc1 lds
    v_mfma_f32_16x16x32_bf16 v[136:139], v[40:43], v[56:59], v[136:139]
    ds_read_b64_tr_b16 v[74:75], v23 offset:9280
    v_mfma_f32_16x16x32_bf16 v[140:143], v[40:43], v[60:63], v[140:143]
    ds_read_b64_tr_b16 v[76:77], v24 offset:8288
    v_mfma_f32_16x16x32_bf16 v[144:147], v[44:47], v[48:51], v[144:147]
    ds_read_b128 v[92:95], v31 offset:6144
    v_mfma_f32_16x16x32_bf16 v[148:151], v[44:47], v[52:55], v[148:151]
    s_add_u32 s3, s3, 128
    v_mfma_f32_16x16x32_bf16 v[152:155], v[44:47], v[56:59], v[152:155]
    ds_read_b64_tr_b16 v[78:79], v24 offset:9312
    v_mfma_f32_16x16x32_bf16 v[156:159], v[44:47], v[60:63], v[156:159]
    v_add_u32 v21, s33, v17
    v_add_u32 v22, s33, v18
    v_add_u32 v23, s33, v19
    v_add_u32 v24, s33, v20
    v_add_u32 v30, s33, v29
    s_waitcnt vmcnt(6) lgkmcnt(0)
    s_barrier
    s_setprio 1
    v_mfma_f32_16x16x32_bf16 v[96:99], v[64:67], v[80:83], v[96:99]
    ds_read_b64_tr_b16 v[32:33], v21 offset:0
    v_mfma_f32_16x16x32_bf16 v[100:103], v[64:67], v[84:87], v[100:103]
    s_add_u32 s35, s32, s83
    s_mov_b32 m0, s35
    s_nop 0
    buffer_load_dwordx4 v15, s[24:27], s84 offen lds
    v_mfma_f32_16x16x32_bf16 v[104:107], v[64:67], v[88:91], v[104:107]
    ds_read_b128 v[48:51], v30 offset:0
    v_mfma_f32_16x16x32_bf16 v[108:111], v[64:67], v[92:95], v[108:111]
    ds_read_b64_tr_b16 v[34:35], v21 offset:1024
    v_mfma_f32_16x16x32_bf16 v[112:115], v[68:71], v[80:83], v[112:115]
    ds_read_b64_tr_b16 v[36:37], v22 offset:32
    v_mfma_f32_16x16x32_bf16 v[116:119], v[68:71], v[84:87], v[116:119]
    ds_read_b128 v[52:55], v30 offset:2048
    v_mfma_f32_16x16x32_bf16 v[120:123], v[68:71], v[88:91], v[120:123]
    buffer_load_dwordx4 v16, s[24:27], s84 offen offset:1024 lds
    v_mfma_f32_16x16x32_bf16 v[124:127], v[68:71], v[92:95], v[124:127]
    ds_read_b64_tr_b16 v[38:39], v22 offset:1056
    v_mfma_f32_16x16x32_bf16 v[128:131], v[72:75], v[80:83], v[128:131]
    ds_read_b64_tr_b16 v[40:41], v23 offset:64
    v_mfma_f32_16x16x32_bf16 v[132:135], v[72:75], v[84:87], v[132:135]
    ds_read_b128 v[56:59], v30 offset:4096
    v_mfma_f32_16x16x32_bf16 v[136:139], v[72:75], v[88:91], v[136:139]
    ds_read_b64_tr_b16 v[42:43], v23 offset:1088
    v_mfma_f32_16x16x32_bf16 v[140:143], v[72:75], v[92:95], v[140:143]
    s_add_u32 s84, s84, 131072
    v_mfma_f32_16x16x32_bf16 v[144:147], v[76:79], v[80:83], v[144:147]
    ds_read_b64_tr_b16 v[44:45], v24 offset:96
    v_mfma_f32_16x16x32_bf16 v[148:151], v[76:79], v[84:87], v[148:151]
    ds_read_b128 v[60:63], v30 offset:6144
    v_mfma_f32_16x16x32_bf16 v[152:155], v[76:79], v[88:91], v[152:155]
    ds_read_b64_tr_b16 v[46:47], v24 offset:1120
    v_mfma_f32_16x16x32_bf16 v[156:159], v[76:79], v[92:95], v[156:159]
    v_xor_b32 v31, 64, v30
    s_setprio 0
    s_sub_u32 s34, s34, 1
    s_cmp_lg_u32 s34, 0
    s_cbranch_scc1 L_gl69
    s_mov_b32 s31, s32
    s_mov_b32 s32, s33
    s_add_u32 s33, s33, 49152
    s_cmp_eq_u32 s33, 147456
    s_cselect_b32 s33, 0, s33
    s_waitcnt lgkmcnt(0)
    v_mfma_f32_16x16x32_bf16 v[96:99], v[32:35], v[48:51], v[96:99]
    ds_read_b64_tr_b16 v[64:65], v21 offset:8192
    s_add_u32 s35, s31, s39
    s_mov_b32 m0, s35
    s_nop 0
    buffer_load_dwordx4 v25, s[16:19], s3 offen sc1 lds
    v_mfma_f32_16x16x32_bf16 v[100:103], v[32:35], v[52:55], v[100:103]
    ds_read_b128 v[80:83], v31 offset:0
    v_mfma_f32_16x16x32_bf16 v[104:107], v[32:35], v[56:59], v[104:107]
    ds_read_b64_tr_b16 v[66:67], v21 offset:9216
    v_mfma_f32_16x16x32_bf16 v[108:111], v[32:35], v[60:63], v[108:111]
    buffer_load_dwordx4 v26, s[16:19], s3 offen offset:1024 sc1 lds
    v_mfma_f32_16x16x32_bf16 v[112:115], v[36:39], v[48:51], v[112:115]
    ds_read_b64_tr_b16 v[68:69], v22 offset:8224
    v_mfma_f32_16x16x32_bf16 v[116:119], v[36:39], v[52:55], v[116:119]
    ds_read_b128 v[84:87], v31 offset:2048
    v_mfma_f32_16x16x32_bf16 v[120:123], v[36:39], v[56:59], v[120:123]
    ds_read_b64_tr_b16 v[70:71], v22 offset:9248
    v_mfma_f32_16x16x32_bf16 v[124:127], v[36:39], v[60:63], v[124:127]
    buffer_load_dwordx4 v27, s[16:19], s3 offen offset:2048 sc1 lds
    v_mfma_f32_16x16x32_bf16 v[128:131], v[40:43], v[48:51], v[128:131]
    ds_read_b64_tr_b16 v[72:73], v23 offset:8256
    ds_read_b128 v[88:91], v31 offset:4096
    v_mfma_f32_16x16x32_bf16 v[132:135], v[40:43], v[52:55], v[132:135]
    buffer_load_dwordx4 v28, s[16:19], s3 offen offset:3072 sc1 lds
    v_mfma_f32_16x16x32_bf16 v[136:139], v[40:43], v[56:59], v[136:139]
    ds_read_b64_tr_b16 v[74:75], v23 offset:9280
    v_mfma_f32_16x16x32_bf16 v[140:143], v[40:43], v[60:63], v[140:143]
    ds_read_b64_tr_b16 v[76:77], v24 offset:8288
    v_mfma_f32_16x16x32_bf16 v[144:147], v[44:47], v[48:51], v[144:147]
    ds_read_b128 v[92:95], v31 offset:6144
    v_mfma_f32_16x16x32_bf16 v[148:151], v[44:47], v[52:55], v[148:151]
    s_add_u32 s3, s3, 128
    v_mfma_f32_16x16x32_bf16 v[152:155], v[44:47], v[56:59], v[152:155]
    ds_read_b64_tr_b16 v[78:79], v24 offset:9312
    v_mfma_f32_16x16x32_bf16 v[156:159], v[44:47], v[60:63], v[156:159]
    v_add_u32 v21, s33, v17
    v_add_u32 v22, s33, v18
    v_add_u32 v23, s33, v19
    v_add_u32 v24, s33, v20
    v_add_u32 v30, s33, v29
    s_waitcnt vmcnt(6) lgkmcnt(0)
    s_barrier
    s_setprio 1
    v_mfma_f32_16x16x32_bf16 v[96:99], v[64:67], v[80:83], v[96:99]
    ds_read_b64_tr_b16 v[32:33], v21 offset:0
    ds_read_b128 v[48:51], v30 offset:0
    v_mfma_f32_16x16x32_bf16 v[100:103], v[64:67], v[84:87], v[100:103]
    ds_read_b64_tr_b16 v[34:35], v21 offset:1024
    ds_read_b64_tr_b16 v[36:37], v22 offset:32
    v_mfma_f32_16x16x32_bf16 v[104:107], v[64:67], v[88:91], v[104:107]
    ds_read_b128 v[52:55], v30 offset:2048
    v_mfma_f32_16x16x32_bf16 v[108:111], v[64:67], v[92:95], v[108:111]
    ds_read_b64_tr_b16 v[38:39], v22 offset:1056
    ds_read_b64_tr_b16 v[40:41], v23 offset:64
    v_mfma_f32_16x16x32_bf16 v[112:115], v[68:71], v[80:83], v[112:115]
    ds_read_b128 v[56:59], v30 offset:4096
    v_mfma_f32_16x16x32_bf16 v[116:119], v[68:71], v[84:87], v[116:119]
    ds_read_b64_tr_b16 v[42:43], v23 offset:1088
    ds_read_b64_tr_b16 v[44:45], v24 offset:96
    v_mfma_f32_16x16x32_bf16 v[120:123], v[68:71], v[88:91], v[120:123]
    ds_read_b128 v[60:63], v30 offset:6144
    v_mfma_f32_16x16x32_bf16 v[124:127], v[68:71], v[92:95], v[124:127]
    ds_read_b64_tr_b16 v[46:47], v24 offset:1120
    v_xor_b32 v31, 64, v30
    v_mfma_f32_16x16x32_bf16 v[128:131], v[72:75], v[80:83], v[128:131]
    s_mul_i32 s76, s86, 256
    s_mul_i32 s77, s81, 64
    s_add_u32 s76, s76, s77
    v_and_b32 v232, 15, v0
    v_add_u32 v232, s76, v232
    v_lshlrev_b32 v233, 3, v232
    s_add_u32 s76, s0, 0
    s_and_b32 s76, s76, 3
    s_lshl_b32 s76, s76, 7
    s_add_u32 s76, s76, 25165824
    buffer_load_dwordx2 v[224:225], v233, s[16:19], s76 offen sc1
    v_mfma_f32_16x16x32_bf16 v[132:135], v[72:75], v[84:87], v[132:135]
    s_add_u32 s76, s0, 1
    s_and_b32 s76, s76, 3
    s_lshl_b32 s76, s76, 7
    s_add_u32 s76, s76, 25165824
    buffer_load_dwordx2 v[226:227], v233, s[16:19], s76 offen sc1
    v_mfma_f32_16x16x32_bf16 v[136:139], v[72:75], v[88:91], v[136:139]
    s_add_u32 s76, s0, 2
    s_and_b32 s76, s76, 3
    s_lshl_b32 s76, s76, 7
    s_add_u32 s76, s76, 25165824
    buffer_load_dwordx2 v[228:229], v233, s[16:19], s76 offen sc1
    s_add_u32 s76, s0, 3
    s_and_b32 s76, s76, 3
    s_lshl_b32 s76, s76, 7
    s_add_u32 s76, s76, 25165824
    buffer_load_dwordx2 v[230:231], v233, s[16:19], s76 offen sc1
    v_mfma_f32_16x16x32_bf16 v[140:143], v[72:75], v[92:95], v[140:143]
    s_lshl_b32 s76, s0, 4
    v_add_u32 v232, s76, v232
    v_lshrrev_b32 v234, 4, v0
    v_lshlrev_b32 v234, 2, v234
    s_lshl_b32 s76, s87, 7
    s_lshl_b32 s77, s80, 6
    s_add_u32 s76, s76, s77
    v_add_u32 v234, s76, v234
    v_lshlrev_b32 v234, 1, v234
    v_lshl_add_u32 v233, v232, 11, v234
    v_lshlrev_b32 v235, 4, v0
    v_mfma_f32_16x16x32_bf16 v[144:147], v[76:79], v[80:83], v[144:147]
    s_add_u32 s77, s0, 1
    s_and_b32 s77, s77, 3
    s_mul_i32 s76, s77, 2
    s_and_b32 s78, s2, 1
    s_add_u32 s76, s76, s78
    s_lshr_b32 s78, s87, 2
    s_xor_b32 s78, s78, s77
    s_and_b32 s78, s78, 1
    s_xor_b32 s78, s78, 1
    s_lshl_b32 s78, s78, 7
    s_or_b32 s76, s76, s78
    s_and_b32 s78, s2, 0x78
    s_or_b32 s76, s76, s78
    s_lshl_b32 s76, s76, 3
    s_add_u32 s76, s76, s28
    s_mul_i32 s76, s76, 12288
    s_add_u32 s44, s76, 33562624
    s_add_u32 s77, s0, 2
    s_and_b32 s77, s77, 3
    s_mul_i32 s76, s77, 2
    s_and_b32 s78, s2, 1
    s_add_u32 s76, s76, s78
    s_lshr_b32 s78, s87, 2
    s_xor_b32 s78, s78, s77
    s_and_b32 s78, s78, 1
    s_xor_b32 s78, s78, 1
    s_lshl_b32 s78, s78, 7
    s_or_b32 s76, s76, s78
    s_and_b32 s78, s2, 0x78
    s_or_b32 s76, s76, s78
    s_lshl_b32 s76, s76, 3
    s_add_u32 s76, s76, s28
    s_mul_i32 s76, s76, 12288
    s_add_u32 s45, s76, 33558528
    v_mfma_f32_16x16x32_bf16 v[148:151], v[76:79], v[84:87], v[148:151]
    s_add_u32 s77, s0, 3
    s_and_b32 s77, s77, 3
    s_mul_i32 s76, s77, 2
    s_and_b32 s78, s2, 1
    s_add_u32 s76, s76, s78
    s_lshr_b32 s78, s87, 2
    s_xor_b32 s78, s78, s77
    s_and_b32 s78, s78, 1
    s_xor_b32 s78, s78, 1
    s_lshl_b32 s78, s78, 7
    s_or_b32 s76, s76, s78
    s_and_b32 s78, s2, 0x78
    s_or_b32 s76, s76, s78
    s_lshl_b32 s76, s76, 3
    s_add_u32 s76, s76, s28
    s_mul_i32 s76, s76, 12288
    s_add_u32 s46, s76, 33554432
    v_mfma_f32_16x16x32_bf16 v[152:155], v[76:79], v[88:91], v[152:155]
    buffer_load_dword v250, v233, s[4:7], 0 offen
    s_mov_b32 s72, s56
    s_mov_b32 s73, s57
    s_mov_b32 s74, 2048
    s_mov_b32 s75, 0x20000
    buffer_load_dword v250, v234, s[72:75], 0 offen
    v_mfma_f32_16x16x32_bf16 v[156:159], v[76:79], v[92:95], v[156:159]
    s_mov_b32 s72, s66
    s_mov_b32 s73, s67
    buffer_load_dword v250, v234, s[72:75], 0 offen
    s_setprio 0
    s_mov_b32 s31, s32
    s_mov_b32 s32, s33
    s_add_u32 s33, s33, 49152
    s_cmp_eq_u32 s33, 147456
    s_cselect_b32 s33, 0, s33
    s_waitcnt lgkmcnt(0)
    v_mfma_f32_16x16x32_bf16 v[96:99], v[32:35], v[48:51], v[96:99]
    ds_read_b64_tr_b16 v[64:65], v21 offset:8192
    v_mfma_f32_16x16x32_bf16 v[100:103], v[32:35], v[52:55], v[100:103]
    ds_read_b128 v[80:83], v31 offset:0
    v_mfma_f32_16x16x32_bf16 v[104:107], v[32:35], v[56:59], v[104:107]
    ds_read_b64_tr_b16 v[66:67], v21 offset:9216
    v_mfma_f32_16x16x32_bf16 v[108:111], v[32:35], v[60:63], v[108:111]
    ds_read_b64_tr_b16 v[68:69], v22 offset:8224
    v_mfma_f32_16x16x32_bf16 v[112:115], v[36:39], v[48:51], v[112:115]
    ds_read_b128 v[84:87], v31 offset:2048
    v_mfma_f32_16x16x32_bf16 v[116:119], v[36:39], v[52:55], v[116:119]
    v_mfma_f32_16x16x32_bf16 v[120:123], v[36:39], v[56:59], v[120:123]
    ds_read_b64_tr_b16 v[70:71], v22 offset:9248
    v_mfma_f32_16x16x32_bf16 v[124:127], v[36:39], v[60:63], v[124:127]
    ds_read_b64_tr_b16 v[72:73], v23 offset:8256
    v_mfma_f32_16x16x32_bf16 v[128:131], v[40:43], v[48:51], v[128:131]
    ds_read_b128 v[88:91], v31 offset:4096
    v_mfma_f32_16x16x32_bf16 v[132:135], v[40:43], v[52:55], v[132:135]
    ds_read_b64_tr_b16 v[74:75], v23 offset:9280
    v_mfma_f32_16x16x32_bf16 v[136:139], v[40:43], v[56:59], v[136:139]
    v_mfma_f32_16x16x32_bf16 v[140:143], v[40:43], v[60:63], v[140:143]
    ds_read_b64_tr_b16 v[76:77], v24 offset:8288
    v_mfma_f32_16x16x32_bf16 v[144:147], v[44:47], v[48:51], v[144:147]
    ds_read_b128 v[92:95], v31 offset:6144
    v_mfma_f32_16x16x32_bf16 v[148:151], v[44:47], v[52:55], v[148:151]
    ds_read_b64_tr_b16 v[78:79], v24 offset:9312
    v_mfma_f32_16x16x32_bf16 v[152:155], v[44:47], v[56:59], v[152:155]
    v_add_u32 v21, s33, v17
    v_add_u32 v22, s33, v18
    v_add_u32 v23, s33, v19
    v_add_u32 v24, s33, v20
    v_add_u32 v30, s33, v29
    v_mfma_f32_16x16x32_bf16 v[156:159], v[44:47], v[60:63], v[156:159]
    s_waitcnt vmcnt(7) lgkmcnt(0)
    s_barrier
    s_setprio 1
    v_mfma_f32_16x16x32_bf16 v[96:99], v[64:67], v[80:83], v[96:99]
    ds_read_b64_tr_b16 v[32:33], v21 offset:0
    v_mfma_f32_16x16x32_bf16 v[100:103], v[64:67], v[84:87], v[100:103]
    ds_read_b128 v[48:51], v30 offset:0
    v_mfma_f32_16x16x32_bf16 v[104:107], v[64:67], v[88:91], v[104:107]
    ds_read_b64_tr_b16 v[34:35], v21 offset:1024
    v_mfma_f32_16x16x32_bf16 v[108:111], v[64:67], v[92:95], v[108:111]
    ds_read_b64_tr_b16 v[36:37], v22 offset:32
    v_mfma_f32_16x16x32_bf16 v[112:115], v[68:71], v[80:83], v[112:115]
    ds_read_b128 v[52:55], v30 offset:2048
    v_mfma_f32_16x16x32_bf16 v[116:119], v[68:71], v[84:87], v[116:119]
    v_mfma_f32_16x16x32_bf16 v[120:123], v[68:71], v[88:91], v[120:123]
    ds_read_b64_tr_b16 v[38:39], v22 offset:1056
    v_mfma_f32_16x16x32_bf16 v[124:127], v[68:71], v[92:95], v[124:127]
    ds_read_b64_tr_b16 v[40:41], v23 offset:64
    v_mfma_f32_16x16x32_bf16 v[128:131], v[72:75], v[80:83], v[128:131]
    ds_read_b128 v[56:59], v30 offset:4096
    v_mfma_f32_16x16x32_bf16 v[132:135], v[72:75], v[84:87], v[132:135]
    ds_read_b64_tr_b16 v[42:43], v23 offset:1088
    v_mfma_f32_16x16x32_bf16 v[136:139], v[72:75], v[88:91], v[136:139]
    v_mfma_f32_16x16x32_bf16 v[140:143], v[72:75], v[92:95], v[140:143]
    ds_read_b64_tr_b16 v[44:45], v24 offset:96
    v_mfma_f32_16x16x32_bf16 v[144:147], v[76:79], v[80:83], v[144:147]
    ds_read_b128 v[60:63], v30 offset:6144
    v_mfma_f32_16x16x32_bf16 v[148:151], v[76:79], v[84:87], v[148:151]
    ds_read_b64_tr_b16 v[46:47], v24 offset:1120
    v_mfma_f32_16x16x32_bf16 v[152:155], v[76:79], v[88:91], v[152:155]
    v_xor_b32 v31, 64, v30
    v_mfma_f32_16x16x32_bf16 v[156:159], v[76:79], v[92:95], v[156:159]
    s_setprio 0
    s_mov_b32 s31, s32
    s_mov_b32 s32, s33
    s_add_u32 s33, s33, 49152
    s_cmp_eq_u32 s33, 147456
    s_cselect_b32 s33, 0, s33
    s_waitcnt lgkmcnt(0)
    v_mfma_f32_16x16x32_bf16 v[96:99], v[32:35], v[48:51], v[96:99]
    ds_read_b64_tr_b16 v[64:65], v21 offset:8192
    v_mfma_f32_16x16x32_bf16 v[100:103], v[32:35], v[52:55], v[100:103]
    ds_read_b128 v[80:83], v31 offset:0
    v_mfma_f32_16x16x32_bf16 v[104:107], v[32:35], v[56:59], v[104:107]
    ds_read_b64_tr_b16 v[66:67], v21 offset:9216
    v_mfma_f32_16x16x32_bf16 v[108:111], v[32:35], v[60:63], v[108:111]
    v_mfma_f32_16x16x32_bf16 v[112:115], v[36:39], v[48:51], v[112:115]
    ds_read_b64_tr_b16 v[68:69], v22 offset:8224
    v_mfma_f32_16x16x32_bf16 v[116:119], v[36:39], v[52:55], v[116:119]
    ds_read_b128 v[84:87], v31 offset:2048
    v_mfma_f32_16x16x32_bf16 v[120:123], v[36:39], v[56:59], v[120:123]
    ds_read_b64_tr_b16 v[70:71], v22 offset:9248
    v_mfma_f32_16x16x32_bf16 v[124:127], v[36:39], v[60:63], v[124:127]
    v_mfma_f32_16x16x32_bf16 v[128:131], v[40:43], v[48:51], v[128:131]
    ds_read_b64_tr_b16 v[72:73], v23 offset:8256
    v_mfma_f32_16x16x32_bf16 v[132:135], v[40:43], v[52:55], v[132:135]
    ds_read_b128 v[88:91], v31 offset:4096
    v_mfma_f32_16x16x32_bf16 v[136:139], v[40:43], v[56:59], v[136:139]
    ds_read_b64_tr_b16 v[74:75], v23 offset:9280
    v_mfma_f32_16x16x32_bf16 v[140:143], v[40:43], v[60:63], v[140:143]
    v_mfma_f32_16x16x32_bf16 v[144:147], v[44:47], v[48:51], v[144:147]
    ds_read_b64_tr_b16 v[76:77], v24 offset:8288
    v_mfma_f32_16x16x32_bf16 v[148:151], v[44:47], v[52:55], v[148:151]
    ds_read_b128 v[92:95], v31 offset:6144
    v_mfma_f32_16x16x32_bf16 v[152:155], v[44:47], v[56:59], v[152:155]
    ds_read_b64_tr_b16 v[78:79], v24 offset:9312
    v_mfma_f32_16x16x32_bf16 v[156:159], v[44:47], v[60:63], v[156:159]
    s_waitcnt lgkmcnt(0)
    v_mfma_f32_16x16x32_bf16 v[96:99], v[64:67], v[80:83], v[96:99]
    v_mfma_f32_16x16x32_bf16 v[100:103], v[64:67], v[84:87], v[100:103]
    v_mfma_f32_16x16x32_bf16 v[104:107], v[64:67], v[88:91], v[104:107]
    v_mfma_f32_16x16x32_bf16 v[108:111], v[64:67], v[92:95], v[108:111]
    v_mfma_f32_16x16x32_bf16 v[112:115], v[68:71], v[80:83], v[112:115]
    v_mfma_f32_16x16x32_bf16 v[116:119], v[68:71], v[84:87], v[116:119]
    v_mfma_f32_16x16x32_bf16 v[120:123], v[68:71], v[88:91], v[120:123]
    v_mfma_f32_16x16x32_bf16 v[124:127], v[68:71], v[92:95], v[124:127]
    v_mfma_f32_16x16x32_bf16 v[128:131], v[72:75], v[80:83], v[128:131]
    v_mfma_f32_16x16x32_bf16 v[132:135], v[72:75], v[84:87], v[132:135]
    v_mfma_f32_16x16x32_bf16 v[136:139], v[72:75], v[88:91], v[136:139]
    v_mfma_f32_16x16x32_bf16 v[140:143], v[72:75], v[92:95], v[140:143]
    v_mfma_f32_16x16x32_bf16 v[144:147], v[76:79], v[80:83], v[144:147]
    v_mfma_f32_16x16x32_bf16 v[148:151], v[76:79], v[84:87], v[148:151]
    v_mfma_f32_16x16x32_bf16 v[152:155], v[76:79], v[88:91], v[152:155]
    v_mfma_f32_16x16x32_bf16 v[156:159], v[76:79], v[92:95], v[156:159]
    s_nop 7
    s_waitcnt vmcnt(0)
    buffer_load_dwordx2 v[64:65], v233, s[4:7], 0 offen offset:0
    buffer_load_dwordx2 v[66:67], v233, s[4:7], 0 offen offset:32
    buffer_load_dwordx2 v[68:69], v233, s[4:7], 0 offen offset:64
    buffer_load_dwordx2 v[70:71], v233, s[4:7], 0 offen offset:96
    s_mov_b32 s72, s56
    s_mov_b32 s73, s57
    s_mov_b32 s74, 2048
    s_mov_b32 s75, 0x20000
    buffer_load_dwordx2 v[72:73], v234, s[72:75], 0 offen offset:0
    buffer_load_dwordx2 v[74:75], v234, s[72:75], 0 offen offset:32
    buffer_load_dwordx2 v[76:77], v234, s[72:75], 0 offen offset:64
    buffer_load_dwordx2 v[78:79], v234, s[72:75], 0 offen offset:96
    s_mov_b32 s72, s66
    s_mov_b32 s73, s67
    buffer_load_dwordx2 v[80:81], v234, s[72:75], 0 offen offset:0
    buffer_load_dwordx2 v[82:83], v234, s[72:75], 0 offen offset:32
    buffer_load_dwordx2 v[84:85], v234, s[72:75], 0 offen offset:64
    buffer_load_dwordx2 v[86:87], v234, s[72:75], 0 offen offset:96
    v_mul_f32 v100, v227, v100
    v_fmac_f32 v100, v226, v164
    v_mul_f32 v101, v227, v101
    v_fmac_f32 v101, v226, v165
    v_mul_f32 v102, v227, v102
    v_fmac_f32 v102, v226, v166
    v_mul_f32 v103, v227, v103
    v_fmac_f32 v103, v226, v167
    v_mul_f32 v116, v227, v116
    v_fmac_f32 v116, v226, v180
    v_mul_f32 v117, v227, v117
    v_fmac_f32 v117, v226, v181
    v_mul_f32 v118, v227, v118
    v_fmac_f32 v118, v226, v182
    v_mul_f32 v119, v227, v119
    v_fmac_f32 v119, v226, v183
    v_mul_f32 v132, v227, v132
    v_fmac_f32 v132, v226, v196
    v_mul_f32 v133, v227, v133
    v_fmac_f32 v133, v226, v197
    v_mul_f32 v134, v227, v134
    v_fmac_f32 v134, v226, v198
    v_mul_f32 v135, v227, v135
    v_fmac_f32 v135, v226, v199
    v_mul_f32 v148, v227, v148
    v_fmac_f32 v148, v226, v212
    v_mul_f32 v149, v227, v149
    v_fmac_f32 v149, v226, v213
    v_mul_f32 v150, v227, v150
    v_fmac_f32 v150, v226, v214
    v_mul_f32 v151, v227, v151
    v_fmac_f32 v151, v226, v215
    v_cvt_pk_bf16_f32 v100, v100, v101
    v_cvt_pk_bf16_f32 v101, v102, v103
    v_cvt_pk_bf16_f32 v102, v116, v117
    v_cvt_pk_bf16_f32 v103, v118, v119
    buffer_store_dwordx4 v[100:103], v235, s[16:19], s44 offen offset:0 sc1
    v_cvt_pk_bf16_f32 v132, v132, v133
    v_cvt_pk_bf16_f32 v133, v134, v135
    v_cvt_pk_bf16_f32 v134, v148, v149
    v_cvt_pk_bf16_f32 v135, v150, v151
    buffer_store_dwordx4 v[132:135], v235, s[16:19], s44 offen offset:1024 sc1
    v_mul_f32 v104, v229, v104
    v_fmac_f32 v104, v228, v168
    v_mul_f32 v105, v229, v105
    v_fmac_f32 v105, v228, v169
    v_mul_f32 v106, v229, v106
    v_fmac_f32 v106, v228, v170
    v_mul_f32 v107, v229, v107
    v_fmac_f32 v107, v228, v171
    v_mul_f32 v120, v229, v120
    v_fmac_f32 v120, v228, v184
    v_mul_f32 v121, v229, v121
    v_fmac_f32 v121, v228, v185
    v_mul_f32 v122, v229, v122
    v_fmac_f32 v122, v228, v186
    v_mul_f32 v123, v229, v123
    v_fmac_f32 v123, v228, v187
    v_mul_f32 v136, v229, v136
    v_fmac_f32 v136, v228, v200
    v_mul_f32 v137, v229, v137
    v_fmac_f32 v137, v228, v201
    v_mul_f32 v138, v229, v138
    v_fmac_f32 v138, v228, v202
    v_mul_f32 v139, v229, v139
    v_fmac_f32 v139, v228, v203
    v_mul_f32 v152, v229, v152
    v_fmac_f32 v152, v228, v216
    v_mul_f32 v153, v229, v153
    v_fmac_f32 v153, v228, v217
    v_mul_f32 v154, v229, v154
    v_fmac_f32 v154, v228, v218
    v_mul_f32 v155, v229, v155
    v_fmac_f32 v155, v228, v219
    v_cvt_pk_bf16_f32 v104, v104, v105
    v_cvt_pk_bf16_f32 v105, v106, v107
    v_cvt_pk_bf16_f32 v106, v120, v121
    v_cvt_pk_bf16_f32 v107, v122, v123
    buffer_store_dwordx4 v[104:107], v235, s[16:19], s45 offen offset:0 sc1
    v_cvt_pk_bf16_f32 v136, v136, v137
    v_cvt_pk_bf16_f32 v137, v138, v139
    v_cvt_pk_bf16_f32 v138, v152, v153
    v_cvt_pk_bf16_f32 v139, v154, v155
    buffer_store_dwordx4 v[136:139], v235, s[16:19], s45 offen offset:1024 sc1
    v_mul_f32 v108, v231, v108
    v_fmac_f32 v108, v230, v172
    v_mul_f32 v109, v231, v109
    v_fmac_f32 v109, v230, v173
    v_mul_f32 v110, v231, v110
    v_fmac_f32 v110, v230, v174
    v_mul_f32 v111, v231, v111
    v_fmac_f32 v111, v230, v175
    v_mul_f32 v124, v231, v124
    v_fmac_f32 v124, v230, v188
    v_mul_f32 v125, v231, v125
    v_fmac_f32 v125, v230, v189
    v_mul_f32 v126, v231, v126
    v_fmac_f32 v126, v230, v190
    v_mul_f32 v127, v231, v127
    v_fmac_f32 v127, v230, v191
    v_mul_f32 v140, v231, v140
    v_fmac_f32 v140, v230, v204
    v_mul_f32 v141, v231, v141
    v_fmac_f32 v141, v230, v205
    v_mul_f32 v142, v231, v142
    v_fmac_f32 v142, v230, v206
    v_mul_f32 v143, v231, v143
    v_fmac_f32 v143, v230, v207
    v_mul_f32 v156, v231, v156
    v_fmac_f32 v156, v230, v220
    v_mul_f32 v157, v231, v157
    v_fmac_f32 v157, v230, v221
    v_mul_f32 v158, v231, v158
    v_fmac_f32 v158, v230, v222
    v_mul_f32 v159, v231, v159
    v_fmac_f32 v159, v230, v223
    v_cvt_pk_bf16_f32 v108, v108, v109
    v_cvt_pk_bf16_f32 v109, v110, v111
    v_cvt_pk_bf16_f32 v110, v124, v125
    v_cvt_pk_bf16_f32 v111, v126, v127
    buffer_store_dwordx4 v[108:111], v235, s[16:19], s46 offen offset:0 sc1
    v_cvt_pk_bf16_f32 v140, v140, v141
    v_cvt_pk_bf16_f32 v141, v142, v143
    v_cvt_pk_bf16_f32 v142, v156, v157
    v_cvt_pk_bf16_f32 v143, v158, v159
    buffer_store_dwordx4 v[140:143], v235, s[16:19], s46 offen offset:1024 sc1
    v_mul_f32 v96, v225, v96
    v_fmac_f32 v96, v224, v160
    v_mul_f32 v97, v225, v97
    v_fmac_f32 v97, v224, v161
    v_mul_f32 v98, v225, v98
    v_fmac_f32 v98, v224, v162
    v_mul_f32 v99, v225, v99
    v_fmac_f32 v99, v224, v163
    v_mul_f32 v112, v225, v112
    v_fmac_f32 v112, v224, v176
    v_mul_f32 v113, v225, v113
    v_fmac_f32 v113, v224, v177
    v_mul_f32 v114, v225, v114
    v_fmac_f32 v114, v224, v178
    v_mul_f32 v115, v225, v115
    v_fmac_f32 v115, v224, v179
    v_mul_f32 v128, v225, v128
    v_fmac_f32 v128, v224, v192
    v_mul_f32 v129, v225, v129
    v_fmac_f32 v129, v224, v193
    v_mul_f32 v130, v225, v130
    v_fmac_f32 v130, v224, v194
    v_mul_f32 v131, v225, v131
    v_fmac_f32 v131, v224, v195
    v_mul_f32 v144, v225, v144
    v_fmac_f32 v144, v224, v208
    v_mul_f32 v145, v225, v145
    v_fmac_f32 v145, v224, v209
    v_mul_f32 v146, v225, v146
    v_fmac_f32 v146, v224, v210
    v_mul_f32 v147, v225, v147
    v_fmac_f32 v147, v224, v211
    s_and_b32 s76, s2, 1
    v_mul_u32_u24 v7, 2, v0
    v_add_u32 v7, s76, v7
    s_lshr_b32 s76, s87, 2
    v_and_b32 v8, 1, v0
    v_xor_b32 v8, s76, v8
    v_xor_b32 v8, 1, v8
    s_lshr_b32 s76, s2, 3
    s_and_b32 s76, s76, 15
    v_lshlrev_b32 v8, 4, v8
    v_add_u32 v8, s76, v8
    v_lshl_or_b32 v8, v8, 3, v7
    v_lshlrev_b32 v8, 8, v8
    v_subrev_u32 v7, s0, v0
    v_and_b32 v7, 3, v7
    v_sub_u32 v7, 3, v7
    v_lshl_add_u32 v8, v7, 2, v8
    v_mov_b32 v9, 1
    s_lshl_b32 s76, 1, s0
    s_andn2_b32 s76, 15, s76
    s_lshl_b32 s77, s28, 4
    s_add_u32 s77, s77, 25362464
    s_lshl_b32 s79, s2, 8
    s_add_u32 s79, s79, s77
    s_waitcnt vmcnt(6)
    v_lshlrev_b32 v2, 16, v64
    v_and_b32 v3, 0xffff0000, v64
    v_lshlrev_b32 v4, 16, v72
    v_and_b32 v5, 0xffff0000, v72
    v_mul_f32 v2, v2, v4
    v_mul_f32 v3, v3, v5
    v_cvt_pk_bf16_f32 v2, v2, v3
    v_and_b32 v3, 0xffff0000, v2
    v_lshlrev_b32 v2, 16, v2
    v_fmac_f32 v96, v224, v2
    v_fmac_f32 v97, v224, v3
    v_lshlrev_b32 v2, 16, v80
    v_and_b32 v3, 0xffff0000, v80
    v_fmac_f32 v96, v225, v2
    v_fmac_f32 v97, v225, v3
    v_lshlrev_b32 v2, 16, v65
    v_and_b32 v3, 0xffff0000, v65
    v_lshlrev_b32 v4, 16, v73
    v_and_b32 v5, 0xffff0000, v73
    v_mul_f32 v2, v2, v4
    v_mul_f32 v3, v3, v5
    v_cvt_pk_bf16_f32 v2, v2, v3
    v_and_b32 v3, 0xffff0000, v2
    v_lshlrev_b32 v2, 16, v2
    v_fmac_f32 v98, v224, v2
    v_fmac_f32 v99, v224, v3
    v_lshlrev_b32 v2, 16, v81
    v_and_b32 v3, 0xffff0000, v81
    v_fmac_f32 v98, v225, v2
    v_fmac_f32 v99, v225, v3
    v_lshlrev_b32 v2, 16, v66
    v_and_b32 v3, 0xffff0000, v66
    v_lshlrev_b32 v4, 16, v74
    v_and_b32 v5, 0xffff0000, v74
    v_mul_f32 v2, v2, v4
    v_mul_f32 v3, v3, v5
    v_cvt_pk_bf16_f32 v2, v2, v3
    v_and_b32 v3, 0xffff0000, v2
    v_lshlrev_b32 v2, 16, v2
    v_fmac_f32 v112, v224, v2
    v_fmac_f32 v113, v224, v3
    v_lshlrev_b32 v2, 16, v82
    v_and_b32 v3, 0xffff0000, v82
    v_fmac_f32 v112, v225, v2
    v_fmac_f32 v113, v225, v3
    v_lshlrev_b32 v2, 16, v67
    v_and_b32 v3, 0xffff0000, v67
    v_lshlrev_b32 v4, 16, v75
    v_and_b32 v5, 0xffff0000, v75
    v_mul_f32 v2, v2, v4
    v_mul_f32 v3, v3, v5
    v_cvt_pk_bf16_f32 v2, v2, v3
    v_and_b32 v3, 0xffff0000, v2
    v_lshlrev_b32 v2, 16, v2
    v_fmac_f32 v114, v224, v2
    v_fmac_f32 v115, v224, v3
    v_lshlrev_b32 v2, 16, v83
    v_and_b32 v3, 0xffff0000, v83
    v_fmac_f32 v114, v225, v2
    v_fmac_f32 v115, v225, v3
    v_lshlrev_b32 v2, 16, v68
    v_and_b32 v3, 0xffff0000, v68
    v_lshlrev_b32 v4, 16, v76
    v_and_b32 v5, 0xffff0000, v76
    v_mul_f32 v2, v2, v4
    v_mul_f32 v3, v3, v5
    v_cvt_pk_bf16_f32 v2, v2, v3
    v_and_b32 v3, 0xffff0000, v2
    v_lshlrev_b32 v2, 16, v2
    v_fmac_f32 v128, v224, v2
    v_fmac_f32 v129, v224, v3
    v_lshlrev_b32 v2, 16, v84
    v_and_b32 v3, 0xffff0000, v84
    v_fmac_f32 v128, v225, v2
    v_fmac_f32 v129, v225, v3
    v_lshlrev_b32 v2, 16, v69
    v_and_b32 v3, 0xffff0000, v69
    v_lshlrev_b32 v4, 16, v77
    v_and_b32 v5, 0xffff0000, v77
    v_mul_f32 v2, v2, v4
    v_mul_f32 v3, v3, v5
    v_cvt_pk_bf16_f32 v2, v2, v3
    v_and_b32 v3, 0xffff0000, v2
    v_lshlrev_b32 v2, 16, v2
    v_fmac_f32 v130, v224, v2
    v_fmac_f32 v131, v224, v3
    v_lshlrev_b32 v2, 16, v85
    v_and_b32 v3, 0xffff0000, v85
    v_fmac_f32 v130, v225, v2
    v_fmac_f32 v131, v225, v3
    v_lshlrev_b32 v2, 16, v70
    v_and_b32 v3, 0xffff0000, v70
    v_lshlrev_b32 v4, 16, v78
    v_and_b32 v5, 0xffff0000, v78
    v_mul_f32 v2, v2, v4
    v_mul_f32 v3, v3, v5
    v_cvt_pk_bf16_f32 v2, v2, v3
    v_and_b32 v3, 0xffff0000, v2
    v_lshlrev_b32 v2, 16, v2
    v_fmac_f32 v144, v224, v2
    v_fmac_f32 v145, v224, v3
    v_lshlrev_b32 v2, 16, v86
    v_and_b32 v3, 0xffff0000, v86
    v_fmac_f32 v144, v225, v2
    v_fmac_f32 v145, v225, v3
    v_lshlrev_b32 v2, 16, v71
    v_and_b32 v3, 0xffff0000, v71
    v_lshlrev_b32 v4, 16, v79
    v_and_b32 v5, 0xffff0000, v79
    v_mul_f32 v2, v2, v4
    v_mul_f32 v3, v3, v5
    v_cvt_pk_bf16_f32 v2, v2, v3
    v_and_b32 v3, 0xffff0000, v2
    v_lshlrev_b32 v2, 16, v2
    v_fmac_f32 v146, v224, v2
    v_fmac_f32 v147, v224, v3
    v_lshlrev_b32 v2, 16, v87
    v_and_b32 v3, 0xffff0000, v87
    v_fmac_f32 v146, v225, v2
    v_fmac_f32 v147, v225, v3
    s_waitcnt vmcnt(0)
    s_mov_b32 exec_lo, s76
    s_mov_b32 exec_hi, 0
    buffer_store_dword v9, v8, s[16:19], s77 offen sc1
    s_mov_b64 exec, -1
    v_mov_b32 v6, s79
    s_mov_b32 s90, 300000
L_poll70:
    s_sub_u32 s90, s90, 1
    s_cmp_eq_u32 s90, 0
    s_cbranch_scc1 L_pok71
    buffer_load_dwordx4 v[2:5], v6, s[16:19], 0 offen sc1
    s_waitcnt vmcnt(0)
    v_readfirstlane_b32 s88, v2
    v_readfirstlane_b32 s89, v3
    v_readfirstlane_b32 s91, v4
    s_nop 3
    s_and_b32 s88, s88, s89
    s_and_b32 s88, s88, s91
    s_cmp_lg_u32 s88, 0
    s_cbranch_scc1 L_pok71
    s_sleep 1
    s_branch L_poll70
L_pok71:
    s_lshl_b32 s76, s2, 3
    s_add_u32 s76, s76, s28
    s_mul_i32 s76, s76, 12288
    s_add_u32 s76, s76, 33554432
    buffer_load_dwordx4 v[32:35], v235, s[16:19], s76 offen offset:0 sc1
    buffer_load_dwordx4 v[36:39], v235, s[16:19], s76 offen offset:1024 sc1
    s_add_u32 s76, s76, 4096
    buffer_load_dwordx4 v[40:43], v235, s[16:19], s76 offen offset:0 sc1
    buffer_load_dwordx4 v[44:47], v235, s[16:19], s76 offen offset:1024 sc1
    s_add_u32 s76, s76, 4096
    buffer_load_dwordx4 v[48:51], v235, s[16:19], s76 offen offset:0 sc1
    buffer_load_dwordx4 v[52:55], v235, s[16:19], s76 offen offset:1024 sc1
    s_mov_b32 s72, s70
    s_mov_b32 s73, s71
    s_mov_b32 s74, 8388608
    s_mov_b32 s75, 0x20000
    v_lshlrev_b32 v2, 12, v232
    v_lshl_add_u32 v2, v234, 1, v2
    s_waitcnt vmcnt(0)
    v_lshlrev_b32 v4, 16, v32
    v_and_b32 v5, 0xffff0000, v32
    v_add_f32 v96, v96, v4
    v_add_f32 v97, v97, v5
    v_lshlrev_b32 v4, 16, v33
    v_and_b32 v5, 0xffff0000, v33
    v_add_f32 v98, v98, v4
    v_add_f32 v99, v99, v5
    v_lshlrev_b32 v4, 16, v40
    v_and_b32 v5, 0xffff0000, v40
    v_add_f32 v96, v96, v4
    v_add_f32 v97, v97, v5
    v_lshlrev_b32 v4, 16, v41
    v_and_b32 v5, 0xffff0000, v41
    v_add_f32 v98, v98, v4
    v_add_f32 v99, v99, v5
    v_lshlrev_b32 v4, 16, v48
    v_and_b32 v5, 0xffff0000, v48
    v_add_f32 v96, v96, v4
    v_add_f32 v97, v97, v5
    v_lshlrev_b32 v4, 16, v49
    v_and_b32 v5, 0xffff0000, v49
    v_add_f32 v98, v98, v4
    v_add_f32 v99, v99, v5
    buffer_store_dwordx4 v[96:99], v2, s[72:75], 0 offen offset:0
    v_lshlrev_b32 v4, 16, v34
    v_and_b32 v5, 0xffff0000, v34
    v_add_f32 v112, v112, v4
    v_add_f32 v113, v113, v5
    v_lshlrev_b32 v4, 16, v35
    v_and_b32 v5, 0xffff0000, v35
    v_add_f32 v114, v114, v4
    v_add_f32 v115, v115, v5
    v_lshlrev_b32 v4, 16, v42
    v_and_b32 v5, 0xffff0000, v42
    v_add_f32 v112, v112, v4
    v_add_f32 v113, v113, v5
    v_lshlrev_b32 v4, 16, v43
    v_and_b32 v5, 0xffff0000, v43
    v_add_f32 v114, v114, v4
    v_add_f32 v115, v115, v5
    v_lshlrev_b32 v4, 16, v50
    v_and_b32 v5, 0xffff0000, v50
    v_add_f32 v112, v112, v4
    v_add_f32 v113, v113, v5
    v_lshlrev_b32 v4, 16, v51
    v_and_b32 v5, 0xffff0000, v51
    v_add_f32 v114, v114, v4
    v_add_f32 v115, v115, v5
    buffer_store_dwordx4 v[112:115], v2, s[72:75], 0 offen offset:64
    v_lshlrev_b32 v4, 16, v36
    v_and_b32 v5, 0xffff0000, v36
    v_add_f32 v128, v128, v4
    v_add_f32 v129, v129, v5
    v_lshlrev_b32 v4, 16, v37
    v_and_b32 v5, 0xffff0000, v37
    v_add_f32 v130, v130, v4
    v_add_f32 v131, v131, v5
    v_lshlrev_b32 v4, 16, v44
    v_and_b32 v5, 0xffff0000, v44
    v_add_f32 v128, v128, v4
    v_add_f32 v129, v129, v5
    v_lshlrev_b32 v4, 16, v45
    v_and_b32 v5, 0xffff0000, v45
    v_add_f32 v130, v130, v4
    v_add_f32 v131, v131, v5
    v_lshlrev_b32 v4, 16, v52
    v_and_b32 v5, 0xffff0000, v52
    v_add_f32 v128, v128, v4
    v_add_f32 v129, v129, v5
    v_lshlrev_b32 v4, 16, v53
    v_and_b32 v5, 0xffff0000, v53
    v_add_f32 v130, v130, v4
    v_add_f32 v131, v131, v5
    buffer_store_dwordx4 v[128:131], v2, s[72:75], 0 offen offset:128
    v_lshlrev_b32 v4, 16, v38
    v_and_b32 v5, 0xffff0000, v38
    v_add_f32 v144, v144, v4
    v_add_f32 v145, v145, v5
    v_lshlrev_b32 v4, 16, v39
    v_and_b32 v5, 0xffff0000, v39
    v_add_f32 v146, v146, v4
    v_add_f32 v147, v147, v5
    v_lshlrev_b32 v4, 16, v46
    v_and_b32 v5, 0xffff0000, v46
    v_add_f32 v144, v144, v4
    v_add_f32 v145, v145, v5
    v_lshlrev_b32 v4, 16, v47
    v_and_b32 v5, 0xffff0000, v47
    v_add_f32 v146, v146, v4
    v_add_f32 v147, v147, v5
    v_lshlrev_b32 v4, 16, v54
    v_and_b32 v5, 0xffff0000, v54
    v_add_f32 v144, v144, v4
    v_add_f32 v145, v145, v5
    v_lshlrev_b32 v4, 16, v55
    v_and_b32 v5, 0xffff0000, v55
    v_add_f32 v146, v146, v4
    v_add_f32 v147, v147, v5
    buffer_store_dwordx4 v[144:147], v2, s[72:75], 0 offen offset:192
L_fin:
L_end:
    s_endpgm
L_codeend:
.section .rodata,"a"
.p2align 6
.amdhsa_kernel gated_mix__ssm_conv_s5__dense_activation_squared_relu__prompt_kernel
  .amdhsa_next_free_vgpr 251
  .amdhsa_next_free_sgpr 102
  .amdhsa_accum_offset 252
  .amdhsa_group_segment_fixed_size 0
  .amdhsa_kernarg_size 144
  .amdhsa_user_sgpr_count 2
  .amdhsa_user_sgpr_kernarg_segment_ptr 1
  .amdhsa_system_sgpr_workgroup_id_x 1
.end_amdhsa_kernel
```
